```python
import torch

def _softmax(x, axis=-1):
    return torch.softmax(x, dim=axis)

def _gelu(x):
    return torch.nn.functional.gelu(x, approximate='tanh')

def _silu(x):
    return torch.nn.functional.silu(x)

def _sigmoid(x):
    return torch.sigmoid(x)

def _layernorm(x, axis=-1, eps=1e-05):
    m = x.mean(dim=axis, keepdim=True)
    v = x.var(dim=axis, keepdim=True, unbiased=False)
    return (x - m) / torch.sqrt(v + eps)

def _scatter_add(tgt, idx, src, axis=0):
    return tgt.clone().index_add_(axis, idx, src)

def _segment_sum(src, seg, n):
    out = torch.zeros((n,) + src.shape[1:], dtype=src.dtype)
    return out.index_add_(0, seg, src)

def _pad(x, pw):
    flat = tuple((v for pair in reversed(pw) for v in pair))
    return torch.nn.functional.pad(x, flat)
kernel_name = 'parallel_sum__memory_aug_recurrent_mem_tr__geglu_ffn__prompt'

def setup_inputs():

    _w = lambda a: (lambda t: t.to(torch.bfloat16) if t.is_floating_point() else t)(torch.as_tensor(a))

    def _A_setup():
        B, S, Dm = (1, 2048, 576)
        H, Dh = (32, 128)
        M, seg = (8, 32)
        seg = min(seg, S)
        S = S // seg * seg
        return {'x': _w((lambda *s: torch.randn(*s, dtype=torch.bfloat16) * 0.05)(B, S, Dm)), 'mem0': _w((lambda *s: torch.randn(*s, dtype=torch.bfloat16) * 1.6)(B, M, Dm)), 'Wq': _w((lambda *s: torch.randn(*s, dtype=torch.bfloat16) * 0.8)(Dm, H, Dh) * Dm ** (-0.5)), 'Wk': _w((lambda *s: torch.randn(*s, dtype=torch.bfloat16) * 0.8)(Dm, H, Dh) * Dm ** (-0.5)), 'Wv': _w((lambda *s: torch.randn(*s, dtype=torch.bfloat16) * 1.6)(Dm, H, Dh) * Dm ** (-0.5)), 'Wo': _w((lambda *s: torch.randn(*s, dtype=torch.bfloat16) * 1.6)(H, Dh, Dm) * (H * Dh) ** (-0.5)), 'seg_len': seg}
    _A_in = _A_setup()

    def _B_setup():
        B, S, D, F = (1, 2048, 576, 4608)
        return {'x': _w((lambda *s: torch.randn(*s, dtype=torch.bfloat16) * 0.05)(B, S, D)), 'w_gate': _w((lambda *s: torch.randn(*s, dtype=torch.bfloat16) * 0.05)(D, F)), 'w_up': _w((lambda *s: torch.randn(*s, dtype=torch.bfloat16) * 0.05)(D, F)), 'w_down': _w((lambda *s: torch.randn(*s, dtype=torch.bfloat16) * 0.05)(F, D))}
    _B_in = _B_setup()
    return {'A_x': _A_in['x'], 'A_mem0': _A_in['mem0'], 'A_Wq': _A_in['Wq'], 'A_Wk': _A_in['Wk'], 'A_Wv': _A_in['Wv'], 'A_Wo': _A_in['Wo'], 'A_seg_len': _A_in['seg_len'], 'B_x': _B_in['x'], 'B_w_gate': _B_in['w_gate'], 'B_w_up': _B_in['w_up'], 'B_w_down': _B_in['w_down']}

def reference(A_x, A_mem0, A_Wq, A_Wk, A_Wv, A_Wo, A_seg_len, B_x, B_w_gate, B_w_up, B_w_down):

    def _A_ref(x, mem0, Wq, Wk, Wv, Wo, seg_len):
        B, S, Dm = x.shape
        H, Dh = (Wq.shape[1], Wq.shape[2])
        M = mem0.shape[1]
        scale = Dh ** (-0.5)
        n_seg = S // seg_len
        L = M + seg_len
        idx = torch.arange(L)
        mask = (idx[:, None] < M) | (idx[:, None] >= idx[None, :])
        mem = mem0
        outs = []
        for s in range(n_seg):
            xs = x[:, s * seg_len:(s + 1) * seg_len, :].clone()
            h = torch.concatenate([mem, xs], axis=1)
            q = torch.einsum('btd,dhe->bhte', h, Wq)
            k = torch.einsum('btd,dhe->bhte', h, Wk)
            v = torch.einsum('btd,dhe->bhte', h, Wv)
            scores = torch.einsum('bhqe,bhke->bhqk', q, k) * scale
            scores = torch.where(mask[None, None], scores, -1000000000.0)
            p = _softmax(scores, axis=-1)
            o = torch.einsum('bhqk,bhke->bhqe', p, v)
            o = torch.einsum('bhte,hed->btd', o, Wo)
            mem = o[:, :M, :].clone()
            outs.append(o[:, M:, :])
        return torch.concatenate(outs, axis=1)

    def _B_ref(x, w_gate, w_up, w_down):
        return _gelu(x @ w_gate) * (x @ w_up) @ w_down
    x = A_x
    xn = _layernorm(x, axis=-1)
    return x + _A_ref(xn, A_mem0, A_Wq, A_Wk, A_Wv, A_Wo, A_seg_len) + _B_ref(xn, B_w_gate, B_w_up, B_w_down)
```

```asm
; @launch grid=(256,1,1) block=(256,1,1) lds=163840
.amdgcn_target "amdgcn-amd-amdhsa--gfx950"
.text
.globl parallel_sum__memory_aug_recurrent_mem_tr__geglu_ffn__prompt_kernel
.p2align 8
.type parallel_sum__memory_aug_recurrent_mem_tr__geglu_ffn__prompt_kernel,@function
parallel_sum__memory_aug_recurrent_mem_tr__geglu_ffn__prompt_kernel:
  s_cmp_ge_u32 s2, 256
  s_cbranch_scc1 K_END
  s_load_dwordx2 s[72:73], s[0:1], 0
  s_load_dwordx2 s[74:75], s[0:1], 8
  s_load_dwordx2 s[76:77], s[0:1], 16
  s_load_dwordx2 s[78:79], s[0:1], 24
  s_load_dwordx2 s[80:81], s[0:1], 32
  s_load_dwordx2 s[82:83], s[0:1], 40
  s_load_dwordx2 s[84:85], s[0:1], 64
  s_load_dwordx2 s[86:87], s[0:1], 72
  s_load_dwordx2 s[88:89], s[0:1], 80
  s_load_dwordx2 s[90:91], s[0:1], 88
  s_load_dwordx2 s[92:93], s[0:1], 96
  s_load_dwordx2 s[94:95], s[0:1], 104
  s_getreg_b32 s3, hwreg(HW_REG_XCC_ID)
  v_lshrrev_b32 v4, 6, v0
  s_nop 0
  v_readfirstlane_b32 s13, v4
  s_waitcnt lgkmcnt(0)
  s_mov_b32 s4, s94
  s_mov_b32 s5, s95
  s_mov_b32 s6, 268435456
  s_mov_b32 s7, 0x20000
  s_cmp_lt_u32 s3, 8
  s_cselect_b32 s54, s3, 7
  s_lshr_b32 s55, s2, 3
  s_and_b32 s55, s55, 31
  s_cmp_lg_u32 s13, 0
  s_cbranch_scc1 CL_ISSUED
  s_mov_b64 exec, 1
  s_lshl_b32 s27, 1, s55
  s_lshl_b32 s29, s54, 2
  v_mov_b32 v4, s29
  v_mov_b32 v5, s27
  global_atomic_or v250, v4, v5, s[92:93] sc0
  s_mov_b64 exec, -1
CL_ISSUED:
  s_and_b32 s24, s2, 7
  s_cmp_lg_u32 s24, 1
  s_cbranch_scc1 NO_LN
  s_lshr_b32 s28, s2, 3
  s_cmp_ge_u32 s28, 16
  s_cbranch_scc1 NO_LN
  s_mov_b32 s45, 0
LN_GO:
  s_mov_b32 s8, s72
  s_mov_b32 s9, s73
  s_mov_b32 s10, 2359296
  s_mov_b32 s11, 0x20000
  v_and_b32 v1, 63, v0
  v_lshrrev_b32 v2, 3, v1
  v_and_b32 v3, 7, v1
  s_lshl_b32 s24, s28, 2
  s_add_u32 s24, s24, s13
  s_lshl_b32 s24, s24, 3
  s_mul_i32 s25, s24, 1152
  v_mul_u32_u24 v4, 1152, v2
  v_lshl_add_u32 v4, v3, 4, v4
  buffer_load_dwordx4 v[8:11], v4, s[8:11], s25 offen offset:0
  buffer_load_dwordx4 v[12:15], v4, s[8:11], s25 offen offset:128
  buffer_load_dwordx4 v[16:19], v4, s[8:11], s25 offen offset:256
  buffer_load_dwordx4 v[20:23], v4, s[8:11], s25 offen offset:384
  buffer_load_dwordx4 v[24:27], v4, s[8:11], s25 offen offset:512
  buffer_load_dwordx4 v[28:31], v4, s[8:11], s25 offen offset:640
  buffer_load_dwordx4 v[32:35], v4, s[8:11], s25 offen offset:768
  buffer_load_dwordx4 v[36:39], v4, s[8:11], s25 offen offset:896
  buffer_load_dwordx4 v[40:43], v4, s[8:11], s25 offen offset:1024
  s_lshr_b32 s26, s24, 5
  s_mul_i32 s26, s26, 36864
  s_and_b32 s27, s24, 31
  s_lshl_b32 s27, s27, 4
  s_add_u32 s26, s26, s27
  s_add_u32 s26, s26, 2097152
  v_lshrrev_b32 v5, 1, v3
  v_lshlrev_b32 v5, 10, v5
  v_and_b32 v6, 1, v3
  v_lshl_add_u32 v5, v6, 9, v5
  v_lshl_add_u32 v5, v2, 4, v5
  s_waitcnt vmcnt(8)
  v_lshlrev_b32 v48, 16, v8
  v_and_b32 v49, 0xffff0000, v8
  v_lshlrev_b32 v50, 16, v9
  v_and_b32 v51, 0xffff0000, v9
  v_lshlrev_b32 v52, 16, v10
  v_and_b32 v53, 0xffff0000, v10
  v_lshlrev_b32 v54, 16, v11
  v_and_b32 v55, 0xffff0000, v11
  s_waitcnt vmcnt(7)
  v_lshlrev_b32 v56, 16, v12
  v_and_b32 v57, 0xffff0000, v12
  v_lshlrev_b32 v58, 16, v13
  v_and_b32 v59, 0xffff0000, v13
  v_lshlrev_b32 v60, 16, v14
  v_and_b32 v61, 0xffff0000, v14
  v_lshlrev_b32 v62, 16, v15
  v_and_b32 v63, 0xffff0000, v15
  s_waitcnt vmcnt(6)
  v_lshlrev_b32 v64, 16, v16
  v_and_b32 v65, 0xffff0000, v16
  v_lshlrev_b32 v66, 16, v17
  v_and_b32 v67, 0xffff0000, v17
  v_lshlrev_b32 v68, 16, v18
  v_and_b32 v69, 0xffff0000, v18
  v_lshlrev_b32 v70, 16, v19
  v_and_b32 v71, 0xffff0000, v19
  s_waitcnt vmcnt(5)
  v_lshlrev_b32 v72, 16, v20
  v_and_b32 v73, 0xffff0000, v20
  v_lshlrev_b32 v74, 16, v21
  v_and_b32 v75, 0xffff0000, v21
  v_lshlrev_b32 v76, 16, v22
  v_and_b32 v77, 0xffff0000, v22
  v_lshlrev_b32 v78, 16, v23
  v_and_b32 v79, 0xffff0000, v23
  s_waitcnt vmcnt(4)
  v_lshlrev_b32 v80, 16, v24
  v_and_b32 v81, 0xffff0000, v24
  v_lshlrev_b32 v82, 16, v25
  v_and_b32 v83, 0xffff0000, v25
  v_lshlrev_b32 v84, 16, v26
  v_and_b32 v85, 0xffff0000, v26
  v_lshlrev_b32 v86, 16, v27
  v_and_b32 v87, 0xffff0000, v27
  s_waitcnt vmcnt(3)
  v_lshlrev_b32 v88, 16, v28
  v_and_b32 v89, 0xffff0000, v28
  v_lshlrev_b32 v90, 16, v29
  v_and_b32 v91, 0xffff0000, v29
  v_lshlrev_b32 v92, 16, v30
  v_and_b32 v93, 0xffff0000, v30
  v_lshlrev_b32 v94, 16, v31
  v_and_b32 v95, 0xffff0000, v31
  s_waitcnt vmcnt(2)
  v_lshlrev_b32 v96, 16, v32
  v_and_b32 v97, 0xffff0000, v32
  v_lshlrev_b32 v98, 16, v33
  v_and_b32 v99, 0xffff0000, v33
  v_lshlrev_b32 v100, 16, v34
  v_and_b32 v101, 0xffff0000, v34
  v_lshlrev_b32 v102, 16, v35
  v_and_b32 v103, 0xffff0000, v35
  s_waitcnt vmcnt(1)
  v_lshlrev_b32 v104, 16, v36
  v_and_b32 v105, 0xffff0000, v36
  v_lshlrev_b32 v106, 16, v37
  v_and_b32 v107, 0xffff0000, v37
  v_lshlrev_b32 v108, 16, v38
  v_and_b32 v109, 0xffff0000, v38
  v_lshlrev_b32 v110, 16, v39
  v_and_b32 v111, 0xffff0000, v39
  s_waitcnt vmcnt(0)
  v_lshlrev_b32 v112, 16, v40
  v_and_b32 v113, 0xffff0000, v40
  v_lshlrev_b32 v114, 16, v41
  v_and_b32 v115, 0xffff0000, v41
  v_lshlrev_b32 v116, 16, v42
  v_and_b32 v117, 0xffff0000, v42
  v_lshlrev_b32 v118, 16, v43
  v_and_b32 v119, 0xffff0000, v43
  v_pk_add_f32 v[120:121], v[48:49], v[50:51]
  v_pk_add_f32 v[120:121], v[120:121], v[52:53]
  v_pk_add_f32 v[120:121], v[120:121], v[54:55]
  v_pk_add_f32 v[120:121], v[120:121], v[56:57]
  v_pk_add_f32 v[120:121], v[120:121], v[58:59]
  v_pk_add_f32 v[120:121], v[120:121], v[60:61]
  v_pk_add_f32 v[120:121], v[120:121], v[62:63]
  v_pk_add_f32 v[120:121], v[120:121], v[64:65]
  v_pk_add_f32 v[120:121], v[120:121], v[66:67]
  v_pk_add_f32 v[120:121], v[120:121], v[68:69]
  v_pk_add_f32 v[120:121], v[120:121], v[70:71]
  v_pk_add_f32 v[120:121], v[120:121], v[72:73]
  v_pk_add_f32 v[120:121], v[120:121], v[74:75]
  v_pk_add_f32 v[120:121], v[120:121], v[76:77]
  v_pk_add_f32 v[120:121], v[120:121], v[78:79]
  v_pk_add_f32 v[120:121], v[120:121], v[80:81]
  v_pk_add_f32 v[120:121], v[120:121], v[82:83]
  v_pk_add_f32 v[120:121], v[120:121], v[84:85]
  v_pk_add_f32 v[120:121], v[120:121], v[86:87]
  v_pk_add_f32 v[120:121], v[120:121], v[88:89]
  v_pk_add_f32 v[120:121], v[120:121], v[90:91]
  v_pk_add_f32 v[120:121], v[120:121], v[92:93]
  v_pk_add_f32 v[120:121], v[120:121], v[94:95]
  v_pk_add_f32 v[120:121], v[120:121], v[96:97]
  v_pk_add_f32 v[120:121], v[120:121], v[98:99]
  v_pk_add_f32 v[120:121], v[120:121], v[100:101]
  v_pk_add_f32 v[120:121], v[120:121], v[102:103]
  v_pk_add_f32 v[120:121], v[120:121], v[104:105]
  v_pk_add_f32 v[120:121], v[120:121], v[106:107]
  v_pk_add_f32 v[120:121], v[120:121], v[108:109]
  v_pk_add_f32 v[120:121], v[120:121], v[110:111]
  v_pk_add_f32 v[120:121], v[120:121], v[112:113]
  v_pk_add_f32 v[120:121], v[120:121], v[114:115]
  v_pk_add_f32 v[120:121], v[120:121], v[116:117]
  v_pk_add_f32 v[120:121], v[120:121], v[118:119]
  v_add_f32 v120, v120, v121
  s_nop 1
  v_add_f32_dpp v120, v120, v120 quad_perm:[1,0,3,2] row_mask:0xf bank_mask:0xf
  s_nop 1
  v_add_f32_dpp v120, v120, v120 quad_perm:[2,3,0,1] row_mask:0xf bank_mask:0xf
  s_nop 1
  v_add_f32_dpp v120, v120, v120 row_half_mirror row_mask:0xf bank_mask:0xf
  v_mul_f32 v120, 0x3ae38e39, v120
  v_mov_b32 v121, v120
  v_mov_b64 v[122:123], 0
  v_pk_add_f32 v[124:125], v[48:49], v[120:121] neg_lo:[0,1] neg_hi:[0,1]
  v_pk_fma_f32 v[122:123], v[124:125], v[124:125], v[122:123]
  v_pk_add_f32 v[124:125], v[50:51], v[120:121] neg_lo:[0,1] neg_hi:[0,1]
  v_pk_fma_f32 v[122:123], v[124:125], v[124:125], v[122:123]
  v_pk_add_f32 v[124:125], v[52:53], v[120:121] neg_lo:[0,1] neg_hi:[0,1]
  v_pk_fma_f32 v[122:123], v[124:125], v[124:125], v[122:123]
  v_pk_add_f32 v[124:125], v[54:55], v[120:121] neg_lo:[0,1] neg_hi:[0,1]
  v_pk_fma_f32 v[122:123], v[124:125], v[124:125], v[122:123]
  v_pk_add_f32 v[124:125], v[56:57], v[120:121] neg_lo:[0,1] neg_hi:[0,1]
  v_pk_fma_f32 v[122:123], v[124:125], v[124:125], v[122:123]
  v_pk_add_f32 v[124:125], v[58:59], v[120:121] neg_lo:[0,1] neg_hi:[0,1]
  v_pk_fma_f32 v[122:123], v[124:125], v[124:125], v[122:123]
  v_pk_add_f32 v[124:125], v[60:61], v[120:121] neg_lo:[0,1] neg_hi:[0,1]
  v_pk_fma_f32 v[122:123], v[124:125], v[124:125], v[122:123]
  v_pk_add_f32 v[124:125], v[62:63], v[120:121] neg_lo:[0,1] neg_hi:[0,1]
  v_pk_fma_f32 v[122:123], v[124:125], v[124:125], v[122:123]
  v_pk_add_f32 v[124:125], v[64:65], v[120:121] neg_lo:[0,1] neg_hi:[0,1]
  v_pk_fma_f32 v[122:123], v[124:125], v[124:125], v[122:123]
  v_pk_add_f32 v[124:125], v[66:67], v[120:121] neg_lo:[0,1] neg_hi:[0,1]
  v_pk_fma_f32 v[122:123], v[124:125], v[124:125], v[122:123]
  v_pk_add_f32 v[124:125], v[68:69], v[120:121] neg_lo:[0,1] neg_hi:[0,1]
  v_pk_fma_f32 v[122:123], v[124:125], v[124:125], v[122:123]
  v_pk_add_f32 v[124:125], v[70:71], v[120:121] neg_lo:[0,1] neg_hi:[0,1]
  v_pk_fma_f32 v[122:123], v[124:125], v[124:125], v[122:123]
  v_pk_add_f32 v[124:125], v[72:73], v[120:121] neg_lo:[0,1] neg_hi:[0,1]
  v_pk_fma_f32 v[122:123], v[124:125], v[124:125], v[122:123]
  v_pk_add_f32 v[124:125], v[74:75], v[120:121] neg_lo:[0,1] neg_hi:[0,1]
  v_pk_fma_f32 v[122:123], v[124:125], v[124:125], v[122:123]
  v_pk_add_f32 v[124:125], v[76:77], v[120:121] neg_lo:[0,1] neg_hi:[0,1]
  v_pk_fma_f32 v[122:123], v[124:125], v[124:125], v[122:123]
  v_pk_add_f32 v[124:125], v[78:79], v[120:121] neg_lo:[0,1] neg_hi:[0,1]
  v_pk_fma_f32 v[122:123], v[124:125], v[124:125], v[122:123]
  v_pk_add_f32 v[124:125], v[80:81], v[120:121] neg_lo:[0,1] neg_hi:[0,1]
  v_pk_fma_f32 v[122:123], v[124:125], v[124:125], v[122:123]
  v_pk_add_f32 v[124:125], v[82:83], v[120:121] neg_lo:[0,1] neg_hi:[0,1]
  v_pk_fma_f32 v[122:123], v[124:125], v[124:125], v[122:123]
  v_pk_add_f32 v[124:125], v[84:85], v[120:121] neg_lo:[0,1] neg_hi:[0,1]
  v_pk_fma_f32 v[122:123], v[124:125], v[124:125], v[122:123]
  v_pk_add_f32 v[124:125], v[86:87], v[120:121] neg_lo:[0,1] neg_hi:[0,1]
  v_pk_fma_f32 v[122:123], v[124:125], v[124:125], v[122:123]
  v_pk_add_f32 v[124:125], v[88:89], v[120:121] neg_lo:[0,1] neg_hi:[0,1]
  v_pk_fma_f32 v[122:123], v[124:125], v[124:125], v[122:123]
  v_pk_add_f32 v[124:125], v[90:91], v[120:121] neg_lo:[0,1] neg_hi:[0,1]
  v_pk_fma_f32 v[122:123], v[124:125], v[124:125], v[122:123]
  v_pk_add_f32 v[124:125], v[92:93], v[120:121] neg_lo:[0,1] neg_hi:[0,1]
  v_pk_fma_f32 v[122:123], v[124:125], v[124:125], v[122:123]
  v_pk_add_f32 v[124:125], v[94:95], v[120:121] neg_lo:[0,1] neg_hi:[0,1]
  v_pk_fma_f32 v[122:123], v[124:125], v[124:125], v[122:123]
  v_pk_add_f32 v[124:125], v[96:97], v[120:121] neg_lo:[0,1] neg_hi:[0,1]
  v_pk_fma_f32 v[122:123], v[124:125], v[124:125], v[122:123]
  v_pk_add_f32 v[124:125], v[98:99], v[120:121] neg_lo:[0,1] neg_hi:[0,1]
  v_pk_fma_f32 v[122:123], v[124:125], v[124:125], v[122:123]
  v_pk_add_f32 v[124:125], v[100:101], v[120:121] neg_lo:[0,1] neg_hi:[0,1]
  v_pk_fma_f32 v[122:123], v[124:125], v[124:125], v[122:123]
  v_pk_add_f32 v[124:125], v[102:103], v[120:121] neg_lo:[0,1] neg_hi:[0,1]
  v_pk_fma_f32 v[122:123], v[124:125], v[124:125], v[122:123]
  v_pk_add_f32 v[124:125], v[104:105], v[120:121] neg_lo:[0,1] neg_hi:[0,1]
  v_pk_fma_f32 v[122:123], v[124:125], v[124:125], v[122:123]
  v_pk_add_f32 v[124:125], v[106:107], v[120:121] neg_lo:[0,1] neg_hi:[0,1]
  v_pk_fma_f32 v[122:123], v[124:125], v[124:125], v[122:123]
  v_pk_add_f32 v[124:125], v[108:109], v[120:121] neg_lo:[0,1] neg_hi:[0,1]
  v_pk_fma_f32 v[122:123], v[124:125], v[124:125], v[122:123]
  v_pk_add_f32 v[124:125], v[110:111], v[120:121] neg_lo:[0,1] neg_hi:[0,1]
  v_pk_fma_f32 v[122:123], v[124:125], v[124:125], v[122:123]
  v_pk_add_f32 v[124:125], v[112:113], v[120:121] neg_lo:[0,1] neg_hi:[0,1]
  v_pk_fma_f32 v[122:123], v[124:125], v[124:125], v[122:123]
  v_pk_add_f32 v[124:125], v[114:115], v[120:121] neg_lo:[0,1] neg_hi:[0,1]
  v_pk_fma_f32 v[122:123], v[124:125], v[124:125], v[122:123]
  v_pk_add_f32 v[124:125], v[116:117], v[120:121] neg_lo:[0,1] neg_hi:[0,1]
  v_pk_fma_f32 v[122:123], v[124:125], v[124:125], v[122:123]
  v_pk_add_f32 v[124:125], v[118:119], v[120:121] neg_lo:[0,1] neg_hi:[0,1]
  v_pk_fma_f32 v[122:123], v[124:125], v[124:125], v[122:123]
  v_add_f32 v122, v122, v123
  s_nop 1
  v_add_f32_dpp v122, v122, v122 quad_perm:[1,0,3,2] row_mask:0xf bank_mask:0xf
  s_nop 1
  v_add_f32_dpp v122, v122, v122 quad_perm:[2,3,0,1] row_mask:0xf bank_mask:0xf
  s_nop 1
  v_add_f32_dpp v122, v122, v122 row_half_mirror row_mask:0xf bank_mask:0xf
  v_mul_f32 v122, 0x3ae38e39, v122
  v_cvt_pk_bf16_f32 v122, v122, v122
  v_lshlrev_b32 v122, 16, v122
  v_add_f32 v122, 0x3727c5ac, v122
  v_cvt_pk_bf16_f32 v122, v122, v122
  v_lshlrev_b32 v122, 16, v122
  v_sqrt_f32 v122, v122
  s_nop 0
  v_cvt_pk_bf16_f32 v122, v122, v122
  v_lshlrev_b32 v122, 16, v122
  v_rcp_f32 v122, v122
  v_cvt_pk_bf16_f32 v120, v120, v120
  v_lshlrev_b32 v120, 16, v120
  v_mov_b32 v121, v120
  v_mov_b32 v123, v122
  v_pk_add_f32 v[48:49], v[48:49], v[120:121] neg_lo:[0,1] neg_hi:[0,1]
  v_cvt_pk_bf16_f32 v8, v48, v49
  v_lshlrev_b32 v48, 16, v8
  v_and_b32 v49, 0xffff0000, v8
  v_pk_mul_f32 v[48:49], v[48:49], v[122:123]
  v_cvt_pk_bf16_f32 v8, v48, v49
  v_pk_add_f32 v[50:51], v[50:51], v[120:121] neg_lo:[0,1] neg_hi:[0,1]
  v_cvt_pk_bf16_f32 v9, v50, v51
  v_lshlrev_b32 v50, 16, v9
  v_and_b32 v51, 0xffff0000, v9
  v_pk_mul_f32 v[50:51], v[50:51], v[122:123]
  v_cvt_pk_bf16_f32 v9, v50, v51
  v_pk_add_f32 v[52:53], v[52:53], v[120:121] neg_lo:[0,1] neg_hi:[0,1]
  v_cvt_pk_bf16_f32 v10, v52, v53
  v_lshlrev_b32 v52, 16, v10
  v_and_b32 v53, 0xffff0000, v10
  v_pk_mul_f32 v[52:53], v[52:53], v[122:123]
  v_cvt_pk_bf16_f32 v10, v52, v53
  v_pk_add_f32 v[54:55], v[54:55], v[120:121] neg_lo:[0,1] neg_hi:[0,1]
  v_cvt_pk_bf16_f32 v11, v54, v55
  v_lshlrev_b32 v54, 16, v11
  v_and_b32 v55, 0xffff0000, v11
  v_pk_mul_f32 v[54:55], v[54:55], v[122:123]
  v_cvt_pk_bf16_f32 v11, v54, v55
  buffer_store_dwordx4 v[8:11], v5, s[4:7], s26 offen sc1
  s_add_u32 s26, s26, 4096
  v_pk_add_f32 v[56:57], v[56:57], v[120:121] neg_lo:[0,1] neg_hi:[0,1]
  v_cvt_pk_bf16_f32 v12, v56, v57
  v_lshlrev_b32 v56, 16, v12
  v_and_b32 v57, 0xffff0000, v12
  v_pk_mul_f32 v[56:57], v[56:57], v[122:123]
  v_cvt_pk_bf16_f32 v12, v56, v57
  v_pk_add_f32 v[58:59], v[58:59], v[120:121] neg_lo:[0,1] neg_hi:[0,1]
  v_cvt_pk_bf16_f32 v13, v58, v59
  v_lshlrev_b32 v58, 16, v13
  v_and_b32 v59, 0xffff0000, v13
  v_pk_mul_f32 v[58:59], v[58:59], v[122:123]
  v_cvt_pk_bf16_f32 v13, v58, v59
  v_pk_add_f32 v[60:61], v[60:61], v[120:121] neg_lo:[0,1] neg_hi:[0,1]
  v_cvt_pk_bf16_f32 v14, v60, v61
  v_lshlrev_b32 v60, 16, v14
  v_and_b32 v61, 0xffff0000, v14
  v_pk_mul_f32 v[60:61], v[60:61], v[122:123]
  v_cvt_pk_bf16_f32 v14, v60, v61
  v_pk_add_f32 v[62:63], v[62:63], v[120:121] neg_lo:[0,1] neg_hi:[0,1]
  v_cvt_pk_bf16_f32 v15, v62, v63
  v_lshlrev_b32 v62, 16, v15
  v_and_b32 v63, 0xffff0000, v15
  v_pk_mul_f32 v[62:63], v[62:63], v[122:123]
  v_cvt_pk_bf16_f32 v15, v62, v63
  buffer_store_dwordx4 v[12:15], v5, s[4:7], s26 offen sc1
  s_add_u32 s26, s26, 4096
  v_pk_add_f32 v[64:65], v[64:65], v[120:121] neg_lo:[0,1] neg_hi:[0,1]
  v_cvt_pk_bf16_f32 v16, v64, v65
  v_lshlrev_b32 v64, 16, v16
  v_and_b32 v65, 0xffff0000, v16
  v_pk_mul_f32 v[64:65], v[64:65], v[122:123]
  v_cvt_pk_bf16_f32 v16, v64, v65
  v_pk_add_f32 v[66:67], v[66:67], v[120:121] neg_lo:[0,1] neg_hi:[0,1]
  v_cvt_pk_bf16_f32 v17, v66, v67
  v_lshlrev_b32 v66, 16, v17
  v_and_b32 v67, 0xffff0000, v17
  v_pk_mul_f32 v[66:67], v[66:67], v[122:123]
  v_cvt_pk_bf16_f32 v17, v66, v67
  v_pk_add_f32 v[68:69], v[68:69], v[120:121] neg_lo:[0,1] neg_hi:[0,1]
  v_cvt_pk_bf16_f32 v18, v68, v69
  v_lshlrev_b32 v68, 16, v18
  v_and_b32 v69, 0xffff0000, v18
  v_pk_mul_f32 v[68:69], v[68:69], v[122:123]
  v_cvt_pk_bf16_f32 v18, v68, v69
  v_pk_add_f32 v[70:71], v[70:71], v[120:121] neg_lo:[0,1] neg_hi:[0,1]
  v_cvt_pk_bf16_f32 v19, v70, v71
  v_lshlrev_b32 v70, 16, v19
  v_and_b32 v71, 0xffff0000, v19
  v_pk_mul_f32 v[70:71], v[70:71], v[122:123]
  v_cvt_pk_bf16_f32 v19, v70, v71
  buffer_store_dwordx4 v[16:19], v5, s[4:7], s26 offen sc1
  s_add_u32 s26, s26, 4096
  v_pk_add_f32 v[72:73], v[72:73], v[120:121] neg_lo:[0,1] neg_hi:[0,1]
  v_cvt_pk_bf16_f32 v20, v72, v73
  v_lshlrev_b32 v72, 16, v20
  v_and_b32 v73, 0xffff0000, v20
  v_pk_mul_f32 v[72:73], v[72:73], v[122:123]
  v_cvt_pk_bf16_f32 v20, v72, v73
  v_pk_add_f32 v[74:75], v[74:75], v[120:121] neg_lo:[0,1] neg_hi:[0,1]
  v_cvt_pk_bf16_f32 v21, v74, v75
  v_lshlrev_b32 v74, 16, v21
  v_and_b32 v75, 0xffff0000, v21
  v_pk_mul_f32 v[74:75], v[74:75], v[122:123]
  v_cvt_pk_bf16_f32 v21, v74, v75
  v_pk_add_f32 v[76:77], v[76:77], v[120:121] neg_lo:[0,1] neg_hi:[0,1]
  v_cvt_pk_bf16_f32 v22, v76, v77
  v_lshlrev_b32 v76, 16, v22
  v_and_b32 v77, 0xffff0000, v22
  v_pk_mul_f32 v[76:77], v[76:77], v[122:123]
  v_cvt_pk_bf16_f32 v22, v76, v77
  v_pk_add_f32 v[78:79], v[78:79], v[120:121] neg_lo:[0,1] neg_hi:[0,1]
  v_cvt_pk_bf16_f32 v23, v78, v79
  v_lshlrev_b32 v78, 16, v23
  v_and_b32 v79, 0xffff0000, v23
  v_pk_mul_f32 v[78:79], v[78:79], v[122:123]
  v_cvt_pk_bf16_f32 v23, v78, v79
  buffer_store_dwordx4 v[20:23], v5, s[4:7], s26 offen sc1
  s_add_u32 s26, s26, 4096
  v_pk_add_f32 v[80:81], v[80:81], v[120:121] neg_lo:[0,1] neg_hi:[0,1]
  v_cvt_pk_bf16_f32 v24, v80, v81
  v_lshlrev_b32 v80, 16, v24
  v_and_b32 v81, 0xffff0000, v24
  v_pk_mul_f32 v[80:81], v[80:81], v[122:123]
  v_cvt_pk_bf16_f32 v24, v80, v81
  v_pk_add_f32 v[82:83], v[82:83], v[120:121] neg_lo:[0,1] neg_hi:[0,1]
  v_cvt_pk_bf16_f32 v25, v82, v83
  v_lshlrev_b32 v82, 16, v25
  v_and_b32 v83, 0xffff0000, v25
  v_pk_mul_f32 v[82:83], v[82:83], v[122:123]
  v_cvt_pk_bf16_f32 v25, v82, v83
  v_pk_add_f32 v[84:85], v[84:85], v[120:121] neg_lo:[0,1] neg_hi:[0,1]
  v_cvt_pk_bf16_f32 v26, v84, v85
  v_lshlrev_b32 v84, 16, v26
  v_and_b32 v85, 0xffff0000, v26
  v_pk_mul_f32 v[84:85], v[84:85], v[122:123]
  v_cvt_pk_bf16_f32 v26, v84, v85
  v_pk_add_f32 v[86:87], v[86:87], v[120:121] neg_lo:[0,1] neg_hi:[0,1]
  v_cvt_pk_bf16_f32 v27, v86, v87
  v_lshlrev_b32 v86, 16, v27
  v_and_b32 v87, 0xffff0000, v27
  v_pk_mul_f32 v[86:87], v[86:87], v[122:123]
  v_cvt_pk_bf16_f32 v27, v86, v87
  buffer_store_dwordx4 v[24:27], v5, s[4:7], s26 offen sc1
  s_add_u32 s26, s26, 4096
  v_pk_add_f32 v[88:89], v[88:89], v[120:121] neg_lo:[0,1] neg_hi:[0,1]
  v_cvt_pk_bf16_f32 v28, v88, v89
  v_lshlrev_b32 v88, 16, v28
  v_and_b32 v89, 0xffff0000, v28
  v_pk_mul_f32 v[88:89], v[88:89], v[122:123]
  v_cvt_pk_bf16_f32 v28, v88, v89
  v_pk_add_f32 v[90:91], v[90:91], v[120:121] neg_lo:[0,1] neg_hi:[0,1]
  v_cvt_pk_bf16_f32 v29, v90, v91
  v_lshlrev_b32 v90, 16, v29
  v_and_b32 v91, 0xffff0000, v29
  v_pk_mul_f32 v[90:91], v[90:91], v[122:123]
  v_cvt_pk_bf16_f32 v29, v90, v91
  v_pk_add_f32 v[92:93], v[92:93], v[120:121] neg_lo:[0,1] neg_hi:[0,1]
  v_cvt_pk_bf16_f32 v30, v92, v93
  v_lshlrev_b32 v92, 16, v30
  v_and_b32 v93, 0xffff0000, v30
  v_pk_mul_f32 v[92:93], v[92:93], v[122:123]
  v_cvt_pk_bf16_f32 v30, v92, v93
  v_pk_add_f32 v[94:95], v[94:95], v[120:121] neg_lo:[0,1] neg_hi:[0,1]
  v_cvt_pk_bf16_f32 v31, v94, v95
  v_lshlrev_b32 v94, 16, v31
  v_and_b32 v95, 0xffff0000, v31
  v_pk_mul_f32 v[94:95], v[94:95], v[122:123]
  v_cvt_pk_bf16_f32 v31, v94, v95
  buffer_store_dwordx4 v[28:31], v5, s[4:7], s26 offen sc1
  s_add_u32 s26, s26, 4096
  v_pk_add_f32 v[96:97], v[96:97], v[120:121] neg_lo:[0,1] neg_hi:[0,1]
  v_cvt_pk_bf16_f32 v32, v96, v97
  v_lshlrev_b32 v96, 16, v32
  v_and_b32 v97, 0xffff0000, v32
  v_pk_mul_f32 v[96:97], v[96:97], v[122:123]
  v_cvt_pk_bf16_f32 v32, v96, v97
  v_pk_add_f32 v[98:99], v[98:99], v[120:121] neg_lo:[0,1] neg_hi:[0,1]
  v_cvt_pk_bf16_f32 v33, v98, v99
  v_lshlrev_b32 v98, 16, v33
  v_and_b32 v99, 0xffff0000, v33
  v_pk_mul_f32 v[98:99], v[98:99], v[122:123]
  v_cvt_pk_bf16_f32 v33, v98, v99
  v_pk_add_f32 v[100:101], v[100:101], v[120:121] neg_lo:[0,1] neg_hi:[0,1]
  v_cvt_pk_bf16_f32 v34, v100, v101
  v_lshlrev_b32 v100, 16, v34
  v_and_b32 v101, 0xffff0000, v34
  v_pk_mul_f32 v[100:101], v[100:101], v[122:123]
  v_cvt_pk_bf16_f32 v34, v100, v101
  v_pk_add_f32 v[102:103], v[102:103], v[120:121] neg_lo:[0,1] neg_hi:[0,1]
  v_cvt_pk_bf16_f32 v35, v102, v103
  v_lshlrev_b32 v102, 16, v35
  v_and_b32 v103, 0xffff0000, v35
  v_pk_mul_f32 v[102:103], v[102:103], v[122:123]
  v_cvt_pk_bf16_f32 v35, v102, v103
  buffer_store_dwordx4 v[32:35], v5, s[4:7], s26 offen sc1
  s_add_u32 s26, s26, 4096
  v_pk_add_f32 v[104:105], v[104:105], v[120:121] neg_lo:[0,1] neg_hi:[0,1]
  v_cvt_pk_bf16_f32 v36, v104, v105
  v_lshlrev_b32 v104, 16, v36
  v_and_b32 v105, 0xffff0000, v36
  v_pk_mul_f32 v[104:105], v[104:105], v[122:123]
  v_cvt_pk_bf16_f32 v36, v104, v105
  v_pk_add_f32 v[106:107], v[106:107], v[120:121] neg_lo:[0,1] neg_hi:[0,1]
  v_cvt_pk_bf16_f32 v37, v106, v107
  v_lshlrev_b32 v106, 16, v37
  v_and_b32 v107, 0xffff0000, v37
  v_pk_mul_f32 v[106:107], v[106:107], v[122:123]
  v_cvt_pk_bf16_f32 v37, v106, v107
  v_pk_add_f32 v[108:109], v[108:109], v[120:121] neg_lo:[0,1] neg_hi:[0,1]
  v_cvt_pk_bf16_f32 v38, v108, v109
  v_lshlrev_b32 v108, 16, v38
  v_and_b32 v109, 0xffff0000, v38
  v_pk_mul_f32 v[108:109], v[108:109], v[122:123]
  v_cvt_pk_bf16_f32 v38, v108, v109
  v_pk_add_f32 v[110:111], v[110:111], v[120:121] neg_lo:[0,1] neg_hi:[0,1]
  v_cvt_pk_bf16_f32 v39, v110, v111
  v_lshlrev_b32 v110, 16, v39
  v_and_b32 v111, 0xffff0000, v39
  v_pk_mul_f32 v[110:111], v[110:111], v[122:123]
  v_cvt_pk_bf16_f32 v39, v110, v111
  buffer_store_dwordx4 v[36:39], v5, s[4:7], s26 offen sc1
  s_add_u32 s26, s26, 4096
  v_pk_add_f32 v[112:113], v[112:113], v[120:121] neg_lo:[0,1] neg_hi:[0,1]
  v_cvt_pk_bf16_f32 v40, v112, v113
  v_lshlrev_b32 v112, 16, v40
  v_and_b32 v113, 0xffff0000, v40
  v_pk_mul_f32 v[112:113], v[112:113], v[122:123]
  v_cvt_pk_bf16_f32 v40, v112, v113
  v_pk_add_f32 v[114:115], v[114:115], v[120:121] neg_lo:[0,1] neg_hi:[0,1]
  v_cvt_pk_bf16_f32 v41, v114, v115
  v_lshlrev_b32 v114, 16, v41
  v_and_b32 v115, 0xffff0000, v41
  v_pk_mul_f32 v[114:115], v[114:115], v[122:123]
  v_cvt_pk_bf16_f32 v41, v114, v115
  v_pk_add_f32 v[116:117], v[116:117], v[120:121] neg_lo:[0,1] neg_hi:[0,1]
  v_cvt_pk_bf16_f32 v42, v116, v117
  v_lshlrev_b32 v116, 16, v42
  v_and_b32 v117, 0xffff0000, v42
  v_pk_mul_f32 v[116:117], v[116:117], v[122:123]
  v_cvt_pk_bf16_f32 v42, v116, v117
  v_pk_add_f32 v[118:119], v[118:119], v[120:121] neg_lo:[0,1] neg_hi:[0,1]
  v_cvt_pk_bf16_f32 v43, v118, v119
  v_lshlrev_b32 v118, 16, v43
  v_and_b32 v119, 0xffff0000, v43
  v_pk_mul_f32 v[118:119], v[118:119], v[122:123]
  v_cvt_pk_bf16_f32 v43, v118, v119
  buffer_store_dwordx4 v[40:43], v5, s[4:7], s26 offen sc1
  s_add_u32 s26, s26, 4096
  s_waitcnt vmcnt(0)
  s_barrier
  s_lshr_b32 s28, s28, 3
  s_cmp_lg_u32 s13, 0
  s_cbranch_scc1 SIG_1
  s_lshl_b32 s29, s28, 2
  s_add_u32 s29, s29, 64
  v_mov_b32 v4, s29
  v_mov_b32 v5, 1
  s_mov_b64 exec, 1
  global_atomic_add v4, v5, s[92:93]
  s_mov_b64 exec, -1
SIG_1:
  s_cmp_eq_u32 s45, 1
  s_cbranch_scc1 LN_RET1
  s_cmp_eq_u32 s45, 2
  s_cbranch_scc1 LN_RET2
NO_LN:
  s_mov_b32 s52, 1
  s_mov_b32 s12, s55
  s_cmp_eq_u32 s54, 0
  s_cbranch_scc1 R_CHAIN2
  s_cmp_lg_u32 s13, 0
  s_cbranch_scc1 CL_WAITA
  s_mov_b32 s25, s55
  s_mov_b32 s26, s54
  s_mov_b32 s28, 0
  s_lshl_b32 s27, 1, s25
  s_lshr_b32 s53, s2, 2
  s_mov_b64 exec, 1
  s_waitcnt vmcnt(0)
  s_branch CL_CHKA
CL_TRYA:
  s_lshl_b32 s27, 1, s25
  s_lshl_b32 s29, s26, 2
  v_mov_b32 v248, s29
  v_mov_b32 v249, s27
  global_atomic_or v250, v248, v249, s[92:93] sc0
  s_waitcnt vmcnt(0)
CL_CHKA:
  v_readfirstlane_b32 s30, v250
  s_nop 0
  s_and_b32 s31, s30, s27
  s_cbranch_scc0 CL_GOTA
  s_not_b32 s31, s30
  s_cbranch_scc0 CL_FULLA
  s_mul_i32 s53, s53, 13
  s_add_u32 s53, s53, s2
  s_add_u32 s53, s53, 7
  s_and_b32 s29, s53, 31
  s_mov_b32 s30, s31
  s_lshr_b64 s[30:31], s[30:31], s29
  s_ff1_i32_b32 s25, s30
  s_add_u32 s25, s25, s29
  s_and_b32 s25, s25, 31
  s_branch CL_TRYA
CL_FULLA:
  s_add_u32 s28, s28, 1
  s_sub_u32 s26, 8, s28
  s_cmp_gt_u32 s28, 8
  s_cbranch_scc1 CL_NONEA
  s_mov_b32 s25, 0
  s_cmp_lg_u32 s26, 0
  s_cbranch_scc1 CL_TRYA
  v_mov_b32 v248, 48
  v_mov_b32 v249, 1
  global_atomic_or v250, v248, v249, s[92:93] sc0
  s_waitcnt vmcnt(0)
  s_branch CL_TRYA
CL_NONEA:
  s_mov_b32 s26, 8
  s_mov_b32 s25, 0
CL_GOTA:
  s_lshl_b32 s26, s26, 5
  s_add_u32 s26, s26, s25
  v_mov_b32 v248, 0
  v_mov_b32 v249, s26
  ds_write_b32 v248, v249
  s_waitcnt lgkmcnt(0)
  s_mov_b64 exec, -1
CL_WAITA:
  s_barrier
  v_mov_b32 v248, 0
  ds_read_b32 v249, v248
  s_waitcnt lgkmcnt(0)
  v_readfirstlane_b32 s26, v249
  s_barrier
ROLE:
  s_lshr_b32 s24, s26, 5
  s_and_b32 s28, s26, 31
  s_cmp_ge_u32 s24, 8
  s_cbranch_scc1 K_END
  s_cmp_eq_u32 s24, 0
  s_cbranch_scc1 R_CHAIN
  s_cmp_eq_u32 s24, 1
  s_cbranch_scc1 R_AO
  s_sub_u32 s12, s24, 2
  s_lshl_b32 s12, s12, 2
  s_lshr_b32 s25, s28, 3
  s_add_u32 s12, s12, s25
  s_and_b32 s14, s28, 7
  v_and_b32 v1, 63, v0
  v_lshlrev_b32 v7, 4, v1
  v_lshrrev_b32 v8, 2, v1
  v_and_b32 v9, 3, v1
  v_lshlrev_b32 v9, 4, v9
  v_lshl_add_u32 v2, v8, 13, v9
  v_mul_u32_u24 v3, 9216, v8
  v_add_u32 v3, v3, v9
  v_lshrrev_b32 v8, 5, v1
  v_bfe_u32 v9, v1, 2, 2
  v_lshl_add_u32 v8, v8, 3, v9
  v_lshlrev_b32 v8, 6, v8
  v_bfe_u32 v9, v1, 4, 1
  v_lshl_add_u32 v8, v9, 5, v8
  v_and_b32 v9, 3, v1
  v_lshl_add_u32 v4, v9, 3, v8
  v_lshrrev_b32 v8, 5, v1
  v_and_b32 v9, 15, v1
  v_lshlrev_b32 v9, 4, v9
  v_lshl_add_u32 v8, v8, 8, v9
  v_bfe_u32 v9, v1, 4, 1
  v_lshl_add_u32 v5, v9, 12, v8
  v_lshl_add_u32 v6, v9, 10, v8
  s_mov_b32 s11, 0x20000
  s_mov_b32 s23, 4718592
  s_mov_b32 s31, 131072
  s_mul_i32 s30, s13, 9216
  s_mov_b32 s32, 0xc0135761
  s_mov_b32 s33, s32
  s_mov_b32 s34, 0xbdd2d3e8
  s_mov_b32 s35, s34
  s_mov_b32 s36, 0x3f800000
  s_mov_b32 s37, s36
  s_mov_b32 s38, 0
  s_mov_b32 s40, 0
  s_mov_b32 s39, 0
  s_lshr_b32 s24, s14, 1
  s_mul_i32 s44, s24, 3
  s_cmp_eq_u32 s24, 3
  s_cselect_b32 s43, 2, 3
  s_sub_u32 s45, 0, s43
  s_add_u32 s48, s43, 16
  s_add_u32 s49, s43, 11
  s_cmp_lt_u32 s14, 2
  s_cselect_b32 s45, 8, s45
  s_cselect_b32 s48, 8, s48
  s_cselect_b32 s49, 99, s49
  s_and_b32 s47, s14, 1
  s_cmp_lt_u32 s38, s43
  s_cselect_b32 s24, s44, s45
  s_add_u32 s24, s24, s38
  s_min_u32 s24, s24, 27
  s_mul_i32 s25, s24, 24
  s_add_u32 s25, s25, s12
  s_lshr_b32 s26, s25, 7
  s_and_b32 s25, s25, 127
  s_lshl_b32 s25, s25, 6
  s_mul_i32 s41, s13, 1179648
  s_add_u32 s41, s41, s25
  s_cmp_eq_u32 s26, 1
  s_cselect_b64 s[8:9], s[80:81], s[78:79]
  s_cmp_eq_u32 s26, 2
  s_cselect_b64 s[8:9], s[76:77], s[8:9]
  s_sub_u32 s25, s24, 16
  s_lshr_b32 s26, s25, 1
  s_mul_i32 s26, s26, 24
  s_add_u32 s26, s26, s12
  s_lshl_b32 s26, s26, 6
  s_mul_i32 s27, s13, 1327104
  s_add_u32 s26, s26, s27
  s_bitcmp1_b32 s25, 0
  s_cselect_b64 s[20:21], s[86:87], s[84:85]
  s_cmp_ge_u32 s24, 16
  s_cselect_b64 s[8:9], s[20:21], s[8:9]
  s_cselect_b32 s41, s26, s41
  s_cselect_b32 s10, 5308416, s23
  s_cselect_b32 s16, 147456, s31
  s_cselect_b64 s[18:19], -1, 0
  v_cndmask_b32 v10, v2, v3, s[18:19]
  s_add_u32 s24, s40, s30
  s_add_u32 m0, s24, 0
  s_nop 0
  buffer_load_dwordx4 v10, s[8:11], s41 offen lds
  s_add_u32 s41, s41, s16
  s_add_u32 m0, s24, 1024
  s_nop 0
  buffer_load_dwordx4 v10, s[8:11], s41 offen lds
  s_add_u32 s41, s41, s16
  s_add_u32 m0, s24, 2048
  s_nop 0
  buffer_load_dwordx4 v10, s[8:11], s41 offen lds
  s_add_u32 s41, s41, s16
  s_add_u32 m0, s24, 3072
  s_nop 0
  buffer_load_dwordx4 v10, s[8:11], s41 offen lds
  s_add_u32 s41, s41, s16
  s_add_u32 m0, s24, 4096
  s_nop 0
  buffer_load_dwordx4 v10, s[8:11], s41 offen lds
  s_add_u32 s41, s41, s16
  s_add_u32 m0, s24, 5120
  s_nop 0
  buffer_load_dwordx4 v10, s[8:11], s41 offen lds
  s_add_u32 s41, s41, s16
  s_add_u32 m0, s24, 6144
  s_nop 0
  buffer_load_dwordx4 v10, s[8:11], s41 offen lds
  s_add_u32 s41, s41, s16
  s_add_u32 m0, s24, 7168
  s_nop 0
  buffer_load_dwordx4 v10, s[8:11], s41 offen lds
  s_add_u32 s41, s41, s16
  s_add_u32 m0, s24, 8192
  s_nop 0
  buffer_load_dwordx4 v10, s[8:11], s41 offen lds
  s_add_u32 s41, s41, s16
  s_add_u32 s38, s38, 1
  s_add_u32 s40, s40, 36864
  s_cmp_eq_u32 s40, 147456
  s_cselect_b32 s40, 0, s40
  s_cmp_lt_u32 s38, s43
  s_cselect_b32 s24, s44, s45
  s_add_u32 s24, s24, s38
  s_min_u32 s24, s24, 27
  s_mul_i32 s25, s24, 24
  s_add_u32 s25, s25, s12
  s_lshr_b32 s26, s25, 7
  s_and_b32 s25, s25, 127
  s_lshl_b32 s25, s25, 6
  s_mul_i32 s41, s13, 1179648
  s_add_u32 s41, s41, s25
  s_cmp_eq_u32 s26, 1
  s_cselect_b64 s[8:9], s[80:81], s[78:79]
  s_cmp_eq_u32 s26, 2
  s_cselect_b64 s[8:9], s[76:77], s[8:9]
  s_sub_u32 s25, s24, 16
  s_lshr_b32 s26, s25, 1
  s_mul_i32 s26, s26, 24
  s_add_u32 s26, s26, s12
  s_lshl_b32 s26, s26, 6
  s_mul_i32 s27, s13, 1327104
  s_add_u32 s26, s26, s27
  s_bitcmp1_b32 s25, 0
  s_cselect_b64 s[20:21], s[86:87], s[84:85]
  s_cmp_ge_u32 s24, 16
  s_cselect_b64 s[8:9], s[20:21], s[8:9]
  s_cselect_b32 s41, s26, s41
  s_cselect_b32 s10, 5308416, s23
  s_cselect_b32 s16, 147456, s31
  s_cselect_b64 s[18:19], -1, 0
  v_cndmask_b32 v10, v2, v3, s[18:19]
  s_add_u32 s24, s40, s30
  s_add_u32 m0, s24, 0
  s_nop 0
  buffer_load_dwordx4 v10, s[8:11], s41 offen lds
  s_add_u32 s41, s41, s16
  s_add_u32 m0, s24, 1024
  s_nop 0
  buffer_load_dwordx4 v10, s[8:11], s41 offen lds
  s_add_u32 s41, s41, s16
  s_add_u32 m0, s24, 2048
  s_nop 0
  buffer_load_dwordx4 v10, s[8:11], s41 offen lds
  s_add_u32 s41, s41, s16
  s_add_u32 m0, s24, 3072
  s_nop 0
  buffer_load_dwordx4 v10, s[8:11], s41 offen lds
  s_add_u32 s41, s41, s16
  s_add_u32 m0, s24, 4096
  s_nop 0
  buffer_load_dwordx4 v10, s[8:11], s41 offen lds
  s_add_u32 s41, s41, s16
  s_add_u32 m0, s24, 5120
  s_nop 0
  buffer_load_dwordx4 v10, s[8:11], s41 offen lds
  s_add_u32 s41, s41, s16
  s_add_u32 m0, s24, 6144
  s_nop 0
  buffer_load_dwordx4 v10, s[8:11], s41 offen lds
  s_add_u32 s41, s41, s16
  s_add_u32 m0, s24, 7168
  s_nop 0
  buffer_load_dwordx4 v10, s[8:11], s41 offen lds
  s_add_u32 s41, s41, s16
  s_add_u32 m0, s24, 8192
  s_nop 0
  buffer_load_dwordx4 v10, s[8:11], s41 offen lds
  s_add_u32 s41, s41, s16
  s_add_u32 s38, s38, 1
  s_add_u32 s40, s40, 36864
  s_cmp_eq_u32 s40, 147456
  s_cselect_b32 s40, 0, s40
  s_cmp_lt_u32 s38, s43
  s_cselect_b32 s24, s44, s45
  s_add_u32 s24, s24, s38
  s_min_u32 s24, s24, 27
  s_mul_i32 s25, s24, 24
  s_add_u32 s25, s25, s12
  s_lshr_b32 s26, s25, 7
  s_and_b32 s25, s25, 127
  s_lshl_b32 s25, s25, 6
  s_mul_i32 s41, s13, 1179648
  s_add_u32 s41, s41, s25
  s_cmp_eq_u32 s26, 1
  s_cselect_b64 s[8:9], s[80:81], s[78:79]
  s_cmp_eq_u32 s26, 2
  s_cselect_b64 s[8:9], s[76:77], s[8:9]
  s_sub_u32 s25, s24, 16
  s_lshr_b32 s26, s25, 1
  s_mul_i32 s26, s26, 24
  s_add_u32 s26, s26, s12
  s_lshl_b32 s26, s26, 6
  s_mul_i32 s27, s13, 1327104
  s_add_u32 s26, s26, s27
  s_bitcmp1_b32 s25, 0
  s_cselect_b64 s[20:21], s[86:87], s[84:85]
  s_cmp_ge_u32 s24, 16
  s_cselect_b64 s[8:9], s[20:21], s[8:9]
  s_cselect_b32 s41, s26, s41
  s_cselect_b32 s10, 5308416, s23
  s_cselect_b32 s16, 147456, s31
  s_cselect_b64 s[18:19], -1, 0
  v_cndmask_b32 v10, v2, v3, s[18:19]
  s_add_u32 s24, s40, s30
  s_add_u32 m0, s24, 0
  s_nop 0
  buffer_load_dwordx4 v10, s[8:11], s41 offen lds
  s_add_u32 s41, s41, s16
  s_add_u32 m0, s24, 1024
  s_nop 0
  buffer_load_dwordx4 v10, s[8:11], s41 offen lds
  s_add_u32 s41, s41, s16
  s_add_u32 m0, s24, 2048
  s_nop 0
  buffer_load_dwordx4 v10, s[8:11], s41 offen lds
  s_add_u32 s41, s41, s16
  s_add_u32 m0, s24, 3072
  s_nop 0
  buffer_load_dwordx4 v10, s[8:11], s41 offen lds
  s_add_u32 s41, s41, s16
  s_add_u32 m0, s24, 4096
  s_nop 0
  buffer_load_dwordx4 v10, s[8:11], s41 offen lds
  s_add_u32 s41, s41, s16
  s_add_u32 m0, s24, 5120
  s_nop 0
  buffer_load_dwordx4 v10, s[8:11], s41 offen lds
  s_add_u32 s41, s41, s16
  s_add_u32 m0, s24, 6144
  s_nop 0
  buffer_load_dwordx4 v10, s[8:11], s41 offen lds
  s_add_u32 s41, s41, s16
  s_add_u32 m0, s24, 7168
  s_nop 0
  buffer_load_dwordx4 v10, s[8:11], s41 offen lds
  s_add_u32 s41, s41, s16
  s_add_u32 m0, s24, 8192
  s_nop 0
  buffer_load_dwordx4 v10, s[8:11], s41 offen lds
  s_add_u32 s41, s41, s16
  s_add_u32 s38, s38, 1
  s_add_u32 s40, s40, 36864
  s_cmp_eq_u32 s40, 147456
  s_cselect_b32 s40, 0, s40
  s_cmp_lg_u32 s13, 0
  s_cbranch_scc1 WFE_4
  s_lshl_b32 s29, s47, 2
  s_add_u32 s29, s29, 64
  v_mov_b32 v8, s29
  s_mov_b64 exec, 1
  s_mov_b32 s42, 0
WF_2:
  global_load_dword v9, v8, s[92:93] sc1
  s_add_u32 s42, s42, 1
  s_cmp_gt_u32 s42, 0x20000
  s_cbranch_scc1 WFD_3
  s_waitcnt vmcnt(0)
  v_cmp_gt_u32 vcc, 8, v9
  s_cbranch_vccz WFD_3
  s_sleep 4
  s_branch WF_2
WFD_3:
  s_waitcnt vmcnt(0)
  s_mov_b64 exec, -1
WFE_4:
  s_barrier
  s_lshl_b32 s24, s47, 3
  s_lshl_b32 s25, s13, 1
  s_add_u32 s24, s24, s25
  s_mul_i32 s24, s24, 36864
  s_add_u32 s24, s24, 2097152
  s_add_u32 s25, s24, 36864
  buffer_load_dwordx4 a[0:3], v7, s[4:7], s24 offen offset:0 sc1
  buffer_load_dwordx4 a[144:147], v7, s[4:7], s25 offen offset:0 sc1
  buffer_load_dwordx4 a[4:7], v7, s[4:7], s24 offen offset:1024 sc1
  buffer_load_dwordx4 a[148:151], v7, s[4:7], s25 offen offset:1024 sc1
  buffer_load_dwordx4 a[8:11], v7, s[4:7], s24 offen offset:2048 sc1
  buffer_load_dwordx4 a[152:155], v7, s[4:7], s25 offen offset:2048 sc1
  buffer_load_dwordx4 a[12:15], v7, s[4:7], s24 offen offset:3072 sc1
  buffer_load_dwordx4 a[156:159], v7, s[4:7], s25 offen offset:3072 sc1
  s_add_u32 s24, s24, 4096
  s_add_u32 s25, s25, 4096
  buffer_load_dwordx4 a[16:19], v7, s[4:7], s24 offen offset:0 sc1
  buffer_load_dwordx4 a[160:163], v7, s[4:7], s25 offen offset:0 sc1
  buffer_load_dwordx4 a[20:23], v7, s[4:7], s24 offen offset:1024 sc1
  buffer_load_dwordx4 a[164:167], v7, s[4:7], s25 offen offset:1024 sc1
  buffer_load_dwordx4 a[24:27], v7, s[4:7], s24 offen offset:2048 sc1
  buffer_load_dwordx4 a[168:171], v7, s[4:7], s25 offen offset:2048 sc1
  buffer_load_dwordx4 a[28:31], v7, s[4:7], s24 offen offset:3072 sc1
  buffer_load_dwordx4 a[172:175], v7, s[4:7], s25 offen offset:3072 sc1
  s_add_u32 s24, s24, 4096
  s_add_u32 s25, s25, 4096
  buffer_load_dwordx4 a[32:35], v7, s[4:7], s24 offen offset:0 sc1
  buffer_load_dwordx4 a[176:179], v7, s[4:7], s25 offen offset:0 sc1
  buffer_load_dwordx4 a[36:39], v7, s[4:7], s24 offen offset:1024 sc1
  buffer_load_dwordx4 a[180:183], v7, s[4:7], s25 offen offset:1024 sc1
  buffer_load_dwordx4 a[40:43], v7, s[4:7], s24 offen offset:2048 sc1
  buffer_load_dwordx4 a[184:187], v7, s[4:7], s25 offen offset:2048 sc1
  buffer_load_dwordx4 a[44:47], v7, s[4:7], s24 offen offset:3072 sc1
  buffer_load_dwordx4 a[188:191], v7, s[4:7], s25 offen offset:3072 sc1
  s_add_u32 s24, s24, 4096
  s_add_u32 s25, s25, 4096
  buffer_load_dwordx4 a[48:51], v7, s[4:7], s24 offen offset:0 sc1
  buffer_load_dwordx4 a[192:195], v7, s[4:7], s25 offen offset:0 sc1
  buffer_load_dwordx4 a[52:55], v7, s[4:7], s24 offen offset:1024 sc1
  buffer_load_dwordx4 a[196:199], v7, s[4:7], s25 offen offset:1024 sc1
  buffer_load_dwordx4 a[56:59], v7, s[4:7], s24 offen offset:2048 sc1
  buffer_load_dwordx4 a[200:203], v7, s[4:7], s25 offen offset:2048 sc1
  buffer_load_dwordx4 a[60:63], v7, s[4:7], s24 offen offset:3072 sc1
  buffer_load_dwordx4 a[204:207], v7, s[4:7], s25 offen offset:3072 sc1
  s_add_u32 s24, s24, 4096
  s_add_u32 s25, s25, 4096
  buffer_load_dwordx4 a[64:67], v7, s[4:7], s24 offen offset:0 sc1
  buffer_load_dwordx4 a[208:211], v7, s[4:7], s25 offen offset:0 sc1
  buffer_load_dwordx4 a[68:71], v7, s[4:7], s24 offen offset:1024 sc1
  buffer_load_dwordx4 a[212:215], v7, s[4:7], s25 offen offset:1024 sc1
  buffer_load_dwordx4 a[72:75], v7, s[4:7], s24 offen offset:2048 sc1
  buffer_load_dwordx4 a[216:219], v7, s[4:7], s25 offen offset:2048 sc1
  buffer_load_dwordx4 a[76:79], v7, s[4:7], s24 offen offset:3072 sc1
  buffer_load_dwordx4 a[220:223], v7, s[4:7], s25 offen offset:3072 sc1
  s_add_u32 s24, s24, 4096
  s_add_u32 s25, s25, 4096
  buffer_load_dwordx4 a[80:83], v7, s[4:7], s24 offen offset:0 sc1
  buffer_load_dwordx4 a[224:227], v7, s[4:7], s25 offen offset:0 sc1
  buffer_load_dwordx4 a[84:87], v7, s[4:7], s24 offen offset:1024 sc1
  buffer_load_dwordx4 a[228:231], v7, s[4:7], s25 offen offset:1024 sc1
  buffer_load_dwordx4 a[88:91], v7, s[4:7], s24 offen offset:2048 sc1
  buffer_load_dwordx4 a[232:235], v7, s[4:7], s25 offen offset:2048 sc1
  buffer_load_dwordx4 a[92:95], v7, s[4:7], s24 offen offset:3072 sc1
  buffer_load_dwordx4 a[236:239], v7, s[4:7], s25 offen offset:3072 sc1
  s_add_u32 s24, s24, 4096
  s_add_u32 s25, s25, 4096
  s_waitcnt vmcnt(48)
  buffer_load_dwordx4 a[96:99], v7, s[4:7], s24 offen offset:0 sc1
  buffer_load_dwordx4 a[240:243], v7, s[4:7], s25 offen offset:0 sc1
  buffer_load_dwordx4 a[100:103], v7, s[4:7], s24 offen offset:1024 sc1
  buffer_load_dwordx4 a[244:247], v7, s[4:7], s25 offen offset:1024 sc1
  buffer_load_dwordx4 a[104:107], v7, s[4:7], s24 offen offset:2048 sc1
  buffer_load_dwordx4 a[248:251], v7, s[4:7], s25 offen offset:2048 sc1
  buffer_load_dwordx4 a[108:111], v7, s[4:7], s24 offen offset:3072 sc1
  buffer_load_dwordx4 a[252:255], v7, s[4:7], s25 offen offset:3072 sc1
  s_add_u32 s24, s24, 4096
  s_add_u32 s25, s25, 4096
  buffer_load_dwordx4 a[112:115], v7, s[4:7], s24 offen offset:0 sc1
  buffer_load_dwordx4 v[224:227], v7, s[4:7], s25 offen offset:0 sc1
  buffer_load_dwordx4 a[116:119], v7, s[4:7], s24 offen offset:1024 sc1
  buffer_load_dwordx4 v[228:231], v7, s[4:7], s25 offen offset:1024 sc1
  buffer_load_dwordx4 a[120:123], v7, s[4:7], s24 offen offset:2048 sc1
  buffer_load_dwordx4 v[232:235], v7, s[4:7], s25 offen offset:2048 sc1
  buffer_load_dwordx4 a[124:127], v7, s[4:7], s24 offen offset:3072 sc1
  buffer_load_dwordx4 v[236:239], v7, s[4:7], s25 offen offset:3072 sc1
  s_add_u32 s24, s24, 4096
  s_add_u32 s25, s25, 4096
  buffer_load_dwordx4 a[128:131], v7, s[4:7], s24 offen offset:0 sc1
  buffer_load_dwordx4 v[240:243], v7, s[4:7], s25 offen offset:0 sc1
  buffer_load_dwordx4 a[132:135], v7, s[4:7], s24 offen offset:1024 sc1
  buffer_load_dwordx4 v[244:247], v7, s[4:7], s25 offen offset:1024 sc1
  buffer_load_dwordx4 a[136:139], v7, s[4:7], s24 offen offset:2048 sc1
  buffer_load_dwordx4 v[248:251], v7, s[4:7], s25 offen offset:2048 sc1
  buffer_load_dwordx4 a[140:143], v7, s[4:7], s24 offen offset:3072 sc1
  buffer_load_dwordx4 v[252:255], v7, s[4:7], s25 offen offset:3072 sc1
  s_add_u32 s24, s24, 4096
  s_add_u32 s25, s25, 4096
  s_lshl_b32 s24, s12, 3
  s_add_u32 s24, s24, s14
  v_lshlrev_b32 v8, 4, v0
  v_mov_b32 v12, -1
  v_mov_b32 v13, -1
  v_mov_b32 v14, -1
  v_mov_b32 v15, -1
  s_lshl_b32 s25, s24, 12
  s_add_u32 s25, s25, 88080384
  buffer_store_dwordx4 v[12:15], v8, s[4:7], s25 offen sc1
  s_add_u32 s25, s25, 786432
  buffer_store_dwordx4 v[12:15], v8, s[4:7], s25 offen sc1
  s_add_u32 s25, s25, 786432
  buffer_store_dwordx4 v[12:15], v8, s[4:7], s25 offen sc1
  s_add_u32 s25, s25, 786432
  buffer_store_dwordx4 v[12:15], v8, s[4:7], s25 offen sc1
  s_add_u32 s25, s25, 786432
  buffer_store_dwordx4 v[12:15], v8, s[4:7], s25 offen sc1
  s_add_u32 s25, s25, 786432
  buffer_store_dwordx4 v[12:15], v8, s[4:7], s25 offen sc1
  s_add_u32 s25, s25, 786432
  buffer_store_dwordx4 v[12:15], v8, s[4:7], s25 offen sc1
  s_add_u32 s25, s25, 786432
  buffer_store_dwordx4 v[12:15], v8, s[4:7], s25 offen sc1
  s_add_u32 s25, s25, 786432
  buffer_store_dwordx4 v[12:15], v8, s[4:7], s25 offen sc1
  s_add_u32 s25, s25, 786432
  buffer_store_dwordx4 v[12:15], v8, s[4:7], s25 offen sc1
  s_add_u32 s25, s25, 786432
  s_cmp_ge_u32 s24, 128
  s_cselect_b32 s26, 786432, 0
  s_sub_u32 s25, s25, s26
  buffer_store_dwordx4 v[12:15], v8, s[4:7], s25 offen sc1
  s_add_u32 s25, s25, 786432
  s_mov_b32 s46, 0
G1A:
  s_barrier
  v_add_u32 v11, s39, v4
  s_add_u32 s39, s39, 36864
  s_cmp_eq_u32 s39, 147456
  s_cselect_b32 s39, 0, s39
  s_cmp_lt_u32 s46, s43
  s_cselect_b32 s15, s44, s45
  s_add_u32 s15, s15, s46
  s_mul_i32 s28, s15, 24
  s_add_u32 s28, s28, s12
  s_lshl_b32 s22, s47, 3
  s_lshl_b32 s29, s13, 1
  s_add_u32 s22, s22, s29
  s_lshl_b32 s22, s22, 18
  s_bfe_u32 s29, s28, 0x50002
  s_lshl_b32 s29, s29, 13
  s_add_u32 s22, s22, s29
  s_and_b32 s42, s28, 3
  s_lshl_b32 s42, s42, 10
  s_add_u32 s22, s22, s42
  s_lshr_b32 s28, s28, 7
  s_cmp_eq_u32 s28, 1
  s_cbranch_scc1 G1VA
  s_mov_b32 s29, 16777216
  s_cmp_eq_u32 s28, 0
  s_cselect_b32 s28, s29, 50331648
  s_cselect_b32 s50, 1.0, 0x3e0293ee
  s_mov_b32 s51, s50
  s_add_u32 s22, s22, s28
  ds_read_b64_tr_b16 v[80:81], v11 offset:0
  ds_read_b64_tr_b16 v[82:83], v11 offset:256
  ds_read_b64_tr_b16 v[84:85], v11 offset:1024
  ds_read_b64_tr_b16 v[86:87], v11 offset:1280
  ds_read_b64_tr_b16 v[88:89], v11 offset:2048
  ds_read_b64_tr_b16 v[90:91], v11 offset:2304
  ds_read_b64_tr_b16 v[92:93], v11 offset:3072
  ds_read_b64_tr_b16 v[94:95], v11 offset:3328
  s_waitcnt lgkmcnt(6)
  s_waitcnt vmcnt(63)
  v_mfma_f32_32x32x16_bf16 v[16:31], v[80:83], a[0:3], 0
  v_mfma_f32_32x32x16_bf16 v[32:47], v[80:83], a[144:147], 0
  ds_read_b64_tr_b16 v[80:81], v11 offset:4096
  ds_read_b64_tr_b16 v[82:83], v11 offset:4352
  s_waitcnt lgkmcnt(6)
  s_waitcnt vmcnt(63)
  v_mfma_f32_32x32x16_bf16 v[16:31], v[84:87], a[4:7], v[16:31]
  v_mfma_f32_32x32x16_bf16 v[32:47], v[84:87], a[148:151], v[32:47]
  ds_read_b64_tr_b16 v[84:85], v11 offset:5120
  ds_read_b64_tr_b16 v[86:87], v11 offset:5376
  s_waitcnt lgkmcnt(6)
  s_waitcnt vmcnt(63)
  v_mfma_f32_32x32x16_bf16 v[16:31], v[88:91], a[8:11], v[16:31]
  v_mfma_f32_32x32x16_bf16 v[32:47], v[88:91], a[152:155], v[32:47]
  ds_read_b64_tr_b16 v[88:89], v11 offset:6144
  ds_read_b64_tr_b16 v[90:91], v11 offset:6400
  s_waitcnt lgkmcnt(6)
  s_waitcnt vmcnt(63)
  v_mfma_f32_32x32x16_bf16 v[16:31], v[92:95], a[12:15], v[16:31]
  v_mfma_f32_32x32x16_bf16 v[32:47], v[92:95], a[156:159], v[32:47]
  ds_read_b64_tr_b16 v[92:93], v11 offset:7168
  ds_read_b64_tr_b16 v[94:95], v11 offset:7424
  s_waitcnt lgkmcnt(6)
  s_waitcnt vmcnt(63)
  v_mfma_f32_32x32x16_bf16 v[16:31], v[80:83], a[16:19], v[16:31]
  v_mfma_f32_32x32x16_bf16 v[32:47], v[80:83], a[160:163], v[32:47]
  ds_read_b64_tr_b16 v[80:81], v11 offset:8192
  ds_read_b64_tr_b16 v[82:83], v11 offset:8448
  s_waitcnt lgkmcnt(6)
  s_waitcnt vmcnt(63)
  v_mfma_f32_32x32x16_bf16 v[16:31], v[84:87], a[20:23], v[16:31]
  v_mfma_f32_32x32x16_bf16 v[32:47], v[84:87], a[164:167], v[32:47]
  ds_read_b64_tr_b16 v[84:85], v11 offset:9216
  ds_read_b64_tr_b16 v[86:87], v11 offset:9472
  s_waitcnt lgkmcnt(6)
  s_waitcnt vmcnt(63)
  v_mfma_f32_32x32x16_bf16 v[16:31], v[88:91], a[24:27], v[16:31]
  v_mfma_f32_32x32x16_bf16 v[32:47], v[88:91], a[168:171], v[32:47]
  ds_read_b64_tr_b16 v[88:89], v11 offset:10240
  ds_read_b64_tr_b16 v[90:91], v11 offset:10496
  s_waitcnt lgkmcnt(6)
  s_waitcnt vmcnt(63)
  v_mfma_f32_32x32x16_bf16 v[16:31], v[92:95], a[28:31], v[16:31]
  v_mfma_f32_32x32x16_bf16 v[32:47], v[92:95], a[172:175], v[32:47]
  ds_read_b64_tr_b16 v[92:93], v11 offset:11264
  ds_read_b64_tr_b16 v[94:95], v11 offset:11520
  s_waitcnt lgkmcnt(6)
  s_waitcnt vmcnt(63)
  v_mfma_f32_32x32x16_bf16 v[16:31], v[80:83], a[32:35], v[16:31]
  v_mfma_f32_32x32x16_bf16 v[32:47], v[80:83], a[176:179], v[32:47]
  ds_read_b64_tr_b16 v[80:81], v11 offset:12288
  ds_read_b64_tr_b16 v[82:83], v11 offset:12544
  s_waitcnt lgkmcnt(6)
  s_waitcnt vmcnt(63)
  v_mfma_f32_32x32x16_bf16 v[16:31], v[84:87], a[36:39], v[16:31]
  v_mfma_f32_32x32x16_bf16 v[32:47], v[84:87], a[180:183], v[32:47]
  ds_read_b64_tr_b16 v[84:85], v11 offset:13312
  ds_read_b64_tr_b16 v[86:87], v11 offset:13568
  s_waitcnt lgkmcnt(6)
  s_waitcnt vmcnt(61)
  v_mfma_f32_32x32x16_bf16 v[16:31], v[88:91], a[40:43], v[16:31]
  v_mfma_f32_32x32x16_bf16 v[32:47], v[88:91], a[184:187], v[32:47]
  ds_read_b64_tr_b16 v[88:89], v11 offset:14336
  ds_read_b64_tr_b16 v[90:91], v11 offset:14592
  s_waitcnt lgkmcnt(6)
  s_waitcnt vmcnt(59)
  v_mfma_f32_32x32x16_bf16 v[16:31], v[92:95], a[44:47], v[16:31]
  v_mfma_f32_32x32x16_bf16 v[32:47], v[92:95], a[188:191], v[32:47]
  ds_read_b64_tr_b16 v[92:93], v11 offset:15360
  ds_read_b64_tr_b16 v[94:95], v11 offset:15616
  s_waitcnt lgkmcnt(6)
  s_waitcnt vmcnt(57)
  v_mfma_f32_32x32x16_bf16 v[16:31], v[80:83], a[48:51], v[16:31]
  v_mfma_f32_32x32x16_bf16 v[32:47], v[80:83], a[192:195], v[32:47]
  ds_read_b64_tr_b16 v[80:81], v11 offset:16384
  ds_read_b64_tr_b16 v[82:83], v11 offset:16640
  s_waitcnt lgkmcnt(6)
  s_waitcnt vmcnt(55)
  v_mfma_f32_32x32x16_bf16 v[16:31], v[84:87], a[52:55], v[16:31]
  v_mfma_f32_32x32x16_bf16 v[32:47], v[84:87], a[196:199], v[32:47]
  ds_read_b64_tr_b16 v[84:85], v11 offset:17408
  ds_read_b64_tr_b16 v[86:87], v11 offset:17664
  s_waitcnt lgkmcnt(6)
  s_waitcnt vmcnt(53)
  v_mfma_f32_32x32x16_bf16 v[16:31], v[88:91], a[56:59], v[16:31]
  v_mfma_f32_32x32x16_bf16 v[32:47], v[88:91], a[200:203], v[32:47]
  ds_read_b64_tr_b16 v[88:89], v11 offset:18432
  ds_read_b64_tr_b16 v[90:91], v11 offset:18688
  s_waitcnt lgkmcnt(6)
  s_waitcnt vmcnt(51)
  v_mfma_f32_32x32x16_bf16 v[16:31], v[92:95], a[60:63], v[16:31]
  v_mfma_f32_32x32x16_bf16 v[32:47], v[92:95], a[204:207], v[32:47]
  ds_read_b64_tr_b16 v[92:93], v11 offset:19456
  ds_read_b64_tr_b16 v[94:95], v11 offset:19712
  s_waitcnt lgkmcnt(6)
  s_waitcnt vmcnt(49)
  v_mfma_f32_32x32x16_bf16 v[16:31], v[80:83], a[64:67], v[16:31]
  v_mfma_f32_32x32x16_bf16 v[32:47], v[80:83], a[208:211], v[32:47]
  ds_read_b64_tr_b16 v[80:81], v11 offset:20480
  ds_read_b64_tr_b16 v[82:83], v11 offset:20736
  s_waitcnt lgkmcnt(6)
  s_waitcnt vmcnt(47)
  v_mfma_f32_32x32x16_bf16 v[16:31], v[84:87], a[68:71], v[16:31]
  v_mfma_f32_32x32x16_bf16 v[32:47], v[84:87], a[212:215], v[32:47]
  ds_read_b64_tr_b16 v[84:85], v11 offset:21504
  ds_read_b64_tr_b16 v[86:87], v11 offset:21760
  s_waitcnt lgkmcnt(6)
  s_waitcnt vmcnt(45)
  v_mfma_f32_32x32x16_bf16 v[16:31], v[88:91], a[72:75], v[16:31]
  v_mfma_f32_32x32x16_bf16 v[32:47], v[88:91], a[216:219], v[32:47]
  ds_read_b64_tr_b16 v[88:89], v11 offset:22528
  ds_read_b64_tr_b16 v[90:91], v11 offset:22784
  s_waitcnt lgkmcnt(6)
  s_waitcnt vmcnt(43)
  v_mfma_f32_32x32x16_bf16 v[16:31], v[92:95], a[76:79], v[16:31]
  v_mfma_f32_32x32x16_bf16 v[32:47], v[92:95], a[220:223], v[32:47]
  ds_read_b64_tr_b16 v[92:93], v11 offset:23552
  ds_read_b64_tr_b16 v[94:95], v11 offset:23808
  s_waitcnt lgkmcnt(6)
  s_waitcnt vmcnt(41)
  v_mfma_f32_32x32x16_bf16 v[16:31], v[80:83], a[80:83], v[16:31]
  v_mfma_f32_32x32x16_bf16 v[32:47], v[80:83], a[224:227], v[32:47]
  ds_read_b64_tr_b16 v[80:81], v11 offset:24576
  ds_read_b64_tr_b16 v[82:83], v11 offset:24832
  s_waitcnt lgkmcnt(6)
  s_waitcnt vmcnt(39)
  v_mfma_f32_32x32x16_bf16 v[16:31], v[84:87], a[84:87], v[16:31]
  v_mfma_f32_32x32x16_bf16 v[32:47], v[84:87], a[228:231], v[32:47]
  ds_read_b64_tr_b16 v[84:85], v11 offset:25600
  ds_read_b64_tr_b16 v[86:87], v11 offset:25856
  s_waitcnt lgkmcnt(6)
  s_waitcnt vmcnt(37)
  v_mfma_f32_32x32x16_bf16 v[16:31], v[88:91], a[88:91], v[16:31]
  v_mfma_f32_32x32x16_bf16 v[32:47], v[88:91], a[232:235], v[32:47]
  ds_read_b64_tr_b16 v[88:89], v11 offset:26624
  ds_read_b64_tr_b16 v[90:91], v11 offset:26880
  s_waitcnt lgkmcnt(6)
  s_waitcnt vmcnt(35)
  v_mfma_f32_32x32x16_bf16 v[16:31], v[92:95], a[92:95], v[16:31]
  v_mfma_f32_32x32x16_bf16 v[32:47], v[92:95], a[236:239], v[32:47]
  ds_read_b64_tr_b16 v[92:93], v11 offset:27648
  ds_read_b64_tr_b16 v[94:95], v11 offset:27904
  s_waitcnt lgkmcnt(6)
  s_waitcnt vmcnt(33)
  v_mfma_f32_32x32x16_bf16 v[16:31], v[80:83], a[96:99], v[16:31]
  v_mfma_f32_32x32x16_bf16 v[32:47], v[80:83], a[240:243], v[32:47]
  ds_read_b64_tr_b16 v[80:81], v11 offset:28672
  ds_read_b64_tr_b16 v[82:83], v11 offset:28928
  s_waitcnt lgkmcnt(6)
  s_waitcnt vmcnt(31)
  v_mfma_f32_32x32x16_bf16 v[16:31], v[84:87], a[100:103], v[16:31]
  v_mfma_f32_32x32x16_bf16 v[32:47], v[84:87], a[244:247], v[32:47]
  ds_read_b64_tr_b16 v[84:85], v11 offset:29696
  ds_read_b64_tr_b16 v[86:87], v11 offset:29952
  s_waitcnt lgkmcnt(6)
  s_waitcnt vmcnt(29)
  v_mfma_f32_32x32x16_bf16 v[16:31], v[88:91], a[104:107], v[16:31]
  v_mfma_f32_32x32x16_bf16 v[32:47], v[88:91], a[248:251], v[32:47]
  ds_read_b64_tr_b16 v[88:89], v11 offset:30720
  ds_read_b64_tr_b16 v[90:91], v11 offset:30976
  s_waitcnt lgkmcnt(6)
  s_waitcnt vmcnt(27)
  v_mfma_f32_32x32x16_bf16 v[16:31], v[92:95], a[108:111], v[16:31]
  v_mfma_f32_32x32x16_bf16 v[32:47], v[92:95], a[252:255], v[32:47]
  ds_read_b64_tr_b16 v[92:93], v11 offset:31744
  ds_read_b64_tr_b16 v[94:95], v11 offset:32000
  s_waitcnt lgkmcnt(6)
  s_waitcnt vmcnt(25)
  v_mfma_f32_32x32x16_bf16 v[16:31], v[80:83], a[112:115], v[16:31]
  v_mfma_f32_32x32x16_bf16 v[32:47], v[80:83], v[224:227], v[32:47]
  ds_read_b64_tr_b16 v[80:81], v11 offset:32768
  ds_read_b64_tr_b16 v[82:83], v11 offset:33024
  s_waitcnt lgkmcnt(6)
  s_waitcnt vmcnt(23)
  v_mfma_f32_32x32x16_bf16 v[16:31], v[84:87], a[116:119], v[16:31]
  v_mfma_f32_32x32x16_bf16 v[32:47], v[84:87], v[228:231], v[32:47]
  ds_read_b64_tr_b16 v[84:85], v11 offset:33792
  ds_read_b64_tr_b16 v[86:87], v11 offset:34048
  s_waitcnt lgkmcnt(6)
  s_waitcnt vmcnt(21)
  v_mfma_f32_32x32x16_bf16 v[16:31], v[88:91], a[120:123], v[16:31]
  v_mfma_f32_32x32x16_bf16 v[32:47], v[88:91], v[232:235], v[32:47]
  ds_read_b64_tr_b16 v[88:89], v11 offset:34816
  ds_read_b64_tr_b16 v[90:91], v11 offset:35072
  s_waitcnt lgkmcnt(6)
  s_waitcnt vmcnt(19)
  v_mfma_f32_32x32x16_bf16 v[16:31], v[92:95], a[124:127], v[16:31]
  v_mfma_f32_32x32x16_bf16 v[32:47], v[92:95], v[236:239], v[32:47]
  ds_read_b64_tr_b16 v[92:93], v11 offset:35840
  ds_read_b64_tr_b16 v[94:95], v11 offset:36096
  s_waitcnt lgkmcnt(6)
  s_waitcnt vmcnt(17)
  v_mfma_f32_32x32x16_bf16 v[16:31], v[80:83], a[128:131], v[16:31]
  v_mfma_f32_32x32x16_bf16 v[32:47], v[80:83], v[240:243], v[32:47]
  s_waitcnt lgkmcnt(4)
  s_waitcnt vmcnt(15)
  v_mfma_f32_32x32x16_bf16 v[16:31], v[84:87], a[132:135], v[16:31]
  v_mfma_f32_32x32x16_bf16 v[32:47], v[84:87], v[244:247], v[32:47]
  s_waitcnt lgkmcnt(2)
  s_waitcnt vmcnt(13)
  v_mfma_f32_32x32x16_bf16 v[16:31], v[88:91], a[136:139], v[16:31]
  v_mfma_f32_32x32x16_bf16 v[32:47], v[88:91], v[248:251], v[32:47]
  s_waitcnt lgkmcnt(0)
  s_waitcnt vmcnt(11)
  v_mfma_f32_32x32x16_bf16 v[16:31], v[92:95], a[140:143], v[16:31]
  v_mfma_f32_32x32x16_bf16 v[32:47], v[92:95], v[252:255], v[32:47]
  s_nop 10
  v_pk_mul_f32 v[16:17], v[16:17], s[50:51]
  v_pk_mul_f32 v[18:19], v[18:19], s[50:51]
  v_pk_mul_f32 v[20:21], v[20:21], s[50:51]
  v_pk_mul_f32 v[22:23], v[22:23], s[50:51]
  v_pk_mul_f32 v[24:25], v[24:25], s[50:51]
  v_pk_mul_f32 v[26:27], v[26:27], s[50:51]
  v_pk_mul_f32 v[28:29], v[28:29], s[50:51]
  v_pk_mul_f32 v[30:31], v[30:31], s[50:51]
  v_pk_mul_f32 v[32:33], v[32:33], s[50:51]
  v_pk_mul_f32 v[34:35], v[34:35], s[50:51]
  v_pk_mul_f32 v[36:37], v[36:37], s[50:51]
  v_pk_mul_f32 v[38:39], v[38:39], s[50:51]
  v_pk_mul_f32 v[40:41], v[40:41], s[50:51]
  v_pk_mul_f32 v[42:43], v[42:43], s[50:51]
  v_pk_mul_f32 v[44:45], v[44:45], s[50:51]
  v_pk_mul_f32 v[46:47], v[46:47], s[50:51]
  v_cvt_pk_bf16_f32 v96, v16, v17
  v_cvt_pk_bf16_f32 v97, v18, v19
  v_cvt_pk_bf16_f32 v98, v20, v21
  v_cvt_pk_bf16_f32 v99, v22, v23
  s_nop 0
  v_permlane32_swap_b32 v96, v98
  v_permlane32_swap_b32 v97, v99
  buffer_store_dwordx4 v[96:99], v5, s[4:7], s22 offen offset:0 sc1
  v_cvt_pk_bf16_f32 v100, v24, v25
  v_cvt_pk_bf16_f32 v101, v26, v27
  v_cvt_pk_bf16_f32 v102, v28, v29
  v_cvt_pk_bf16_f32 v103, v30, v31
  s_nop 0
  v_permlane32_swap_b32 v100, v102
  v_permlane32_swap_b32 v101, v103
  buffer_store_dwordx4 v[100:103], v5, s[4:7], s22 offen offset:512 sc1
  s_add_u32 s22, s22, 262144
  v_cvt_pk_bf16_f32 v104, v32, v33
  v_cvt_pk_bf16_f32 v105, v34, v35
  v_cvt_pk_bf16_f32 v106, v36, v37
  v_cvt_pk_bf16_f32 v107, v38, v39
  s_nop 0
  v_permlane32_swap_b32 v104, v106
  v_permlane32_swap_b32 v105, v107
  buffer_store_dwordx4 v[104:107], v5, s[4:7], s22 offen offset:0 sc1
  v_cvt_pk_bf16_f32 v108, v40, v41
  v_cvt_pk_bf16_f32 v109, v42, v43
  v_cvt_pk_bf16_f32 v110, v44, v45
  v_cvt_pk_bf16_f32 v111, v46, v47
  s_nop 0
  v_permlane32_swap_b32 v108, v110
  v_permlane32_swap_b32 v109, v111
  buffer_store_dwordx4 v[108:111], v5, s[4:7], s22 offen offset:512 sc1
  s_branch G1SEA
G1VA:
  s_add_u32 s22, s22, s42
  s_add_u32 s22, s22, 33554432
  ds_read_b64_tr_b16 v[80:81], v11 offset:0
  ds_read_b64_tr_b16 v[82:83], v11 offset:256
  ds_read_b64_tr_b16 v[84:85], v11 offset:1024
  ds_read_b64_tr_b16 v[86:87], v11 offset:1280
  ds_read_b64_tr_b16 v[88:89], v11 offset:2048
  ds_read_b64_tr_b16 v[90:91], v11 offset:2304
  ds_read_b64_tr_b16 v[92:93], v11 offset:3072
  ds_read_b64_tr_b16 v[94:95], v11 offset:3328
  s_waitcnt lgkmcnt(6)
  s_waitcnt vmcnt(63)
  v_mfma_f32_32x32x16_bf16 v[16:31], a[0:3], v[80:83], 0
  v_mfma_f32_32x32x16_bf16 v[32:47], a[144:147], v[80:83], 0
  ds_read_b64_tr_b16 v[80:81], v11 offset:4096
  ds_read_b64_tr_b16 v[82:83], v11 offset:4352
  s_waitcnt lgkmcnt(6)
  s_waitcnt vmcnt(63)
  v_mfma_f32_32x32x16_bf16 v[16:31], a[4:7], v[84:87], v[16:31]
  v_mfma_f32_32x32x16_bf16 v[32:47], a[148:151], v[84:87], v[32:47]
  ds_read_b64_tr_b16 v[84:85], v11 offset:5120
  ds_read_b64_tr_b16 v[86:87], v11 offset:5376
  s_waitcnt lgkmcnt(6)
  s_waitcnt vmcnt(63)
  v_mfma_f32_32x32x16_bf16 v[16:31], a[8:11], v[88:91], v[16:31]
  v_mfma_f32_32x32x16_bf16 v[32:47], a[152:155], v[88:91], v[32:47]
  ds_read_b64_tr_b16 v[88:89], v11 offset:6144
  ds_read_b64_tr_b16 v[90:91], v11 offset:6400
  s_waitcnt lgkmcnt(6)
  s_waitcnt vmcnt(63)
  v_mfma_f32_32x32x16_bf16 v[16:31], a[12:15], v[92:95], v[16:31]
  v_mfma_f32_32x32x16_bf16 v[32:47], a[156:159], v[92:95], v[32:47]
  ds_read_b64_tr_b16 v[92:93], v11 offset:7168
  ds_read_b64_tr_b16 v[94:95], v11 offset:7424
  s_waitcnt lgkmcnt(6)
  s_waitcnt vmcnt(63)
  v_mfma_f32_32x32x16_bf16 v[16:31], a[16:19], v[80:83], v[16:31]
  v_mfma_f32_32x32x16_bf16 v[32:47], a[160:163], v[80:83], v[32:47]
  ds_read_b64_tr_b16 v[80:81], v11 offset:8192
  ds_read_b64_tr_b16 v[82:83], v11 offset:8448
  s_waitcnt lgkmcnt(6)
  s_waitcnt vmcnt(63)
  v_mfma_f32_32x32x16_bf16 v[16:31], a[20:23], v[84:87], v[16:31]
  v_mfma_f32_32x32x16_bf16 v[32:47], a[164:167], v[84:87], v[32:47]
  ds_read_b64_tr_b16 v[84:85], v11 offset:9216
  ds_read_b64_tr_b16 v[86:87], v11 offset:9472
  s_waitcnt lgkmcnt(6)
  s_waitcnt vmcnt(63)
  v_mfma_f32_32x32x16_bf16 v[16:31], a[24:27], v[88:91], v[16:31]
  v_mfma_f32_32x32x16_bf16 v[32:47], a[168:171], v[88:91], v[32:47]
  ds_read_b64_tr_b16 v[88:89], v11 offset:10240
  ds_read_b64_tr_b16 v[90:91], v11 offset:10496
  s_waitcnt lgkmcnt(6)
  s_waitcnt vmcnt(63)
  v_mfma_f32_32x32x16_bf16 v[16:31], a[28:31], v[92:95], v[16:31]
  v_mfma_f32_32x32x16_bf16 v[32:47], a[172:175], v[92:95], v[32:47]
  ds_read_b64_tr_b16 v[92:93], v11 offset:11264
  ds_read_b64_tr_b16 v[94:95], v11 offset:11520
  s_waitcnt lgkmcnt(6)
  s_waitcnt vmcnt(63)
  v_mfma_f32_32x32x16_bf16 v[16:31], a[32:35], v[80:83], v[16:31]
  v_mfma_f32_32x32x16_bf16 v[32:47], a[176:179], v[80:83], v[32:47]
  ds_read_b64_tr_b16 v[80:81], v11 offset:12288
  ds_read_b64_tr_b16 v[82:83], v11 offset:12544
  s_waitcnt lgkmcnt(6)
  s_waitcnt vmcnt(63)
  v_mfma_f32_32x32x16_bf16 v[16:31], a[36:39], v[84:87], v[16:31]
  v_mfma_f32_32x32x16_bf16 v[32:47], a[180:183], v[84:87], v[32:47]
  ds_read_b64_tr_b16 v[84:85], v11 offset:13312
  ds_read_b64_tr_b16 v[86:87], v11 offset:13568
  s_waitcnt lgkmcnt(6)
  s_waitcnt vmcnt(61)
  v_mfma_f32_32x32x16_bf16 v[16:31], a[40:43], v[88:91], v[16:31]
  v_mfma_f32_32x32x16_bf16 v[32:47], a[184:187], v[88:91], v[32:47]
  ds_read_b64_tr_b16 v[88:89], v11 offset:14336
  ds_read_b64_tr_b16 v[90:91], v11 offset:14592
  s_waitcnt lgkmcnt(6)
  s_waitcnt vmcnt(59)
  v_mfma_f32_32x32x16_bf16 v[16:31], a[44:47], v[92:95], v[16:31]
  v_mfma_f32_32x32x16_bf16 v[32:47], a[188:191], v[92:95], v[32:47]
  ds_read_b64_tr_b16 v[92:93], v11 offset:15360
  ds_read_b64_tr_b16 v[94:95], v11 offset:15616
  s_waitcnt lgkmcnt(6)
  s_waitcnt vmcnt(57)
  v_mfma_f32_32x32x16_bf16 v[16:31], a[48:51], v[80:83], v[16:31]
  v_mfma_f32_32x32x16_bf16 v[32:47], a[192:195], v[80:83], v[32:47]
  ds_read_b64_tr_b16 v[80:81], v11 offset:16384
  ds_read_b64_tr_b16 v[82:83], v11 offset:16640
  s_waitcnt lgkmcnt(6)
  s_waitcnt vmcnt(55)
  v_mfma_f32_32x32x16_bf16 v[16:31], a[52:55], v[84:87], v[16:31]
  v_mfma_f32_32x32x16_bf16 v[32:47], a[196:199], v[84:87], v[32:47]
  ds_read_b64_tr_b16 v[84:85], v11 offset:17408
  ds_read_b64_tr_b16 v[86:87], v11 offset:17664
  s_waitcnt lgkmcnt(6)
  s_waitcnt vmcnt(53)
  v_mfma_f32_32x32x16_bf16 v[16:31], a[56:59], v[88:91], v[16:31]
  v_mfma_f32_32x32x16_bf16 v[32:47], a[200:203], v[88:91], v[32:47]
  ds_read_b64_tr_b16 v[88:89], v11 offset:18432
  ds_read_b64_tr_b16 v[90:91], v11 offset:18688
  s_waitcnt lgkmcnt(6)
  s_waitcnt vmcnt(51)
  v_mfma_f32_32x32x16_bf16 v[16:31], a[60:63], v[92:95], v[16:31]
  v_mfma_f32_32x32x16_bf16 v[32:47], a[204:207], v[92:95], v[32:47]
  ds_read_b64_tr_b16 v[92:93], v11 offset:19456
  ds_read_b64_tr_b16 v[94:95], v11 offset:19712
  s_waitcnt lgkmcnt(6)
  s_waitcnt vmcnt(49)
  v_mfma_f32_32x32x16_bf16 v[16:31], a[64:67], v[80:83], v[16:31]
  v_mfma_f32_32x32x16_bf16 v[32:47], a[208:211], v[80:83], v[32:47]
  ds_read_b64_tr_b16 v[80:81], v11 offset:20480
  ds_read_b64_tr_b16 v[82:83], v11 offset:20736
  s_waitcnt lgkmcnt(6)
  s_waitcnt vmcnt(47)
  v_mfma_f32_32x32x16_bf16 v[16:31], a[68:71], v[84:87], v[16:31]
  v_mfma_f32_32x32x16_bf16 v[32:47], a[212:215], v[84:87], v[32:47]
  ds_read_b64_tr_b16 v[84:85], v11 offset:21504
  ds_read_b64_tr_b16 v[86:87], v11 offset:21760
  s_waitcnt lgkmcnt(6)
  s_waitcnt vmcnt(45)
  v_mfma_f32_32x32x16_bf16 v[16:31], a[72:75], v[88:91], v[16:31]
  v_mfma_f32_32x32x16_bf16 v[32:47], a[216:219], v[88:91], v[32:47]
  ds_read_b64_tr_b16 v[88:89], v11 offset:22528
  ds_read_b64_tr_b16 v[90:91], v11 offset:22784
  s_waitcnt lgkmcnt(6)
  s_waitcnt vmcnt(43)
  v_mfma_f32_32x32x16_bf16 v[16:31], a[76:79], v[92:95], v[16:31]
  v_mfma_f32_32x32x16_bf16 v[32:47], a[220:223], v[92:95], v[32:47]
  ds_read_b64_tr_b16 v[92:93], v11 offset:23552
  ds_read_b64_tr_b16 v[94:95], v11 offset:23808
  s_waitcnt lgkmcnt(6)
  s_waitcnt vmcnt(41)
  v_mfma_f32_32x32x16_bf16 v[16:31], a[80:83], v[80:83], v[16:31]
  v_mfma_f32_32x32x16_bf16 v[32:47], a[224:227], v[80:83], v[32:47]
  ds_read_b64_tr_b16 v[80:81], v11 offset:24576
  ds_read_b64_tr_b16 v[82:83], v11 offset:24832
  s_waitcnt lgkmcnt(6)
  s_waitcnt vmcnt(39)
  v_mfma_f32_32x32x16_bf16 v[16:31], a[84:87], v[84:87], v[16:31]
  v_mfma_f32_32x32x16_bf16 v[32:47], a[228:231], v[84:87], v[32:47]
  ds_read_b64_tr_b16 v[84:85], v11 offset:25600
  ds_read_b64_tr_b16 v[86:87], v11 offset:25856
  s_waitcnt lgkmcnt(6)
  s_waitcnt vmcnt(37)
  v_mfma_f32_32x32x16_bf16 v[16:31], a[88:91], v[88:91], v[16:31]
  v_mfma_f32_32x32x16_bf16 v[32:47], a[232:235], v[88:91], v[32:47]
  ds_read_b64_tr_b16 v[88:89], v11 offset:26624
  ds_read_b64_tr_b16 v[90:91], v11 offset:26880
  s_waitcnt lgkmcnt(6)
  s_waitcnt vmcnt(35)
  v_mfma_f32_32x32x16_bf16 v[16:31], a[92:95], v[92:95], v[16:31]
  v_mfma_f32_32x32x16_bf16 v[32:47], a[236:239], v[92:95], v[32:47]
  ds_read_b64_tr_b16 v[92:93], v11 offset:27648
  ds_read_b64_tr_b16 v[94:95], v11 offset:27904
  s_waitcnt lgkmcnt(6)
  s_waitcnt vmcnt(33)
  v_mfma_f32_32x32x16_bf16 v[16:31], a[96:99], v[80:83], v[16:31]
  v_mfma_f32_32x32x16_bf16 v[32:47], a[240:243], v[80:83], v[32:47]
  ds_read_b64_tr_b16 v[80:81], v11 offset:28672
  ds_read_b64_tr_b16 v[82:83], v11 offset:28928
  s_waitcnt lgkmcnt(6)
  s_waitcnt vmcnt(31)
  v_mfma_f32_32x32x16_bf16 v[16:31], a[100:103], v[84:87], v[16:31]
  v_mfma_f32_32x32x16_bf16 v[32:47], a[244:247], v[84:87], v[32:47]
  ds_read_b64_tr_b16 v[84:85], v11 offset:29696
  ds_read_b64_tr_b16 v[86:87], v11 offset:29952
  s_waitcnt lgkmcnt(6)
  s_waitcnt vmcnt(29)
  v_mfma_f32_32x32x16_bf16 v[16:31], a[104:107], v[88:91], v[16:31]
  v_mfma_f32_32x32x16_bf16 v[32:47], a[248:251], v[88:91], v[32:47]
  ds_read_b64_tr_b16 v[88:89], v11 offset:30720
  ds_read_b64_tr_b16 v[90:91], v11 offset:30976
  s_waitcnt lgkmcnt(6)
  s_waitcnt vmcnt(27)
  v_mfma_f32_32x32x16_bf16 v[16:31], a[108:111], v[92:95], v[16:31]
  v_mfma_f32_32x32x16_bf16 v[32:47], a[252:255], v[92:95], v[32:47]
  ds_read_b64_tr_b16 v[92:93], v11 offset:31744
  ds_read_b64_tr_b16 v[94:95], v11 offset:32000
  s_waitcnt lgkmcnt(6)
  s_waitcnt vmcnt(25)
  v_mfma_f32_32x32x16_bf16 v[16:31], a[112:115], v[80:83], v[16:31]
  v_mfma_f32_32x32x16_bf16 v[32:47], v[224:227], v[80:83], v[32:47]
  ds_read_b64_tr_b16 v[80:81], v11 offset:32768
  ds_read_b64_tr_b16 v[82:83], v11 offset:33024
  s_waitcnt lgkmcnt(6)
  s_waitcnt vmcnt(23)
  v_mfma_f32_32x32x16_bf16 v[16:31], a[116:119], v[84:87], v[16:31]
  v_mfma_f32_32x32x16_bf16 v[32:47], v[228:231], v[84:87], v[32:47]
  ds_read_b64_tr_b16 v[84:85], v11 offset:33792
  ds_read_b64_tr_b16 v[86:87], v11 offset:34048
  s_waitcnt lgkmcnt(6)
  s_waitcnt vmcnt(21)
  v_mfma_f32_32x32x16_bf16 v[16:31], a[120:123], v[88:91], v[16:31]
  v_mfma_f32_32x32x16_bf16 v[32:47], v[232:235], v[88:91], v[32:47]
  ds_read_b64_tr_b16 v[88:89], v11 offset:34816
  ds_read_b64_tr_b16 v[90:91], v11 offset:35072
  s_waitcnt lgkmcnt(6)
  s_waitcnt vmcnt(19)
  v_mfma_f32_32x32x16_bf16 v[16:31], a[124:127], v[92:95], v[16:31]
  v_mfma_f32_32x32x16_bf16 v[32:47], v[236:239], v[92:95], v[32:47]
  ds_read_b64_tr_b16 v[92:93], v11 offset:35840
  ds_read_b64_tr_b16 v[94:95], v11 offset:36096
  s_waitcnt lgkmcnt(6)
  s_waitcnt vmcnt(17)
  v_mfma_f32_32x32x16_bf16 v[16:31], a[128:131], v[80:83], v[16:31]
  v_mfma_f32_32x32x16_bf16 v[32:47], v[240:243], v[80:83], v[32:47]
  s_waitcnt lgkmcnt(4)
  s_waitcnt vmcnt(15)
  v_mfma_f32_32x32x16_bf16 v[16:31], a[132:135], v[84:87], v[16:31]
  v_mfma_f32_32x32x16_bf16 v[32:47], v[244:247], v[84:87], v[32:47]
  s_waitcnt lgkmcnt(2)
  s_waitcnt vmcnt(13)
  v_mfma_f32_32x32x16_bf16 v[16:31], a[136:139], v[88:91], v[16:31]
  v_mfma_f32_32x32x16_bf16 v[32:47], v[248:251], v[88:91], v[32:47]
  s_waitcnt lgkmcnt(0)
  s_waitcnt vmcnt(11)
  v_mfma_f32_32x32x16_bf16 v[16:31], a[140:143], v[92:95], v[16:31]
  v_mfma_f32_32x32x16_bf16 v[32:47], v[252:255], v[92:95], v[32:47]
  s_nop 10
  v_cvt_pk_bf16_f32 v96, v16, v17
  v_cvt_pk_bf16_f32 v97, v18, v19
  v_cvt_pk_bf16_f32 v98, v24, v25
  v_cvt_pk_bf16_f32 v99, v26, v27
  buffer_store_dwordx4 v[96:99], v6, s[4:7], s22 offen offset:0 sc1
  v_cvt_pk_bf16_f32 v100, v20, v21
  v_cvt_pk_bf16_f32 v101, v22, v23
  v_cvt_pk_bf16_f32 v102, v28, v29
  v_cvt_pk_bf16_f32 v103, v30, v31
  buffer_store_dwordx4 v[100:103], v6, s[4:7], s22 offen offset:512 sc1
  s_add_u32 s22, s22, 262144
  v_cvt_pk_bf16_f32 v104, v32, v33
  v_cvt_pk_bf16_f32 v105, v34, v35
  v_cvt_pk_bf16_f32 v106, v40, v41
  v_cvt_pk_bf16_f32 v107, v42, v43
  buffer_store_dwordx4 v[104:107], v6, s[4:7], s22 offen offset:0 sc1
  v_cvt_pk_bf16_f32 v108, v36, v37
  v_cvt_pk_bf16_f32 v109, v38, v39
  v_cvt_pk_bf16_f32 v110, v44, v45
  v_cvt_pk_bf16_f32 v111, v46, v47
  buffer_store_dwordx4 v[108:111], v6, s[4:7], s22 offen offset:512 sc1
G1SEA:
  s_add_u32 s46, s46, 1
  s_cmp_lt_u32 s46, s43
  s_cbranch_scc1 G1A
  s_waitcnt vmcnt(0)
  s_barrier
  s_cmp_lg_u32 s13, 0
  s_cbranch_scc1 SIG_5
  s_lshl_b32 s29, s47, 2
  s_add_u32 s29, s29, 96
  v_mov_b32 v8, s29
  v_mov_b32 v9, 1
  s_mov_b64 exec, 1
  global_atomic_add v8, v9, s[92:93]
  s_mov_b64 exec, -1
SIG_5:
  s_cmp_lt_u32 s38, s43
  s_cselect_b32 s24, s44, s45
  s_add_u32 s24, s24, s38
  s_min_u32 s24, s24, 27
  s_mul_i32 s25, s24, 24
  s_add_u32 s25, s25, s12
  s_lshr_b32 s26, s25, 7
  s_and_b32 s25, s25, 127
  s_lshl_b32 s25, s25, 6
  s_mul_i32 s41, s13, 1179648
  s_add_u32 s41, s41, s25
  s_cmp_eq_u32 s26, 1
  s_cselect_b64 s[8:9], s[80:81], s[78:79]
  s_cmp_eq_u32 s26, 2
  s_cselect_b64 s[8:9], s[76:77], s[8:9]
  s_sub_u32 s25, s24, 16
  s_lshr_b32 s26, s25, 1
  s_mul_i32 s26, s26, 24
  s_add_u32 s26, s26, s12
  s_lshl_b32 s26, s26, 6
  s_mul_i32 s27, s13, 1327104
  s_add_u32 s26, s26, s27
  s_bitcmp1_b32 s25, 0
  s_cselect_b64 s[20:21], s[86:87], s[84:85]
  s_cmp_ge_u32 s24, 16
  s_cselect_b64 s[8:9], s[20:21], s[8:9]
  s_cselect_b32 s41, s26, s41
  s_cselect_b32 s10, 5308416, s23
  s_cselect_b32 s16, 147456, s31
  s_cselect_b64 s[18:19], -1, 0
  v_cndmask_b32 v10, v2, v3, s[18:19]
  s_add_u32 s24, s40, s30
  s_add_u32 m0, s24, 0
  s_nop 0
  buffer_load_dwordx4 v10, s[8:11], s41 offen lds
  s_add_u32 s41, s41, s16
  s_add_u32 m0, s24, 1024
  s_nop 0
  buffer_load_dwordx4 v10, s[8:11], s41 offen lds
  s_add_u32 s41, s41, s16
  s_add_u32 m0, s24, 2048
  s_nop 0
  buffer_load_dwordx4 v10, s[8:11], s41 offen lds
  s_add_u32 s41, s41, s16
  s_add_u32 m0, s24, 3072
  s_nop 0
  buffer_load_dwordx4 v10, s[8:11], s41 offen lds
  s_add_u32 s41, s41, s16
  s_add_u32 m0, s24, 4096
  s_nop 0
  buffer_load_dwordx4 v10, s[8:11], s41 offen lds
  s_add_u32 s41, s41, s16
  s_add_u32 m0, s24, 5120
  s_nop 0
  buffer_load_dwordx4 v10, s[8:11], s41 offen lds
  s_add_u32 s41, s41, s16
  s_add_u32 m0, s24, 6144
  s_nop 0
  buffer_load_dwordx4 v10, s[8:11], s41 offen lds
  s_add_u32 s41, s41, s16
  s_add_u32 m0, s24, 7168
  s_nop 0
  buffer_load_dwordx4 v10, s[8:11], s41 offen lds
  s_add_u32 s41, s41, s16
  s_add_u32 m0, s24, 8192
  s_nop 0
  buffer_load_dwordx4 v10, s[8:11], s41 offen lds
  s_add_u32 s41, s41, s16
  s_add_u32 s38, s38, 1
  s_add_u32 s40, s40, 36864
  s_cmp_eq_u32 s40, 147456
  s_cselect_b32 s40, 0, s40
  s_cmp_lt_u32 s38, s43
  s_cselect_b32 s24, s44, s45
  s_add_u32 s24, s24, s38
  s_min_u32 s24, s24, 27
  s_mul_i32 s25, s24, 24
  s_add_u32 s25, s25, s12
  s_lshr_b32 s26, s25, 7
  s_and_b32 s25, s25, 127
  s_lshl_b32 s25, s25, 6
  s_mul_i32 s41, s13, 1179648
  s_add_u32 s41, s41, s25
  s_cmp_eq_u32 s26, 1
  s_cselect_b64 s[8:9], s[80:81], s[78:79]
  s_cmp_eq_u32 s26, 2
  s_cselect_b64 s[8:9], s[76:77], s[8:9]
  s_sub_u32 s25, s24, 16
  s_lshr_b32 s26, s25, 1
  s_mul_i32 s26, s26, 24
  s_add_u32 s26, s26, s12
  s_lshl_b32 s26, s26, 6
  s_mul_i32 s27, s13, 1327104
  s_add_u32 s26, s26, s27
  s_bitcmp1_b32 s25, 0
  s_cselect_b64 s[20:21], s[86:87], s[84:85]
  s_cmp_ge_u32 s24, 16
  s_cselect_b64 s[8:9], s[20:21], s[8:9]
  s_cselect_b32 s41, s26, s41
  s_cselect_b32 s10, 5308416, s23
  s_cselect_b32 s16, 147456, s31
  s_cselect_b64 s[18:19], -1, 0
  v_cndmask_b32 v10, v2, v3, s[18:19]
  s_add_u32 s24, s40, s30
  s_add_u32 m0, s24, 0
  s_nop 0
  buffer_load_dwordx4 v10, s[8:11], s41 offen lds
  s_add_u32 s41, s41, s16
  s_add_u32 m0, s24, 1024
  s_nop 0
  buffer_load_dwordx4 v10, s[8:11], s41 offen lds
  s_add_u32 s41, s41, s16
  s_add_u32 m0, s24, 2048
  s_nop 0
  buffer_load_dwordx4 v10, s[8:11], s41 offen lds
  s_add_u32 s41, s41, s16
  s_add_u32 m0, s24, 3072
  s_nop 0
  buffer_load_dwordx4 v10, s[8:11], s41 offen lds
  s_add_u32 s41, s41, s16
  s_add_u32 m0, s24, 4096
  s_nop 0
  buffer_load_dwordx4 v10, s[8:11], s41 offen lds
  s_add_u32 s41, s41, s16
  s_add_u32 m0, s24, 5120
  s_nop 0
  buffer_load_dwordx4 v10, s[8:11], s41 offen lds
  s_add_u32 s41, s41, s16
  s_add_u32 m0, s24, 6144
  s_nop 0
  buffer_load_dwordx4 v10, s[8:11], s41 offen lds
  s_add_u32 s41, s41, s16
  s_add_u32 m0, s24, 7168
  s_nop 0
  buffer_load_dwordx4 v10, s[8:11], s41 offen lds
  s_add_u32 s41, s41, s16
  s_add_u32 m0, s24, 8192
  s_nop 0
  buffer_load_dwordx4 v10, s[8:11], s41 offen lds
  s_add_u32 s41, s41, s16
  s_add_u32 s38, s38, 1
  s_add_u32 s40, s40, 36864
  s_cmp_eq_u32 s40, 147456
  s_cselect_b32 s40, 0, s40
  s_cmp_lt_u32 s43, 3
  s_cbranch_scc1 G1P
  s_cmp_lt_u32 s38, s43
  s_cselect_b32 s24, s44, s45
  s_add_u32 s24, s24, s38
  s_min_u32 s24, s24, 27
  s_mul_i32 s25, s24, 24
  s_add_u32 s25, s25, s12
  s_lshr_b32 s26, s25, 7
  s_and_b32 s25, s25, 127
  s_lshl_b32 s25, s25, 6
  s_mul_i32 s41, s13, 1179648
  s_add_u32 s41, s41, s25
  s_cmp_eq_u32 s26, 1
  s_cselect_b64 s[8:9], s[80:81], s[78:79]
  s_cmp_eq_u32 s26, 2
  s_cselect_b64 s[8:9], s[76:77], s[8:9]
  s_sub_u32 s25, s24, 16
  s_lshr_b32 s26, s25, 1
  s_mul_i32 s26, s26, 24
  s_add_u32 s26, s26, s12
  s_lshl_b32 s26, s26, 6
  s_mul_i32 s27, s13, 1327104
  s_add_u32 s26, s26, s27
  s_bitcmp1_b32 s25, 0
  s_cselect_b64 s[20:21], s[86:87], s[84:85]
  s_cmp_ge_u32 s24, 16
  s_cselect_b64 s[8:9], s[20:21], s[8:9]
  s_cselect_b32 s41, s26, s41
  s_cselect_b32 s10, 5308416, s23
  s_cselect_b32 s16, 147456, s31
  s_cselect_b64 s[18:19], -1, 0
  v_cndmask_b32 v10, v2, v3, s[18:19]
  s_add_u32 s24, s40, s30
  s_add_u32 m0, s24, 0
  s_nop 0
  buffer_load_dwordx4 v10, s[8:11], s41 offen lds
  s_add_u32 s41, s41, s16
  s_add_u32 m0, s24, 1024
  s_nop 0
  buffer_load_dwordx4 v10, s[8:11], s41 offen lds
  s_add_u32 s41, s41, s16
  s_add_u32 m0, s24, 2048
  s_nop 0
  buffer_load_dwordx4 v10, s[8:11], s41 offen lds
  s_add_u32 s41, s41, s16
  s_add_u32 m0, s24, 3072
  s_nop 0
  buffer_load_dwordx4 v10, s[8:11], s41 offen lds
  s_add_u32 s41, s41, s16
  s_add_u32 m0, s24, 4096
  s_nop 0
  buffer_load_dwordx4 v10, s[8:11], s41 offen lds
  s_add_u32 s41, s41, s16
  s_add_u32 m0, s24, 5120
  s_nop 0
  buffer_load_dwordx4 v10, s[8:11], s41 offen lds
  s_add_u32 s41, s41, s16
  s_add_u32 m0, s24, 6144
  s_nop 0
  buffer_load_dwordx4 v10, s[8:11], s41 offen lds
  s_add_u32 s41, s41, s16
  s_add_u32 m0, s24, 7168
  s_nop 0
  buffer_load_dwordx4 v10, s[8:11], s41 offen lds
  s_add_u32 s41, s41, s16
  s_add_u32 m0, s24, 8192
  s_nop 0
  buffer_load_dwordx4 v10, s[8:11], s41 offen lds
  s_add_u32 s41, s41, s16
  s_add_u32 s38, s38, 1
  s_add_u32 s40, s40, 36864
  s_cmp_eq_u32 s40, 147456
  s_cselect_b32 s40, 0, s40
G1P:
  s_cmp_lt_u32 s14, 2
  s_cbranch_scc1 G1S
  s_mov_b32 s47, s14
  s_cmp_lg_u32 s13, 0
  s_cbranch_scc1 WFE_8
  s_lshl_b32 s29, s47, 2
  s_add_u32 s29, s29, 64
  v_mov_b32 v8, s29
  s_mov_b64 exec, 1
  s_mov_b32 s42, 0
WF_6:
  global_load_dword v9, v8, s[92:93] sc1
  s_add_u32 s42, s42, 1
  s_cmp_gt_u32 s42, 0x20000
  s_cbranch_scc1 WFD_7
  s_waitcnt vmcnt(0)
  v_cmp_gt_u32 vcc, 8, v9
  s_cbranch_vccz WFD_7
  s_sleep 4
  s_branch WF_6
WFD_7:
  s_waitcnt vmcnt(0)
  s_mov_b64 exec, -1
WFE_8:
  s_barrier
  s_lshl_b32 s24, s47, 3
  s_lshl_b32 s25, s13, 1
  s_add_u32 s24, s24, s25
  s_mul_i32 s24, s24, 36864
  s_add_u32 s24, s24, 2097152
  s_add_u32 s25, s24, 36864
  buffer_load_dwordx4 a[0:3], v7, s[4:7], s24 offen offset:0 sc1
  buffer_load_dwordx4 a[144:147], v7, s[4:7], s25 offen offset:0 sc1
  buffer_load_dwordx4 a[4:7], v7, s[4:7], s24 offen offset:1024 sc1
  buffer_load_dwordx4 a[148:151], v7, s[4:7], s25 offen offset:1024 sc1
  buffer_load_dwordx4 a[8:11], v7, s[4:7], s24 offen offset:2048 sc1
  buffer_load_dwordx4 a[152:155], v7, s[4:7], s25 offen offset:2048 sc1
  buffer_load_dwordx4 a[12:15], v7, s[4:7], s24 offen offset:3072 sc1
  buffer_load_dwordx4 a[156:159], v7, s[4:7], s25 offen offset:3072 sc1
  s_add_u32 s24, s24, 4096
  s_add_u32 s25, s25, 4096
  buffer_load_dwordx4 a[16:19], v7, s[4:7], s24 offen offset:0 sc1
  buffer_load_dwordx4 a[160:163], v7, s[4:7], s25 offen offset:0 sc1
  buffer_load_dwordx4 a[20:23], v7, s[4:7], s24 offen offset:1024 sc1
  buffer_load_dwordx4 a[164:167], v7, s[4:7], s25 offen offset:1024 sc1
  buffer_load_dwordx4 a[24:27], v7, s[4:7], s24 offen offset:2048 sc1
  buffer_load_dwordx4 a[168:171], v7, s[4:7], s25 offen offset:2048 sc1
  buffer_load_dwordx4 a[28:31], v7, s[4:7], s24 offen offset:3072 sc1
  buffer_load_dwordx4 a[172:175], v7, s[4:7], s25 offen offset:3072 sc1
  s_add_u32 s24, s24, 4096
  s_add_u32 s25, s25, 4096
  buffer_load_dwordx4 a[32:35], v7, s[4:7], s24 offen offset:0 sc1
  buffer_load_dwordx4 a[176:179], v7, s[4:7], s25 offen offset:0 sc1
  buffer_load_dwordx4 a[36:39], v7, s[4:7], s24 offen offset:1024 sc1
  buffer_load_dwordx4 a[180:183], v7, s[4:7], s25 offen offset:1024 sc1
  buffer_load_dwordx4 a[40:43], v7, s[4:7], s24 offen offset:2048 sc1
  buffer_load_dwordx4 a[184:187], v7, s[4:7], s25 offen offset:2048 sc1
  buffer_load_dwordx4 a[44:47], v7, s[4:7], s24 offen offset:3072 sc1
  buffer_load_dwordx4 a[188:191], v7, s[4:7], s25 offen offset:3072 sc1
  s_add_u32 s24, s24, 4096
  s_add_u32 s25, s25, 4096
  buffer_load_dwordx4 a[48:51], v7, s[4:7], s24 offen offset:0 sc1
  buffer_load_dwordx4 a[192:195], v7, s[4:7], s25 offen offset:0 sc1
  buffer_load_dwordx4 a[52:55], v7, s[4:7], s24 offen offset:1024 sc1
  buffer_load_dwordx4 a[196:199], v7, s[4:7], s25 offen offset:1024 sc1
  buffer_load_dwordx4 a[56:59], v7, s[4:7], s24 offen offset:2048 sc1
  buffer_load_dwordx4 a[200:203], v7, s[4:7], s25 offen offset:2048 sc1
  buffer_load_dwordx4 a[60:63], v7, s[4:7], s24 offen offset:3072 sc1
  buffer_load_dwordx4 a[204:207], v7, s[4:7], s25 offen offset:3072 sc1
  s_add_u32 s24, s24, 4096
  s_add_u32 s25, s25, 4096
  buffer_load_dwordx4 a[64:67], v7, s[4:7], s24 offen offset:0 sc1
  buffer_load_dwordx4 a[208:211], v7, s[4:7], s25 offen offset:0 sc1
  buffer_load_dwordx4 a[68:71], v7, s[4:7], s24 offen offset:1024 sc1
  buffer_load_dwordx4 a[212:215], v7, s[4:7], s25 offen offset:1024 sc1
  buffer_load_dwordx4 a[72:75], v7, s[4:7], s24 offen offset:2048 sc1
  buffer_load_dwordx4 a[216:219], v7, s[4:7], s25 offen offset:2048 sc1
  buffer_load_dwordx4 a[76:79], v7, s[4:7], s24 offen offset:3072 sc1
  buffer_load_dwordx4 a[220:223], v7, s[4:7], s25 offen offset:3072 sc1
  s_add_u32 s24, s24, 4096
  s_add_u32 s25, s25, 4096
  buffer_load_dwordx4 a[80:83], v7, s[4:7], s24 offen offset:0 sc1
  buffer_load_dwordx4 a[224:227], v7, s[4:7], s25 offen offset:0 sc1
  buffer_load_dwordx4 a[84:87], v7, s[4:7], s24 offen offset:1024 sc1
  buffer_load_dwordx4 a[228:231], v7, s[4:7], s25 offen offset:1024 sc1
  buffer_load_dwordx4 a[88:91], v7, s[4:7], s24 offen offset:2048 sc1
  buffer_load_dwordx4 a[232:235], v7, s[4:7], s25 offen offset:2048 sc1
  buffer_load_dwordx4 a[92:95], v7, s[4:7], s24 offen offset:3072 sc1
  buffer_load_dwordx4 a[236:239], v7, s[4:7], s25 offen offset:3072 sc1
  s_add_u32 s24, s24, 4096
  s_add_u32 s25, s25, 4096
  s_waitcnt vmcnt(48)
  buffer_load_dwordx4 a[96:99], v7, s[4:7], s24 offen offset:0 sc1
  buffer_load_dwordx4 a[240:243], v7, s[4:7], s25 offen offset:0 sc1
  buffer_load_dwordx4 a[100:103], v7, s[4:7], s24 offen offset:1024 sc1
  buffer_load_dwordx4 a[244:247], v7, s[4:7], s25 offen offset:1024 sc1
  buffer_load_dwordx4 a[104:107], v7, s[4:7], s24 offen offset:2048 sc1
  buffer_load_dwordx4 a[248:251], v7, s[4:7], s25 offen offset:2048 sc1
  buffer_load_dwordx4 a[108:111], v7, s[4:7], s24 offen offset:3072 sc1
  buffer_load_dwordx4 a[252:255], v7, s[4:7], s25 offen offset:3072 sc1
  s_add_u32 s24, s24, 4096
  s_add_u32 s25, s25, 4096
  buffer_load_dwordx4 a[112:115], v7, s[4:7], s24 offen offset:0 sc1
  buffer_load_dwordx4 v[224:227], v7, s[4:7], s25 offen offset:0 sc1
  buffer_load_dwordx4 a[116:119], v7, s[4:7], s24 offen offset:1024 sc1
  buffer_load_dwordx4 v[228:231], v7, s[4:7], s25 offen offset:1024 sc1
  buffer_load_dwordx4 a[120:123], v7, s[4:7], s24 offen offset:2048 sc1
  buffer_load_dwordx4 v[232:235], v7, s[4:7], s25 offen offset:2048 sc1
  buffer_load_dwordx4 a[124:127], v7, s[4:7], s24 offen offset:3072 sc1
  buffer_load_dwordx4 v[236:239], v7, s[4:7], s25 offen offset:3072 sc1
  s_add_u32 s24, s24, 4096
  s_add_u32 s25, s25, 4096
  buffer_load_dwordx4 a[128:131], v7, s[4:7], s24 offen offset:0 sc1
  buffer_load_dwordx4 v[240:243], v7, s[4:7], s25 offen offset:0 sc1
  buffer_load_dwordx4 a[132:135], v7, s[4:7], s24 offen offset:1024 sc1
  buffer_load_dwordx4 v[244:247], v7, s[4:7], s25 offen offset:1024 sc1
  buffer_load_dwordx4 a[136:139], v7, s[4:7], s24 offen offset:2048 sc1
  buffer_load_dwordx4 v[248:251], v7, s[4:7], s25 offen offset:2048 sc1
  buffer_load_dwordx4 a[140:143], v7, s[4:7], s24 offen offset:3072 sc1
  buffer_load_dwordx4 v[252:255], v7, s[4:7], s25 offen offset:3072 sc1
  s_add_u32 s24, s24, 4096
  s_add_u32 s25, s25, 4096
  s_waitcnt vmcnt(0)
G1S:
  s_waitcnt vmcnt(18)
  s_barrier
  v_add_u32 v11, s39, v4
  s_add_u32 s39, s39, 36864
  s_cmp_eq_u32 s39, 147456
  s_cselect_b32 s39, 0, s39
  s_cmp_lt_u32 s46, s43
  s_cselect_b32 s15, s44, s45
  s_add_u32 s15, s15, s46
  s_mul_i32 s28, s15, 24
  s_add_u32 s28, s28, s12
  s_lshl_b32 s22, s47, 3
  s_lshl_b32 s29, s13, 1
  s_add_u32 s22, s22, s29
  s_lshl_b32 s22, s22, 18
  s_bfe_u32 s29, s28, 0x50002
  s_lshl_b32 s29, s29, 13
  s_add_u32 s22, s22, s29
  s_and_b32 s42, s28, 3
  s_lshl_b32 s42, s42, 10
  s_add_u32 s22, s22, s42
  s_lshr_b32 s28, s28, 7
  s_cmp_eq_u32 s28, 1
  s_cbranch_scc1 G1VB
  s_mov_b32 s29, 16777216
  s_cmp_eq_u32 s28, 0
  s_cselect_b32 s28, s29, 50331648
  s_cselect_b32 s50, 1.0, 0x3e0293ee
  s_mov_b32 s51, s50
  s_add_u32 s22, s22, s28
  ds_read_b64_tr_b16 v[80:81], v11 offset:0
  ds_read_b64_tr_b16 v[82:83], v11 offset:256
  ds_read_b64_tr_b16 v[84:85], v11 offset:1024
  ds_read_b64_tr_b16 v[86:87], v11 offset:1280
  ds_read_b64_tr_b16 v[88:89], v11 offset:2048
  ds_read_b64_tr_b16 v[90:91], v11 offset:2304
  ds_read_b64_tr_b16 v[92:93], v11 offset:3072
  ds_read_b64_tr_b16 v[94:95], v11 offset:3328
  s_waitcnt lgkmcnt(6)
  v_mfma_f32_32x32x16_bf16 v[16:31], v[80:83], a[0:3], 0
  v_mfma_f32_32x32x16_bf16 v[32:47], v[80:83], a[144:147], 0
  ds_read_b64_tr_b16 v[80:81], v11 offset:4096
  ds_read_b64_tr_b16 v[82:83], v11 offset:4352
  s_waitcnt lgkmcnt(6)
  v_mfma_f32_32x32x16_bf16 v[16:31], v[84:87], a[4:7], v[16:31]
  s_cmp_lt_u32 s38, s43
  s_cselect_b32 s24, s44, s45
  s_add_u32 s24, s24, s38
  v_mfma_f32_32x32x16_bf16 v[32:47], v[84:87], a[148:151], v[32:47]
  s_min_u32 s24, s24, 27
  ds_read_b64_tr_b16 v[84:85], v11 offset:5120
  ds_read_b64_tr_b16 v[86:87], v11 offset:5376
  s_waitcnt lgkmcnt(6)
  v_mfma_f32_32x32x16_bf16 v[16:31], v[88:91], a[8:11], v[16:31]
  s_mul_i32 s25, s24, 24
  v_mfma_f32_32x32x16_bf16 v[32:47], v[88:91], a[152:155], v[32:47]
  s_add_u32 s25, s25, s12
  ds_read_b64_tr_b16 v[88:89], v11 offset:6144
  ds_read_b64_tr_b16 v[90:91], v11 offset:6400
  s_waitcnt lgkmcnt(6)
  v_mfma_f32_32x32x16_bf16 v[16:31], v[92:95], a[12:15], v[16:31]
  s_lshr_b32 s26, s25, 7
  v_mfma_f32_32x32x16_bf16 v[32:47], v[92:95], a[156:159], v[32:47]
  s_and_b32 s25, s25, 127
  ds_read_b64_tr_b16 v[92:93], v11 offset:7168
  ds_read_b64_tr_b16 v[94:95], v11 offset:7424
  s_waitcnt lgkmcnt(6)
  v_mfma_f32_32x32x16_bf16 v[16:31], v[80:83], a[16:19], v[16:31]
  s_lshl_b32 s25, s25, 6
  v_mfma_f32_32x32x16_bf16 v[32:47], v[80:83], a[160:163], v[32:47]
  s_mul_i32 s41, s13, 1179648
  ds_read_b64_tr_b16 v[80:81], v11 offset:8192
  ds_read_b64_tr_b16 v[82:83], v11 offset:8448
  s_waitcnt lgkmcnt(6)
  v_mfma_f32_32x32x16_bf16 v[16:31], v[84:87], a[20:23], v[16:31]
  s_add_u32 s41, s41, s25
  v_mfma_f32_32x32x16_bf16 v[32:47], v[84:87], a[164:167], v[32:47]
  s_cmp_eq_u32 s26, 1
  s_cselect_b64 s[8:9], s[80:81], s[78:79]
  ds_read_b64_tr_b16 v[84:85], v11 offset:9216
  ds_read_b64_tr_b16 v[86:87], v11 offset:9472
  s_waitcnt lgkmcnt(6)
  v_mfma_f32_32x32x16_bf16 v[16:31], v[88:91], a[24:27], v[16:31]
  s_cmp_eq_u32 s26, 2
  s_cselect_b64 s[8:9], s[76:77], s[8:9]
  v_mfma_f32_32x32x16_bf16 v[32:47], v[88:91], a[168:171], v[32:47]
  s_sub_u32 s25, s24, 16
  ds_read_b64_tr_b16 v[88:89], v11 offset:10240
  ds_read_b64_tr_b16 v[90:91], v11 offset:10496
  s_waitcnt lgkmcnt(6)
  v_mfma_f32_32x32x16_bf16 v[16:31], v[92:95], a[28:31], v[16:31]
  s_lshr_b32 s26, s25, 1
  v_mfma_f32_32x32x16_bf16 v[32:47], v[92:95], a[172:175], v[32:47]
  s_mul_i32 s26, s26, 24
  ds_read_b64_tr_b16 v[92:93], v11 offset:11264
  ds_read_b64_tr_b16 v[94:95], v11 offset:11520
  s_waitcnt lgkmcnt(6)
  v_mfma_f32_32x32x16_bf16 v[16:31], v[80:83], a[32:35], v[16:31]
  s_add_u32 s26, s26, s12
  v_mfma_f32_32x32x16_bf16 v[32:47], v[80:83], a[176:179], v[32:47]
  s_lshl_b32 s26, s26, 6
  ds_read_b64_tr_b16 v[80:81], v11 offset:12288
  ds_read_b64_tr_b16 v[82:83], v11 offset:12544
  s_waitcnt lgkmcnt(6)
  v_mfma_f32_32x32x16_bf16 v[16:31], v[84:87], a[36:39], v[16:31]
  s_mul_i32 s27, s13, 1327104
  v_mfma_f32_32x32x16_bf16 v[32:47], v[84:87], a[180:183], v[32:47]
  s_add_u32 s26, s26, s27
  ds_read_b64_tr_b16 v[84:85], v11 offset:13312
  ds_read_b64_tr_b16 v[86:87], v11 offset:13568
  s_waitcnt lgkmcnt(6)
  v_mfma_f32_32x32x16_bf16 v[16:31], v[88:91], a[40:43], v[16:31]
  s_bitcmp1_b32 s25, 0
  s_cselect_b64 s[20:21], s[86:87], s[84:85]
  v_mfma_f32_32x32x16_bf16 v[32:47], v[88:91], a[184:187], v[32:47]
  s_cmp_ge_u32 s24, 16
  s_cselect_b64 s[8:9], s[20:21], s[8:9]
  s_cselect_b32 s41, s26, s41
  s_cselect_b32 s10, 5308416, s23
  s_cselect_b32 s16, 147456, s31
  s_cselect_b64 s[18:19], -1, 0
  ds_read_b64_tr_b16 v[88:89], v11 offset:14336
  ds_read_b64_tr_b16 v[90:91], v11 offset:14592
  s_waitcnt lgkmcnt(6)
  v_mfma_f32_32x32x16_bf16 v[16:31], v[92:95], a[44:47], v[16:31]
  v_cndmask_b32 v10, v2, v3, s[18:19]
  v_mfma_f32_32x32x16_bf16 v[32:47], v[92:95], a[188:191], v[32:47]
  s_add_u32 s24, s40, s30
  ds_read_b64_tr_b16 v[92:93], v11 offset:15360
  ds_read_b64_tr_b16 v[94:95], v11 offset:15616
  s_waitcnt lgkmcnt(6)
  v_mfma_f32_32x32x16_bf16 v[16:31], v[80:83], a[48:51], v[16:31]
  s_add_u32 m0, s24, 0
  s_nop 0
  buffer_load_dwordx4 v10, s[8:11], s41 offen lds
  s_add_u32 s41, s41, s16
  v_mfma_f32_32x32x16_bf16 v[32:47], v[80:83], a[192:195], v[32:47]
  ds_read_b64_tr_b16 v[80:81], v11 offset:16384
  ds_read_b64_tr_b16 v[82:83], v11 offset:16640
  s_waitcnt lgkmcnt(6)
  v_mfma_f32_32x32x16_bf16 v[16:31], v[84:87], a[52:55], v[16:31]
  v_mfma_f32_32x32x16_bf16 v[32:47], v[84:87], a[196:199], v[32:47]
  s_add_u32 m0, s24, 1024
  s_nop 0
  buffer_load_dwordx4 v10, s[8:11], s41 offen lds
  s_add_u32 s41, s41, s16
  ds_read_b64_tr_b16 v[84:85], v11 offset:17408
  ds_read_b64_tr_b16 v[86:87], v11 offset:17664
  s_waitcnt lgkmcnt(6)
  v_mfma_f32_32x32x16_bf16 v[16:31], v[88:91], a[56:59], v[16:31]
  v_mfma_f32_32x32x16_bf16 v[32:47], v[88:91], a[200:203], v[32:47]
  ds_read_b64_tr_b16 v[88:89], v11 offset:18432
  ds_read_b64_tr_b16 v[90:91], v11 offset:18688
  s_waitcnt lgkmcnt(6)
  v_mfma_f32_32x32x16_bf16 v[16:31], v[92:95], a[60:63], v[16:31]
  s_add_u32 m0, s24, 2048
  s_nop 0
  buffer_load_dwordx4 v10, s[8:11], s41 offen lds
  s_add_u32 s41, s41, s16
  v_mfma_f32_32x32x16_bf16 v[32:47], v[92:95], a[204:207], v[32:47]
  ds_read_b64_tr_b16 v[92:93], v11 offset:19456
  ds_read_b64_tr_b16 v[94:95], v11 offset:19712
  s_waitcnt lgkmcnt(6)
  v_mfma_f32_32x32x16_bf16 v[16:31], v[80:83], a[64:67], v[16:31]
  v_mfma_f32_32x32x16_bf16 v[32:47], v[80:83], a[208:211], v[32:47]
  s_add_u32 m0, s24, 3072
  s_nop 0
  buffer_load_dwordx4 v10, s[8:11], s41 offen lds
  s_add_u32 s41, s41, s16
  ds_read_b64_tr_b16 v[80:81], v11 offset:20480
  ds_read_b64_tr_b16 v[82:83], v11 offset:20736
  s_waitcnt lgkmcnt(6)
  v_mfma_f32_32x32x16_bf16 v[16:31], v[84:87], a[68:71], v[16:31]
  v_mfma_f32_32x32x16_bf16 v[32:47], v[84:87], a[212:215], v[32:47]
  ds_read_b64_tr_b16 v[84:85], v11 offset:21504
  ds_read_b64_tr_b16 v[86:87], v11 offset:21760
  s_waitcnt lgkmcnt(6)
  v_mfma_f32_32x32x16_bf16 v[16:31], v[88:91], a[72:75], v[16:31]
  s_add_u32 m0, s24, 4096
  s_nop 0
  buffer_load_dwordx4 v10, s[8:11], s41 offen lds
  s_add_u32 s41, s41, s16
  v_mfma_f32_32x32x16_bf16 v[32:47], v[88:91], a[216:219], v[32:47]
  ds_read_b64_tr_b16 v[88:89], v11 offset:22528
  ds_read_b64_tr_b16 v[90:91], v11 offset:22784
  s_waitcnt lgkmcnt(6)
  v_mfma_f32_32x32x16_bf16 v[16:31], v[92:95], a[76:79], v[16:31]
  v_mfma_f32_32x32x16_bf16 v[32:47], v[92:95], a[220:223], v[32:47]
  s_add_u32 m0, s24, 5120
  s_nop 0
  buffer_load_dwordx4 v10, s[8:11], s41 offen lds
  s_add_u32 s41, s41, s16
  ds_read_b64_tr_b16 v[92:93], v11 offset:23552
  ds_read_b64_tr_b16 v[94:95], v11 offset:23808
  s_waitcnt lgkmcnt(6)
  v_mfma_f32_32x32x16_bf16 v[16:31], v[80:83], a[80:83], v[16:31]
  v_mfma_f32_32x32x16_bf16 v[32:47], v[80:83], a[224:227], v[32:47]
  ds_read_b64_tr_b16 v[80:81], v11 offset:24576
  ds_read_b64_tr_b16 v[82:83], v11 offset:24832
  s_waitcnt lgkmcnt(6)
  v_mfma_f32_32x32x16_bf16 v[16:31], v[84:87], a[84:87], v[16:31]
  s_add_u32 m0, s24, 6144
  s_nop 0
  buffer_load_dwordx4 v10, s[8:11], s41 offen lds
  s_add_u32 s41, s41, s16
  v_mfma_f32_32x32x16_bf16 v[32:47], v[84:87], a[228:231], v[32:47]
  ds_read_b64_tr_b16 v[84:85], v11 offset:25600
  ds_read_b64_tr_b16 v[86:87], v11 offset:25856
  s_waitcnt lgkmcnt(6)
  v_mfma_f32_32x32x16_bf16 v[16:31], v[88:91], a[88:91], v[16:31]
  v_mfma_f32_32x32x16_bf16 v[32:47], v[88:91], a[232:235], v[32:47]
  s_add_u32 m0, s24, 7168
  s_nop 0
  buffer_load_dwordx4 v10, s[8:11], s41 offen lds
  s_add_u32 s41, s41, s16
  ds_read_b64_tr_b16 v[88:89], v11 offset:26624
  ds_read_b64_tr_b16 v[90:91], v11 offset:26880
  s_waitcnt lgkmcnt(6)
  v_mfma_f32_32x32x16_bf16 v[16:31], v[92:95], a[92:95], v[16:31]
  v_mfma_f32_32x32x16_bf16 v[32:47], v[92:95], a[236:239], v[32:47]
  ds_read_b64_tr_b16 v[92:93], v11 offset:27648
  ds_read_b64_tr_b16 v[94:95], v11 offset:27904
  s_waitcnt lgkmcnt(6)
  v_mfma_f32_32x32x16_bf16 v[16:31], v[80:83], a[96:99], v[16:31]
  s_add_u32 m0, s24, 8192
  s_nop 0
  buffer_load_dwordx4 v10, s[8:11], s41 offen lds
  s_add_u32 s41, s41, s16
  v_mfma_f32_32x32x16_bf16 v[32:47], v[80:83], a[240:243], v[32:47]
  s_add_u32 s38, s38, 1
  ds_read_b64_tr_b16 v[80:81], v11 offset:28672
  ds_read_b64_tr_b16 v[82:83], v11 offset:28928
  s_waitcnt lgkmcnt(6)
  v_mfma_f32_32x32x16_bf16 v[16:31], v[84:87], a[100:103], v[16:31]
  s_add_u32 s40, s40, 36864
  s_cmp_eq_u32 s40, 147456
  s_cselect_b32 s40, 0, s40
  v_mfma_f32_32x32x16_bf16 v[32:47], v[84:87], a[244:247], v[32:47]
  ds_read_b64_tr_b16 v[84:85], v11 offset:29696
  ds_read_b64_tr_b16 v[86:87], v11 offset:29952
  s_waitcnt lgkmcnt(6)
  v_mfma_f32_32x32x16_bf16 v[16:31], v[88:91], a[104:107], v[16:31]
  v_mfma_f32_32x32x16_bf16 v[32:47], v[88:91], a[248:251], v[32:47]
  ds_read_b64_tr_b16 v[88:89], v11 offset:30720
  ds_read_b64_tr_b16 v[90:91], v11 offset:30976
  s_waitcnt lgkmcnt(6)
  v_mfma_f32_32x32x16_bf16 v[16:31], v[92:95], a[108:111], v[16:31]
  v_mfma_f32_32x32x16_bf16 v[32:47], v[92:95], a[252:255], v[32:47]
  ds_read_b64_tr_b16 v[92:93], v11 offset:31744
  ds_read_b64_tr_b16 v[94:95], v11 offset:32000
  s_waitcnt lgkmcnt(6)
  v_mfma_f32_32x32x16_bf16 v[16:31], v[80:83], a[112:115], v[16:31]
  v_mfma_f32_32x32x16_bf16 v[32:47], v[80:83], v[224:227], v[32:47]
  ds_read_b64_tr_b16 v[80:81], v11 offset:32768
  ds_read_b64_tr_b16 v[82:83], v11 offset:33024
  s_waitcnt lgkmcnt(6)
  v_mfma_f32_32x32x16_bf16 v[16:31], v[84:87], a[116:119], v[16:31]
  v_mfma_f32_32x32x16_bf16 v[32:47], v[84:87], v[228:231], v[32:47]
  ds_read_b64_tr_b16 v[84:85], v11 offset:33792
  ds_read_b64_tr_b16 v[86:87], v11 offset:34048
  s_waitcnt lgkmcnt(6)
  v_mfma_f32_32x32x16_bf16 v[16:31], v[88:91], a[120:123], v[16:31]
  v_mfma_f32_32x32x16_bf16 v[32:47], v[88:91], v[232:235], v[32:47]
  ds_read_b64_tr_b16 v[88:89], v11 offset:34816
  ds_read_b64_tr_b16 v[90:91], v11 offset:35072
  s_waitcnt lgkmcnt(6)
  v_mfma_f32_32x32x16_bf16 v[16:31], v[92:95], a[124:127], v[16:31]
  v_mfma_f32_32x32x16_bf16 v[32:47], v[92:95], v[236:239], v[32:47]
  ds_read_b64_tr_b16 v[92:93], v11 offset:35840
  ds_read_b64_tr_b16 v[94:95], v11 offset:36096
  s_waitcnt lgkmcnt(6)
  v_mfma_f32_32x32x16_bf16 v[16:31], v[80:83], a[128:131], v[16:31]
  v_mfma_f32_32x32x16_bf16 v[32:47], v[80:83], v[240:243], v[32:47]
  s_waitcnt lgkmcnt(4)
  v_mfma_f32_32x32x16_bf16 v[16:31], v[84:87], a[132:135], v[16:31]
  v_mfma_f32_32x32x16_bf16 v[32:47], v[84:87], v[244:247], v[32:47]
  s_waitcnt lgkmcnt(2)
  v_mfma_f32_32x32x16_bf16 v[16:31], v[88:91], a[136:139], v[16:31]
  v_mfma_f32_32x32x16_bf16 v[32:47], v[88:91], v[248:251], v[32:47]
  s_waitcnt lgkmcnt(0)
  v_mfma_f32_32x32x16_bf16 v[16:31], v[92:95], a[140:143], v[16:31]
  v_mfma_f32_32x32x16_bf16 v[32:47], v[92:95], v[252:255], v[32:47]
  s_nop 10
  v_pk_mul_f32 v[16:17], v[16:17], s[50:51]
  v_pk_mul_f32 v[18:19], v[18:19], s[50:51]
  v_pk_mul_f32 v[20:21], v[20:21], s[50:51]
  v_pk_mul_f32 v[22:23], v[22:23], s[50:51]
  v_pk_mul_f32 v[24:25], v[24:25], s[50:51]
  v_pk_mul_f32 v[26:27], v[26:27], s[50:51]
  v_pk_mul_f32 v[28:29], v[28:29], s[50:51]
  v_pk_mul_f32 v[30:31], v[30:31], s[50:51]
  v_pk_mul_f32 v[32:33], v[32:33], s[50:51]
  v_pk_mul_f32 v[34:35], v[34:35], s[50:51]
  v_pk_mul_f32 v[36:37], v[36:37], s[50:51]
  v_pk_mul_f32 v[38:39], v[38:39], s[50:51]
  v_pk_mul_f32 v[40:41], v[40:41], s[50:51]
  v_pk_mul_f32 v[42:43], v[42:43], s[50:51]
  v_pk_mul_f32 v[44:45], v[44:45], s[50:51]
  v_pk_mul_f32 v[46:47], v[46:47], s[50:51]
  v_cvt_pk_bf16_f32 v96, v16, v17
  v_cvt_pk_bf16_f32 v97, v18, v19
  v_cvt_pk_bf16_f32 v98, v20, v21
  v_cvt_pk_bf16_f32 v99, v22, v23
  s_nop 0
  v_permlane32_swap_b32 v96, v98
  v_permlane32_swap_b32 v97, v99
  buffer_store_dwordx4 v[96:99], v5, s[4:7], s22 offen offset:0 sc1
  v_cvt_pk_bf16_f32 v100, v24, v25
  v_cvt_pk_bf16_f32 v101, v26, v27
  v_cvt_pk_bf16_f32 v102, v28, v29
  v_cvt_pk_bf16_f32 v103, v30, v31
  s_nop 0
  v_permlane32_swap_b32 v100, v102
  v_permlane32_swap_b32 v101, v103
  buffer_store_dwordx4 v[100:103], v5, s[4:7], s22 offen offset:512 sc1
  s_add_u32 s22, s22, 262144
  v_cvt_pk_bf16_f32 v104, v32, v33
  v_cvt_pk_bf16_f32 v105, v34, v35
  v_cvt_pk_bf16_f32 v106, v36, v37
  v_cvt_pk_bf16_f32 v107, v38, v39
  s_nop 0
  v_permlane32_swap_b32 v104, v106
  v_permlane32_swap_b32 v105, v107
  buffer_store_dwordx4 v[104:107], v5, s[4:7], s22 offen offset:0 sc1
  v_cvt_pk_bf16_f32 v108, v40, v41
  v_cvt_pk_bf16_f32 v109, v42, v43
  v_cvt_pk_bf16_f32 v110, v44, v45
  v_cvt_pk_bf16_f32 v111, v46, v47
  s_nop 0
  v_permlane32_swap_b32 v108, v110
  v_permlane32_swap_b32 v109, v111
  buffer_store_dwordx4 v[108:111], v5, s[4:7], s22 offen offset:512 sc1
  s_branch G1SEB
G1VB:
  s_add_u32 s22, s22, s42
  s_add_u32 s22, s22, 33554432
  ds_read_b64_tr_b16 v[80:81], v11 offset:0
  ds_read_b64_tr_b16 v[82:83], v11 offset:256
  ds_read_b64_tr_b16 v[84:85], v11 offset:1024
  ds_read_b64_tr_b16 v[86:87], v11 offset:1280
  ds_read_b64_tr_b16 v[88:89], v11 offset:2048
  ds_read_b64_tr_b16 v[90:91], v11 offset:2304
  ds_read_b64_tr_b16 v[92:93], v11 offset:3072
  ds_read_b64_tr_b16 v[94:95], v11 offset:3328
  s_waitcnt lgkmcnt(6)
  v_mfma_f32_32x32x16_bf16 v[16:31], a[0:3], v[80:83], 0
  v_mfma_f32_32x32x16_bf16 v[32:47], a[144:147], v[80:83], 0
  ds_read_b64_tr_b16 v[80:81], v11 offset:4096
  ds_read_b64_tr_b16 v[82:83], v11 offset:4352
  s_waitcnt lgkmcnt(6)
  v_mfma_f32_32x32x16_bf16 v[16:31], a[4:7], v[84:87], v[16:31]
  s_cmp_lt_u32 s38, s43
  s_cselect_b32 s24, s44, s45
  s_add_u32 s24, s24, s38
  v_mfma_f32_32x32x16_bf16 v[32:47], a[148:151], v[84:87], v[32:47]
  s_min_u32 s24, s24, 27
  ds_read_b64_tr_b16 v[84:85], v11 offset:5120
  ds_read_b64_tr_b16 v[86:87], v11 offset:5376
  s_waitcnt lgkmcnt(6)
  v_mfma_f32_32x32x16_bf16 v[16:31], a[8:11], v[88:91], v[16:31]
  s_mul_i32 s25, s24, 24
  v_mfma_f32_32x32x16_bf16 v[32:47], a[152:155], v[88:91], v[32:47]
  s_add_u32 s25, s25, s12
  ds_read_b64_tr_b16 v[88:89], v11 offset:6144
  ds_read_b64_tr_b16 v[90:91], v11 offset:6400
  s_waitcnt lgkmcnt(6)
  v_mfma_f32_32x32x16_bf16 v[16:31], a[12:15], v[92:95], v[16:31]
  s_lshr_b32 s26, s25, 7
  v_mfma_f32_32x32x16_bf16 v[32:47], a[156:159], v[92:95], v[32:47]
  s_and_b32 s25, s25, 127
  ds_read_b64_tr_b16 v[92:93], v11 offset:7168
  ds_read_b64_tr_b16 v[94:95], v11 offset:7424
  s_waitcnt lgkmcnt(6)
  v_mfma_f32_32x32x16_bf16 v[16:31], a[16:19], v[80:83], v[16:31]
  s_lshl_b32 s25, s25, 6
  v_mfma_f32_32x32x16_bf16 v[32:47], a[160:163], v[80:83], v[32:47]
  s_mul_i32 s41, s13, 1179648
  ds_read_b64_tr_b16 v[80:81], v11 offset:8192
  ds_read_b64_tr_b16 v[82:83], v11 offset:8448
  s_waitcnt lgkmcnt(6)
  v_mfma_f32_32x32x16_bf16 v[16:31], a[20:23], v[84:87], v[16:31]
  s_add_u32 s41, s41, s25
  v_mfma_f32_32x32x16_bf16 v[32:47], a[164:167], v[84:87], v[32:47]
  s_cmp_eq_u32 s26, 1
  s_cselect_b64 s[8:9], s[80:81], s[78:79]
  ds_read_b64_tr_b16 v[84:85], v11 offset:9216
  ds_read_b64_tr_b16 v[86:87], v11 offset:9472
  s_waitcnt lgkmcnt(6)
  v_mfma_f32_32x32x16_bf16 v[16:31], a[24:27], v[88:91], v[16:31]
  s_cmp_eq_u32 s26, 2
  s_cselect_b64 s[8:9], s[76:77], s[8:9]
  v_mfma_f32_32x32x16_bf16 v[32:47], a[168:171], v[88:91], v[32:47]
  s_sub_u32 s25, s24, 16
  ds_read_b64_tr_b16 v[88:89], v11 offset:10240
  ds_read_b64_tr_b16 v[90:91], v11 offset:10496
  s_waitcnt lgkmcnt(6)
  v_mfma_f32_32x32x16_bf16 v[16:31], a[28:31], v[92:95], v[16:31]
  s_lshr_b32 s26, s25, 1
  v_mfma_f32_32x32x16_bf16 v[32:47], a[172:175], v[92:95], v[32:47]
  s_mul_i32 s26, s26, 24
  ds_read_b64_tr_b16 v[92:93], v11 offset:11264
  ds_read_b64_tr_b16 v[94:95], v11 offset:11520
  s_waitcnt lgkmcnt(6)
  v_mfma_f32_32x32x16_bf16 v[16:31], a[32:35], v[80:83], v[16:31]
  s_add_u32 s26, s26, s12
  v_mfma_f32_32x32x16_bf16 v[32:47], a[176:179], v[80:83], v[32:47]
  s_lshl_b32 s26, s26, 6
  ds_read_b64_tr_b16 v[80:81], v11 offset:12288
  ds_read_b64_tr_b16 v[82:83], v11 offset:12544
  s_waitcnt lgkmcnt(6)
  v_mfma_f32_32x32x16_bf16 v[16:31], a[36:39], v[84:87], v[16:31]
  s_mul_i32 s27, s13, 1327104
  v_mfma_f32_32x32x16_bf16 v[32:47], a[180:183], v[84:87], v[32:47]
  s_add_u32 s26, s26, s27
  ds_read_b64_tr_b16 v[84:85], v11 offset:13312
  ds_read_b64_tr_b16 v[86:87], v11 offset:13568
  s_waitcnt lgkmcnt(6)
  v_mfma_f32_32x32x16_bf16 v[16:31], a[40:43], v[88:91], v[16:31]
  s_bitcmp1_b32 s25, 0
  s_cselect_b64 s[20:21], s[86:87], s[84:85]
  v_mfma_f32_32x32x16_bf16 v[32:47], a[184:187], v[88:91], v[32:47]
  s_cmp_ge_u32 s24, 16
  s_cselect_b64 s[8:9], s[20:21], s[8:9]
  s_cselect_b32 s41, s26, s41
  s_cselect_b32 s10, 5308416, s23
  s_cselect_b32 s16, 147456, s31
  s_cselect_b64 s[18:19], -1, 0
  ds_read_b64_tr_b16 v[88:89], v11 offset:14336
  ds_read_b64_tr_b16 v[90:91], v11 offset:14592
  s_waitcnt lgkmcnt(6)
  v_mfma_f32_32x32x16_bf16 v[16:31], a[44:47], v[92:95], v[16:31]
  v_cndmask_b32 v10, v2, v3, s[18:19]
  v_mfma_f32_32x32x16_bf16 v[32:47], a[188:191], v[92:95], v[32:47]
  s_add_u32 s24, s40, s30
  ds_read_b64_tr_b16 v[92:93], v11 offset:15360
  ds_read_b64_tr_b16 v[94:95], v11 offset:15616
  s_waitcnt lgkmcnt(6)
  v_mfma_f32_32x32x16_bf16 v[16:31], a[48:51], v[80:83], v[16:31]
  s_add_u32 m0, s24, 0
  s_nop 0
  buffer_load_dwordx4 v10, s[8:11], s41 offen lds
  s_add_u32 s41, s41, s16
  v_mfma_f32_32x32x16_bf16 v[32:47], a[192:195], v[80:83], v[32:47]
  ds_read_b64_tr_b16 v[80:81], v11 offset:16384
  ds_read_b64_tr_b16 v[82:83], v11 offset:16640
  s_waitcnt lgkmcnt(6)
  v_mfma_f32_32x32x16_bf16 v[16:31], a[52:55], v[84:87], v[16:31]
  v_mfma_f32_32x32x16_bf16 v[32:47], a[196:199], v[84:87], v[32:47]
  s_add_u32 m0, s24, 1024
  s_nop 0
  buffer_load_dwordx4 v10, s[8:11], s41 offen lds
  s_add_u32 s41, s41, s16
  ds_read_b64_tr_b16 v[84:85], v11 offset:17408
  ds_read_b64_tr_b16 v[86:87], v11 offset:17664
  s_waitcnt lgkmcnt(6)
  v_mfma_f32_32x32x16_bf16 v[16:31], a[56:59], v[88:91], v[16:31]
  v_mfma_f32_32x32x16_bf16 v[32:47], a[200:203], v[88:91], v[32:47]
  ds_read_b64_tr_b16 v[88:89], v11 offset:18432
  ds_read_b64_tr_b16 v[90:91], v11 offset:18688
  s_waitcnt lgkmcnt(6)
  v_mfma_f32_32x32x16_bf16 v[16:31], a[60:63], v[92:95], v[16:31]
  s_add_u32 m0, s24, 2048
  s_nop 0
  buffer_load_dwordx4 v10, s[8:11], s41 offen lds
  s_add_u32 s41, s41, s16
  v_mfma_f32_32x32x16_bf16 v[32:47], a[204:207], v[92:95], v[32:47]
  ds_read_b64_tr_b16 v[92:93], v11 offset:19456
  ds_read_b64_tr_b16 v[94:95], v11 offset:19712
  s_waitcnt lgkmcnt(6)
  v_mfma_f32_32x32x16_bf16 v[16:31], a[64:67], v[80:83], v[16:31]
  v_mfma_f32_32x32x16_bf16 v[32:47], a[208:211], v[80:83], v[32:47]
  s_add_u32 m0, s24, 3072
  s_nop 0
  buffer_load_dwordx4 v10, s[8:11], s41 offen lds
  s_add_u32 s41, s41, s16
  ds_read_b64_tr_b16 v[80:81], v11 offset:20480
  ds_read_b64_tr_b16 v[82:83], v11 offset:20736
  s_waitcnt lgkmcnt(6)
  v_mfma_f32_32x32x16_bf16 v[16:31], a[68:71], v[84:87], v[16:31]
  v_mfma_f32_32x32x16_bf16 v[32:47], a[212:215], v[84:87], v[32:47]
  ds_read_b64_tr_b16 v[84:85], v11 offset:21504
  ds_read_b64_tr_b16 v[86:87], v11 offset:21760
  s_waitcnt lgkmcnt(6)
  v_mfma_f32_32x32x16_bf16 v[16:31], a[72:75], v[88:91], v[16:31]
  s_add_u32 m0, s24, 4096
  s_nop 0
  buffer_load_dwordx4 v10, s[8:11], s41 offen lds
  s_add_u32 s41, s41, s16
  v_mfma_f32_32x32x16_bf16 v[32:47], a[216:219], v[88:91], v[32:47]
  ds_read_b64_tr_b16 v[88:89], v11 offset:22528
  ds_read_b64_tr_b16 v[90:91], v11 offset:22784
  s_waitcnt lgkmcnt(6)
  v_mfma_f32_32x32x16_bf16 v[16:31], a[76:79], v[92:95], v[16:31]
  v_mfma_f32_32x32x16_bf16 v[32:47], a[220:223], v[92:95], v[32:47]
  s_add_u32 m0, s24, 5120
  s_nop 0
  buffer_load_dwordx4 v10, s[8:11], s41 offen lds
  s_add_u32 s41, s41, s16
  ds_read_b64_tr_b16 v[92:93], v11 offset:23552
  ds_read_b64_tr_b16 v[94:95], v11 offset:23808
  s_waitcnt lgkmcnt(6)
  v_mfma_f32_32x32x16_bf16 v[16:31], a[80:83], v[80:83], v[16:31]
  v_mfma_f32_32x32x16_bf16 v[32:47], a[224:227], v[80:83], v[32:47]
  ds_read_b64_tr_b16 v[80:81], v11 offset:24576
  ds_read_b64_tr_b16 v[82:83], v11 offset:24832
  s_waitcnt lgkmcnt(6)
  v_mfma_f32_32x32x16_bf16 v[16:31], a[84:87], v[84:87], v[16:31]
  s_add_u32 m0, s24, 6144
  s_nop 0
  buffer_load_dwordx4 v10, s[8:11], s41 offen lds
  s_add_u32 s41, s41, s16
  v_mfma_f32_32x32x16_bf16 v[32:47], a[228:231], v[84:87], v[32:47]
  ds_read_b64_tr_b16 v[84:85], v11 offset:25600
  ds_read_b64_tr_b16 v[86:87], v11 offset:25856
  s_waitcnt lgkmcnt(6)
  v_mfma_f32_32x32x16_bf16 v[16:31], a[88:91], v[88:91], v[16:31]
  v_mfma_f32_32x32x16_bf16 v[32:47], a[232:235], v[88:91], v[32:47]
  s_add_u32 m0, s24, 7168
  s_nop 0
  buffer_load_dwordx4 v10, s[8:11], s41 offen lds
  s_add_u32 s41, s41, s16
  ds_read_b64_tr_b16 v[88:89], v11 offset:26624
  ds_read_b64_tr_b16 v[90:91], v11 offset:26880
  s_waitcnt lgkmcnt(6)
  v_mfma_f32_32x32x16_bf16 v[16:31], a[92:95], v[92:95], v[16:31]
  v_mfma_f32_32x32x16_bf16 v[32:47], a[236:239], v[92:95], v[32:47]
  ds_read_b64_tr_b16 v[92:93], v11 offset:27648
  ds_read_b64_tr_b16 v[94:95], v11 offset:27904
  s_waitcnt lgkmcnt(6)
  v_mfma_f32_32x32x16_bf16 v[16:31], a[96:99], v[80:83], v[16:31]
  s_add_u32 m0, s24, 8192
  s_nop 0
  buffer_load_dwordx4 v10, s[8:11], s41 offen lds
  s_add_u32 s41, s41, s16
  v_mfma_f32_32x32x16_bf16 v[32:47], a[240:243], v[80:83], v[32:47]
  s_add_u32 s38, s38, 1
  ds_read_b64_tr_b16 v[80:81], v11 offset:28672
  ds_read_b64_tr_b16 v[82:83], v11 offset:28928
  s_waitcnt lgkmcnt(6)
  v_mfma_f32_32x32x16_bf16 v[16:31], a[100:103], v[84:87], v[16:31]
  s_add_u32 s40, s40, 36864
  s_cmp_eq_u32 s40, 147456
  s_cselect_b32 s40, 0, s40
  v_mfma_f32_32x32x16_bf16 v[32:47], a[244:247], v[84:87], v[32:47]
  ds_read_b64_tr_b16 v[84:85], v11 offset:29696
  ds_read_b64_tr_b16 v[86:87], v11 offset:29952
  s_waitcnt lgkmcnt(6)
  v_mfma_f32_32x32x16_bf16 v[16:31], a[104:107], v[88:91], v[16:31]
  v_mfma_f32_32x32x16_bf16 v[32:47], a[248:251], v[88:91], v[32:47]
  ds_read_b64_tr_b16 v[88:89], v11 offset:30720
  ds_read_b64_tr_b16 v[90:91], v11 offset:30976
  s_waitcnt lgkmcnt(6)
  v_mfma_f32_32x32x16_bf16 v[16:31], a[108:111], v[92:95], v[16:31]
  v_mfma_f32_32x32x16_bf16 v[32:47], a[252:255], v[92:95], v[32:47]
  ds_read_b64_tr_b16 v[92:93], v11 offset:31744
  ds_read_b64_tr_b16 v[94:95], v11 offset:32000
  s_waitcnt lgkmcnt(6)
  v_mfma_f32_32x32x16_bf16 v[16:31], a[112:115], v[80:83], v[16:31]
  v_mfma_f32_32x32x16_bf16 v[32:47], v[224:227], v[80:83], v[32:47]
  ds_read_b64_tr_b16 v[80:81], v11 offset:32768
  ds_read_b64_tr_b16 v[82:83], v11 offset:33024
  s_waitcnt lgkmcnt(6)
  v_mfma_f32_32x32x16_bf16 v[16:31], a[116:119], v[84:87], v[16:31]
  v_mfma_f32_32x32x16_bf16 v[32:47], v[228:231], v[84:87], v[32:47]
  ds_read_b64_tr_b16 v[84:85], v11 offset:33792
  ds_read_b64_tr_b16 v[86:87], v11 offset:34048
  s_waitcnt lgkmcnt(6)
  v_mfma_f32_32x32x16_bf16 v[16:31], a[120:123], v[88:91], v[16:31]
  v_mfma_f32_32x32x16_bf16 v[32:47], v[232:235], v[88:91], v[32:47]
  ds_read_b64_tr_b16 v[88:89], v11 offset:34816
  ds_read_b64_tr_b16 v[90:91], v11 offset:35072
  s_waitcnt lgkmcnt(6)
  v_mfma_f32_32x32x16_bf16 v[16:31], a[124:127], v[92:95], v[16:31]
  v_mfma_f32_32x32x16_bf16 v[32:47], v[236:239], v[92:95], v[32:47]
  ds_read_b64_tr_b16 v[92:93], v11 offset:35840
  ds_read_b64_tr_b16 v[94:95], v11 offset:36096
  s_waitcnt lgkmcnt(6)
  v_mfma_f32_32x32x16_bf16 v[16:31], a[128:131], v[80:83], v[16:31]
  v_mfma_f32_32x32x16_bf16 v[32:47], v[240:243], v[80:83], v[32:47]
  s_waitcnt lgkmcnt(4)
  v_mfma_f32_32x32x16_bf16 v[16:31], a[132:135], v[84:87], v[16:31]
  v_mfma_f32_32x32x16_bf16 v[32:47], v[244:247], v[84:87], v[32:47]
  s_waitcnt lgkmcnt(2)
  v_mfma_f32_32x32x16_bf16 v[16:31], a[136:139], v[88:91], v[16:31]
  v_mfma_f32_32x32x16_bf16 v[32:47], v[248:251], v[88:91], v[32:47]
  s_waitcnt lgkmcnt(0)
  v_mfma_f32_32x32x16_bf16 v[16:31], a[140:143], v[92:95], v[16:31]
  v_mfma_f32_32x32x16_bf16 v[32:47], v[252:255], v[92:95], v[32:47]
  s_nop 10
  v_cvt_pk_bf16_f32 v96, v16, v17
  v_cvt_pk_bf16_f32 v97, v18, v19
  v_cvt_pk_bf16_f32 v98, v24, v25
  v_cvt_pk_bf16_f32 v99, v26, v27
  buffer_store_dwordx4 v[96:99], v6, s[4:7], s22 offen offset:0 sc1
  v_cvt_pk_bf16_f32 v100, v20, v21
  v_cvt_pk_bf16_f32 v101, v22, v23
  v_cvt_pk_bf16_f32 v102, v28, v29
  v_cvt_pk_bf16_f32 v103, v30, v31
  buffer_store_dwordx4 v[100:103], v6, s[4:7], s22 offen offset:512 sc1
  s_add_u32 s22, s22, 262144
  v_cvt_pk_bf16_f32 v104, v32, v33
  v_cvt_pk_bf16_f32 v105, v34, v35
  v_cvt_pk_bf16_f32 v106, v40, v41
  v_cvt_pk_bf16_f32 v107, v42, v43
  buffer_store_dwordx4 v[104:107], v6, s[4:7], s22 offen offset:0 sc1
  v_cvt_pk_bf16_f32 v108, v36, v37
  v_cvt_pk_bf16_f32 v109, v38, v39
  v_cvt_pk_bf16_f32 v110, v44, v45
  v_cvt_pk_bf16_f32 v111, v46, v47
  buffer_store_dwordx4 v[108:111], v6, s[4:7], s22 offen offset:512 sc1
G1SEB:
  s_add_u32 s46, s46, 1
  s_cmp_lg_u32 s46, s49
  s_cbranch_scc1 G1F2
  s_waitcnt vmcnt(0)
  s_barrier
  s_cmp_lg_u32 s13, 0
  s_cbranch_scc1 SIG_9
  s_lshl_b32 s29, s47, 2
  s_add_u32 s29, s29, 96
  v_mov_b32 v8, s29
  v_mov_b32 v9, 1
  s_mov_b64 exec, 1
  global_atomic_add v8, v9, s[92:93]
  s_mov_b64 exec, -1
SIG_9:
G1F2:
  s_cmp_lt_u32 s46, s48
  s_cbranch_scc1 G1S
  s_waitcnt vmcnt(0)
  s_barrier
  s_cmp_lg_u32 s13, 0
  s_cbranch_scc1 SIG_10
  s_lshl_b32 s29, s14, 2
  s_add_u32 s29, s29, 128
  v_mov_b32 v8, s29
  v_mov_b32 v9, 1
  s_mov_b64 exec, 1
  global_atomic_add v8, v9, s[92:93]
  s_mov_b64 exec, -1
SIG_10:
  s_mov_b32 s15, 0
G1G:
  s_waitcnt vmcnt(18)
  s_barrier
  v_add_u32 v11, s39, v4
  s_add_u32 s39, s39, 36864
  s_cmp_eq_u32 s39, 147456
  s_cselect_b32 s39, 0, s39
  ds_read_b64_tr_b16 v[80:81], v11 offset:0
  ds_read_b64_tr_b16 v[82:83], v11 offset:256
  ds_read_b64_tr_b16 v[84:85], v11 offset:1024
  ds_read_b64_tr_b16 v[86:87], v11 offset:1280
  ds_read_b64_tr_b16 v[88:89], v11 offset:2048
  ds_read_b64_tr_b16 v[90:91], v11 offset:2304
  ds_read_b64_tr_b16 v[92:93], v11 offset:3072
  ds_read_b64_tr_b16 v[94:95], v11 offset:3328
  s_waitcnt lgkmcnt(6)
  v_mfma_f32_32x32x16_bf16 v[16:31], v[80:83], a[0:3], 0
  v_mfma_f32_32x32x16_bf16 v[32:47], v[80:83], a[144:147], 0
  ds_read_b64_tr_b16 v[80:81], v11 offset:4096
  ds_read_b64_tr_b16 v[82:83], v11 offset:4352
  s_waitcnt lgkmcnt(6)
  v_mfma_f32_32x32x16_bf16 v[16:31], v[84:87], a[4:7], v[16:31]
  s_cmp_lt_u32 s38, s43
  s_cselect_b32 s24, s44, s45
  s_add_u32 s24, s24, s38
  v_mfma_f32_32x32x16_bf16 v[32:47], v[84:87], a[148:151], v[32:47]
  s_min_u32 s24, s24, 27
  ds_read_b64_tr_b16 v[84:85], v11 offset:5120
  ds_read_b64_tr_b16 v[86:87], v11 offset:5376
  s_waitcnt lgkmcnt(6)
  v_mfma_f32_32x32x16_bf16 v[16:31], v[88:91], a[8:11], v[16:31]
  s_mul_i32 s25, s24, 24
  v_mfma_f32_32x32x16_bf16 v[32:47], v[88:91], a[152:155], v[32:47]
  s_add_u32 s25, s25, s12
  ds_read_b64_tr_b16 v[88:89], v11 offset:6144
  ds_read_b64_tr_b16 v[90:91], v11 offset:6400
  s_waitcnt lgkmcnt(6)
  v_mfma_f32_32x32x16_bf16 v[16:31], v[92:95], a[12:15], v[16:31]
  s_lshr_b32 s26, s25, 7
  v_mfma_f32_32x32x16_bf16 v[32:47], v[92:95], a[156:159], v[32:47]
  s_and_b32 s25, s25, 127
  ds_read_b64_tr_b16 v[92:93], v11 offset:7168
  ds_read_b64_tr_b16 v[94:95], v11 offset:7424
  s_waitcnt lgkmcnt(6)
  v_mfma_f32_32x32x16_bf16 v[16:31], v[80:83], a[16:19], v[16:31]
  s_lshl_b32 s25, s25, 6
  v_mfma_f32_32x32x16_bf16 v[32:47], v[80:83], a[160:163], v[32:47]
  s_mul_i32 s41, s13, 1179648
  ds_read_b64_tr_b16 v[80:81], v11 offset:8192
  ds_read_b64_tr_b16 v[82:83], v11 offset:8448
  s_waitcnt lgkmcnt(6)
  v_mfma_f32_32x32x16_bf16 v[16:31], v[84:87], a[20:23], v[16:31]
  s_add_u32 s41, s41, s25
  v_mfma_f32_32x32x16_bf16 v[32:47], v[84:87], a[164:167], v[32:47]
  s_cmp_eq_u32 s26, 1
  s_cselect_b64 s[8:9], s[80:81], s[78:79]
  ds_read_b64_tr_b16 v[84:85], v11 offset:9216
  ds_read_b64_tr_b16 v[86:87], v11 offset:9472
  s_waitcnt lgkmcnt(6)
  v_mfma_f32_32x32x16_bf16 v[16:31], v[88:91], a[24:27], v[16:31]
  s_cmp_eq_u32 s26, 2
  s_cselect_b64 s[8:9], s[76:77], s[8:9]
  v_mfma_f32_32x32x16_bf16 v[32:47], v[88:91], a[168:171], v[32:47]
  s_sub_u32 s25, s24, 16
  ds_read_b64_tr_b16 v[88:89], v11 offset:10240
  ds_read_b64_tr_b16 v[90:91], v11 offset:10496
  s_waitcnt lgkmcnt(6)
  v_mfma_f32_32x32x16_bf16 v[16:31], v[92:95], a[28:31], v[16:31]
  s_lshr_b32 s26, s25, 1
  v_mfma_f32_32x32x16_bf16 v[32:47], v[92:95], a[172:175], v[32:47]
  s_mul_i32 s26, s26, 24
  ds_read_b64_tr_b16 v[92:93], v11 offset:11264
  ds_read_b64_tr_b16 v[94:95], v11 offset:11520
  s_waitcnt lgkmcnt(6)
  v_mfma_f32_32x32x16_bf16 v[16:31], v[80:83], a[32:35], v[16:31]
  s_add_u32 s26, s26, s12
  v_mfma_f32_32x32x16_bf16 v[32:47], v[80:83], a[176:179], v[32:47]
  s_lshl_b32 s26, s26, 6
  ds_read_b64_tr_b16 v[80:81], v11 offset:12288
  ds_read_b64_tr_b16 v[82:83], v11 offset:12544
  s_waitcnt lgkmcnt(6)
  v_mfma_f32_32x32x16_bf16 v[16:31], v[84:87], a[36:39], v[16:31]
  s_mul_i32 s27, s13, 1327104
  v_mfma_f32_32x32x16_bf16 v[32:47], v[84:87], a[180:183], v[32:47]
  s_add_u32 s26, s26, s27
  ds_read_b64_tr_b16 v[84:85], v11 offset:13312
  ds_read_b64_tr_b16 v[86:87], v11 offset:13568
  s_waitcnt lgkmcnt(6)
  v_mfma_f32_32x32x16_bf16 v[16:31], v[88:91], a[40:43], v[16:31]
  s_bitcmp1_b32 s25, 0
  s_cselect_b64 s[20:21], s[86:87], s[84:85]
  v_mfma_f32_32x32x16_bf16 v[32:47], v[88:91], a[184:187], v[32:47]
  s_cmp_ge_u32 s24, 16
  s_cselect_b64 s[8:9], s[20:21], s[8:9]
  s_cselect_b32 s41, s26, s41
  s_cselect_b32 s10, 5308416, s23
  s_cselect_b32 s16, 147456, s31
  s_cselect_b64 s[18:19], -1, 0
  ds_read_b64_tr_b16 v[88:89], v11 offset:14336
  ds_read_b64_tr_b16 v[90:91], v11 offset:14592
  s_waitcnt lgkmcnt(6)
  v_mfma_f32_32x32x16_bf16 v[16:31], v[92:95], a[44:47], v[16:31]
  v_cndmask_b32 v10, v2, v3, s[18:19]
  v_mfma_f32_32x32x16_bf16 v[32:47], v[92:95], a[188:191], v[32:47]
  s_add_u32 s24, s40, s30
  ds_read_b64_tr_b16 v[92:93], v11 offset:15360
  ds_read_b64_tr_b16 v[94:95], v11 offset:15616
  s_waitcnt lgkmcnt(6)
  v_mfma_f32_32x32x16_bf16 v[16:31], v[80:83], a[48:51], v[16:31]
  s_add_u32 m0, s24, 0
  s_nop 0
  buffer_load_dwordx4 v10, s[8:11], s41 offen lds
  s_add_u32 s41, s41, s16
  v_mfma_f32_32x32x16_bf16 v[32:47], v[80:83], a[192:195], v[32:47]
  ds_read_b64_tr_b16 v[80:81], v11 offset:16384
  ds_read_b64_tr_b16 v[82:83], v11 offset:16640
  s_waitcnt lgkmcnt(6)
  v_mfma_f32_32x32x16_bf16 v[16:31], v[84:87], a[52:55], v[16:31]
  v_mfma_f32_32x32x16_bf16 v[32:47], v[84:87], a[196:199], v[32:47]
  s_add_u32 m0, s24, 1024
  s_nop 0
  buffer_load_dwordx4 v10, s[8:11], s41 offen lds
  s_add_u32 s41, s41, s16
  ds_read_b64_tr_b16 v[84:85], v11 offset:17408
  ds_read_b64_tr_b16 v[86:87], v11 offset:17664
  s_waitcnt lgkmcnt(6)
  v_mfma_f32_32x32x16_bf16 v[16:31], v[88:91], a[56:59], v[16:31]
  v_mfma_f32_32x32x16_bf16 v[32:47], v[88:91], a[200:203], v[32:47]
  ds_read_b64_tr_b16 v[88:89], v11 offset:18432
  ds_read_b64_tr_b16 v[90:91], v11 offset:18688
  s_waitcnt lgkmcnt(6)
  v_mfma_f32_32x32x16_bf16 v[16:31], v[92:95], a[60:63], v[16:31]
  s_add_u32 m0, s24, 2048
  s_nop 0
  buffer_load_dwordx4 v10, s[8:11], s41 offen lds
  s_add_u32 s41, s41, s16
  v_mfma_f32_32x32x16_bf16 v[32:47], v[92:95], a[204:207], v[32:47]
  ds_read_b64_tr_b16 v[92:93], v11 offset:19456
  ds_read_b64_tr_b16 v[94:95], v11 offset:19712
  s_waitcnt lgkmcnt(6)
  v_mfma_f32_32x32x16_bf16 v[16:31], v[80:83], a[64:67], v[16:31]
  v_mfma_f32_32x32x16_bf16 v[32:47], v[80:83], a[208:211], v[32:47]
  s_add_u32 m0, s24, 3072
  s_nop 0
  buffer_load_dwordx4 v10, s[8:11], s41 offen lds
  s_add_u32 s41, s41, s16
  ds_read_b64_tr_b16 v[80:81], v11 offset:20480
  ds_read_b64_tr_b16 v[82:83], v11 offset:20736
  s_waitcnt lgkmcnt(6)
  v_mfma_f32_32x32x16_bf16 v[16:31], v[84:87], a[68:71], v[16:31]
  v_mfma_f32_32x32x16_bf16 v[32:47], v[84:87], a[212:215], v[32:47]
  ds_read_b64_tr_b16 v[84:85], v11 offset:21504
  ds_read_b64_tr_b16 v[86:87], v11 offset:21760
  s_waitcnt lgkmcnt(6)
  v_mfma_f32_32x32x16_bf16 v[16:31], v[88:91], a[72:75], v[16:31]
  s_add_u32 m0, s24, 4096
  s_nop 0
  buffer_load_dwordx4 v10, s[8:11], s41 offen lds
  s_add_u32 s41, s41, s16
  v_mfma_f32_32x32x16_bf16 v[32:47], v[88:91], a[216:219], v[32:47]
  ds_read_b64_tr_b16 v[88:89], v11 offset:22528
  ds_read_b64_tr_b16 v[90:91], v11 offset:22784
  s_waitcnt lgkmcnt(6)
  v_mfma_f32_32x32x16_bf16 v[16:31], v[92:95], a[76:79], v[16:31]
  v_mfma_f32_32x32x16_bf16 v[32:47], v[92:95], a[220:223], v[32:47]
  s_add_u32 m0, s24, 5120
  s_nop 0
  buffer_load_dwordx4 v10, s[8:11], s41 offen lds
  s_add_u32 s41, s41, s16
  ds_read_b64_tr_b16 v[92:93], v11 offset:23552
  ds_read_b64_tr_b16 v[94:95], v11 offset:23808
  s_waitcnt lgkmcnt(6)
  v_mfma_f32_32x32x16_bf16 v[16:31], v[80:83], a[80:83], v[16:31]
  v_mfma_f32_32x32x16_bf16 v[32:47], v[80:83], a[224:227], v[32:47]
  ds_read_b64_tr_b16 v[80:81], v11 offset:24576
  ds_read_b64_tr_b16 v[82:83], v11 offset:24832
  s_waitcnt lgkmcnt(6)
  v_mfma_f32_32x32x16_bf16 v[16:31], v[84:87], a[84:87], v[16:31]
  s_add_u32 m0, s24, 6144
  s_nop 0
  buffer_load_dwordx4 v10, s[8:11], s41 offen lds
  s_add_u32 s41, s41, s16
  v_mfma_f32_32x32x16_bf16 v[32:47], v[84:87], a[228:231], v[32:47]
  ds_read_b64_tr_b16 v[84:85], v11 offset:25600
  ds_read_b64_tr_b16 v[86:87], v11 offset:25856
  s_waitcnt lgkmcnt(6)
  v_mfma_f32_32x32x16_bf16 v[16:31], v[88:91], a[88:91], v[16:31]
  v_mfma_f32_32x32x16_bf16 v[32:47], v[88:91], a[232:235], v[32:47]
  s_add_u32 m0, s24, 7168
  s_nop 0
  buffer_load_dwordx4 v10, s[8:11], s41 offen lds
  s_add_u32 s41, s41, s16
  ds_read_b64_tr_b16 v[88:89], v11 offset:26624
  ds_read_b64_tr_b16 v[90:91], v11 offset:26880
  s_waitcnt lgkmcnt(6)
  v_mfma_f32_32x32x16_bf16 v[16:31], v[92:95], a[92:95], v[16:31]
  v_mfma_f32_32x32x16_bf16 v[32:47], v[92:95], a[236:239], v[32:47]
  ds_read_b64_tr_b16 v[92:93], v11 offset:27648
  ds_read_b64_tr_b16 v[94:95], v11 offset:27904
  s_waitcnt lgkmcnt(6)
  v_mfma_f32_32x32x16_bf16 v[16:31], v[80:83], a[96:99], v[16:31]
  s_add_u32 m0, s24, 8192
  s_nop 0
  buffer_load_dwordx4 v10, s[8:11], s41 offen lds
  s_add_u32 s41, s41, s16
  v_mfma_f32_32x32x16_bf16 v[32:47], v[80:83], a[240:243], v[32:47]
  s_add_u32 s38, s38, 1
  ds_read_b64_tr_b16 v[80:81], v11 offset:28672
  ds_read_b64_tr_b16 v[82:83], v11 offset:28928
  s_waitcnt lgkmcnt(6)
  v_mfma_f32_32x32x16_bf16 v[16:31], v[84:87], a[100:103], v[16:31]
  s_add_u32 s40, s40, 36864
  s_cmp_eq_u32 s40, 147456
  s_cselect_b32 s40, 0, s40
  v_mfma_f32_32x32x16_bf16 v[32:47], v[84:87], a[244:247], v[32:47]
  ds_read_b64_tr_b16 v[84:85], v11 offset:29696
  ds_read_b64_tr_b16 v[86:87], v11 offset:29952
  s_waitcnt lgkmcnt(6)
  v_mfma_f32_32x32x16_bf16 v[16:31], v[88:91], a[104:107], v[16:31]
  v_mfma_f32_32x32x16_bf16 v[32:47], v[88:91], a[248:251], v[32:47]
  ds_read_b64_tr_b16 v[88:89], v11 offset:30720
  ds_read_b64_tr_b16 v[90:91], v11 offset:30976
  s_waitcnt lgkmcnt(6)
  v_mfma_f32_32x32x16_bf16 v[16:31], v[92:95], a[108:111], v[16:31]
  v_mfma_f32_32x32x16_bf16 v[32:47], v[92:95], a[252:255], v[32:47]
  ds_read_b64_tr_b16 v[92:93], v11 offset:31744
  ds_read_b64_tr_b16 v[94:95], v11 offset:32000
  s_waitcnt lgkmcnt(6)
  v_mfma_f32_32x32x16_bf16 v[16:31], v[80:83], a[112:115], v[16:31]
  v_mfma_f32_32x32x16_bf16 v[32:47], v[80:83], v[224:227], v[32:47]
  ds_read_b64_tr_b16 v[80:81], v11 offset:32768
  ds_read_b64_tr_b16 v[82:83], v11 offset:33024
  s_waitcnt lgkmcnt(6)
  v_mfma_f32_32x32x16_bf16 v[16:31], v[84:87], a[116:119], v[16:31]
  v_mfma_f32_32x32x16_bf16 v[32:47], v[84:87], v[228:231], v[32:47]
  ds_read_b64_tr_b16 v[84:85], v11 offset:33792
  ds_read_b64_tr_b16 v[86:87], v11 offset:34048
  s_waitcnt lgkmcnt(6)
  v_mfma_f32_32x32x16_bf16 v[16:31], v[88:91], a[120:123], v[16:31]
  v_mfma_f32_32x32x16_bf16 v[32:47], v[88:91], v[232:235], v[32:47]
  ds_read_b64_tr_b16 v[88:89], v11 offset:34816
  ds_read_b64_tr_b16 v[90:91], v11 offset:35072
  s_waitcnt lgkmcnt(6)
  v_mfma_f32_32x32x16_bf16 v[16:31], v[92:95], a[124:127], v[16:31]
  v_mfma_f32_32x32x16_bf16 v[32:47], v[92:95], v[236:239], v[32:47]
  ds_read_b64_tr_b16 v[92:93], v11 offset:35840
  ds_read_b64_tr_b16 v[94:95], v11 offset:36096
  s_waitcnt lgkmcnt(6)
  v_mfma_f32_32x32x16_bf16 v[16:31], v[80:83], a[128:131], v[16:31]
  v_mfma_f32_32x32x16_bf16 v[32:47], v[80:83], v[240:243], v[32:47]
  s_waitcnt lgkmcnt(4)
  v_mfma_f32_32x32x16_bf16 v[16:31], v[84:87], a[132:135], v[16:31]
  v_mfma_f32_32x32x16_bf16 v[32:47], v[84:87], v[244:247], v[32:47]
  s_waitcnt lgkmcnt(2)
  v_mfma_f32_32x32x16_bf16 v[16:31], v[88:91], a[136:139], v[16:31]
  v_mfma_f32_32x32x16_bf16 v[32:47], v[88:91], v[248:251], v[32:47]
  s_waitcnt lgkmcnt(0)
  v_mfma_f32_32x32x16_bf16 v[16:31], v[92:95], a[140:143], v[16:31]
  v_mfma_f32_32x32x16_bf16 v[32:47], v[92:95], v[252:255], v[32:47]
  s_waitcnt vmcnt(18)
  s_barrier
  v_add_u32 v11, s39, v4
  s_add_u32 s39, s39, 36864
  s_cmp_eq_u32 s39, 147456
  s_cselect_b32 s39, 0, s39
  ds_read_b64_tr_b16 v[80:81], v11 offset:0
  ds_read_b64_tr_b16 v[82:83], v11 offset:256
  ds_read_b64_tr_b16 v[84:85], v11 offset:1024
  ds_read_b64_tr_b16 v[86:87], v11 offset:1280
  ds_read_b64_tr_b16 v[88:89], v11 offset:2048
  ds_read_b64_tr_b16 v[90:91], v11 offset:2304
  ds_read_b64_tr_b16 v[92:93], v11 offset:3072
  ds_read_b64_tr_b16 v[94:95], v11 offset:3328
  s_waitcnt lgkmcnt(6)
  v_mfma_f32_32x32x16_bf16 v[48:63], v[80:83], a[0:3], 0
  v_mfma_f32_32x32x16_bf16 v[64:79], v[80:83], a[144:147], 0
  ds_read_b64_tr_b16 v[80:81], v11 offset:4096
  ds_read_b64_tr_b16 v[82:83], v11 offset:4352
  s_waitcnt lgkmcnt(6)
  v_mfma_f32_32x32x16_bf16 v[48:63], v[84:87], a[4:7], v[48:63]
  s_cmp_lt_u32 s38, s43
  s_cselect_b32 s24, s44, s45
  s_add_u32 s24, s24, s38
  v_mfma_f32_32x32x16_bf16 v[64:79], v[84:87], a[148:151], v[64:79]
  s_min_u32 s24, s24, 27
  ds_read_b64_tr_b16 v[84:85], v11 offset:5120
  ds_read_b64_tr_b16 v[86:87], v11 offset:5376
  s_waitcnt lgkmcnt(6)
  v_mfma_f32_32x32x16_bf16 v[48:63], v[88:91], a[8:11], v[48:63]
  s_mul_i32 s25, s24, 24
  v_mfma_f32_32x32x16_bf16 v[64:79], v[88:91], a[152:155], v[64:79]
  s_add_u32 s25, s25, s12
  ds_read_b64_tr_b16 v[88:89], v11 offset:6144
  ds_read_b64_tr_b16 v[90:91], v11 offset:6400
  s_waitcnt lgkmcnt(6)
  v_mfma_f32_32x32x16_bf16 v[48:63], v[92:95], a[12:15], v[48:63]
  s_lshr_b32 s26, s25, 7
  v_mfma_f32_32x32x16_bf16 v[64:79], v[92:95], a[156:159], v[64:79]
  s_and_b32 s25, s25, 127
  ds_read_b64_tr_b16 v[92:93], v11 offset:7168
  ds_read_b64_tr_b16 v[94:95], v11 offset:7424
  s_waitcnt lgkmcnt(6)
  v_mfma_f32_32x32x16_bf16 v[48:63], v[80:83], a[16:19], v[48:63]
  s_lshl_b32 s25, s25, 6
  v_mfma_f32_32x32x16_bf16 v[64:79], v[80:83], a[160:163], v[64:79]
  s_mul_i32 s41, s13, 1179648
  ds_read_b64_tr_b16 v[80:81], v11 offset:8192
  ds_read_b64_tr_b16 v[82:83], v11 offset:8448
  s_waitcnt lgkmcnt(6)
  v_mfma_f32_32x32x16_bf16 v[48:63], v[84:87], a[20:23], v[48:63]
  s_add_u32 s41, s41, s25
  v_mfma_f32_32x32x16_bf16 v[64:79], v[84:87], a[164:167], v[64:79]
  s_cmp_eq_u32 s26, 1
  s_cselect_b64 s[8:9], s[80:81], s[78:79]
  ds_read_b64_tr_b16 v[84:85], v11 offset:9216
  ds_read_b64_tr_b16 v[86:87], v11 offset:9472
  s_waitcnt lgkmcnt(6)
  v_mfma_f32_32x32x16_bf16 v[48:63], v[88:91], a[24:27], v[48:63]
  s_cmp_eq_u32 s26, 2
  s_cselect_b64 s[8:9], s[76:77], s[8:9]
  v_mfma_f32_32x32x16_bf16 v[64:79], v[88:91], a[168:171], v[64:79]
  s_sub_u32 s25, s24, 16
  ds_read_b64_tr_b16 v[88:89], v11 offset:10240
  ds_read_b64_tr_b16 v[90:91], v11 offset:10496
  s_waitcnt lgkmcnt(6)
  v_mfma_f32_32x32x16_bf16 v[48:63], v[92:95], a[28:31], v[48:63]
  s_lshr_b32 s26, s25, 1
  v_mfma_f32_32x32x16_bf16 v[64:79], v[92:95], a[172:175], v[64:79]
  s_mul_i32 s26, s26, 24
  ds_read_b64_tr_b16 v[92:93], v11 offset:11264
  ds_read_b64_tr_b16 v[94:95], v11 offset:11520
  s_waitcnt lgkmcnt(6)
  v_mfma_f32_32x32x16_bf16 v[48:63], v[80:83], a[32:35], v[48:63]
  s_add_u32 s26, s26, s12
  v_mfma_f32_32x32x16_bf16 v[64:79], v[80:83], a[176:179], v[64:79]
  s_lshl_b32 s26, s26, 6
  ds_read_b64_tr_b16 v[80:81], v11 offset:12288
  ds_read_b64_tr_b16 v[82:83], v11 offset:12544
  s_waitcnt lgkmcnt(6)
  v_mfma_f32_32x32x16_bf16 v[48:63], v[84:87], a[36:39], v[48:63]
  s_mul_i32 s27, s13, 1327104
  v_mfma_f32_32x32x16_bf16 v[64:79], v[84:87], a[180:183], v[64:79]
  s_add_u32 s26, s26, s27
  ds_read_b64_tr_b16 v[84:85], v11 offset:13312
  ds_read_b64_tr_b16 v[86:87], v11 offset:13568
  s_waitcnt lgkmcnt(6)
  v_mfma_f32_32x32x16_bf16 v[48:63], v[88:91], a[40:43], v[48:63]
  s_bitcmp1_b32 s25, 0
  s_cselect_b64 s[20:21], s[86:87], s[84:85]
  v_mfma_f32_32x32x16_bf16 v[64:79], v[88:91], a[184:187], v[64:79]
  s_cmp_ge_u32 s24, 16
  s_cselect_b64 s[8:9], s[20:21], s[8:9]
  s_cselect_b32 s41, s26, s41
  s_cselect_b32 s10, 5308416, s23
  s_cselect_b32 s16, 147456, s31
  s_cselect_b64 s[18:19], -1, 0
  ds_read_b64_tr_b16 v[88:89], v11 offset:14336
  ds_read_b64_tr_b16 v[90:91], v11 offset:14592
  s_waitcnt lgkmcnt(6)
  v_mfma_f32_32x32x16_bf16 v[48:63], v[92:95], a[44:47], v[48:63]
  v_cndmask_b32 v10, v2, v3, s[18:19]
  v_mfma_f32_32x32x16_bf16 v[64:79], v[92:95], a[188:191], v[64:79]
  s_add_u32 s24, s40, s30
  ds_read_b64_tr_b16 v[92:93], v11 offset:15360
  ds_read_b64_tr_b16 v[94:95], v11 offset:15616
  s_waitcnt lgkmcnt(6)
  v_mfma_f32_32x32x16_bf16 v[48:63], v[80:83], a[48:51], v[48:63]
  s_add_u32 m0, s24, 0
  s_nop 0
  buffer_load_dwordx4 v10, s[8:11], s41 offen lds
  s_add_u32 s41, s41, s16
  v_mfma_f32_32x32x16_bf16 v[64:79], v[80:83], a[192:195], v[64:79]
  ds_read_b64_tr_b16 v[80:81], v11 offset:16384
  ds_read_b64_tr_b16 v[82:83], v11 offset:16640
  s_waitcnt lgkmcnt(6)
  v_mfma_f32_32x32x16_bf16 v[48:63], v[84:87], a[52:55], v[48:63]
  v_mfma_f32_32x32x16_bf16 v[64:79], v[84:87], a[196:199], v[64:79]
  s_add_u32 m0, s24, 1024
  s_nop 0
  buffer_load_dwordx4 v10, s[8:11], s41 offen lds
  s_add_u32 s41, s41, s16
  ds_read_b64_tr_b16 v[84:85], v11 offset:17408
  ds_read_b64_tr_b16 v[86:87], v11 offset:17664
  s_waitcnt lgkmcnt(6)
  v_mfma_f32_32x32x16_bf16 v[48:63], v[88:91], a[56:59], v[48:63]
  v_mfma_f32_32x32x16_bf16 v[64:79], v[88:91], a[200:203], v[64:79]
  ds_read_b64_tr_b16 v[88:89], v11 offset:18432
  ds_read_b64_tr_b16 v[90:91], v11 offset:18688
  s_waitcnt lgkmcnt(6)
  v_mfma_f32_32x32x16_bf16 v[48:63], v[92:95], a[60:63], v[48:63]
  s_add_u32 m0, s24, 2048
  s_nop 0
  buffer_load_dwordx4 v10, s[8:11], s41 offen lds
  s_add_u32 s41, s41, s16
  v_mfma_f32_32x32x16_bf16 v[64:79], v[92:95], a[204:207], v[64:79]
  ds_read_b64_tr_b16 v[92:93], v11 offset:19456
  ds_read_b64_tr_b16 v[94:95], v11 offset:19712
  s_waitcnt lgkmcnt(6)
  v_mfma_f32_32x32x16_bf16 v[48:63], v[80:83], a[64:67], v[48:63]
  v_mfma_f32_32x32x16_bf16 v[64:79], v[80:83], a[208:211], v[64:79]
  s_add_u32 m0, s24, 3072
  s_nop 0
  buffer_load_dwordx4 v10, s[8:11], s41 offen lds
  s_add_u32 s41, s41, s16
  ds_read_b64_tr_b16 v[80:81], v11 offset:20480
  ds_read_b64_tr_b16 v[82:83], v11 offset:20736
  s_waitcnt lgkmcnt(6)
  v_mfma_f32_32x32x16_bf16 v[48:63], v[84:87], a[68:71], v[48:63]
  v_mfma_f32_32x32x16_bf16 v[64:79], v[84:87], a[212:215], v[64:79]
  ds_read_b64_tr_b16 v[84:85], v11 offset:21504
  ds_read_b64_tr_b16 v[86:87], v11 offset:21760
  s_waitcnt lgkmcnt(6)
  v_mfma_f32_32x32x16_bf16 v[48:63], v[88:91], a[72:75], v[48:63]
  s_add_u32 m0, s24, 4096
  s_nop 0
  buffer_load_dwordx4 v10, s[8:11], s41 offen lds
  s_add_u32 s41, s41, s16
  v_mfma_f32_32x32x16_bf16 v[64:79], v[88:91], a[216:219], v[64:79]
  ds_read_b64_tr_b16 v[88:89], v11 offset:22528
  ds_read_b64_tr_b16 v[90:91], v11 offset:22784
  s_waitcnt lgkmcnt(6)
  v_mfma_f32_32x32x16_bf16 v[48:63], v[92:95], a[76:79], v[48:63]
  v_mfma_f32_32x32x16_bf16 v[64:79], v[92:95], a[220:223], v[64:79]
  s_add_u32 m0, s24, 5120
  s_nop 0
  buffer_load_dwordx4 v10, s[8:11], s41 offen lds
  s_add_u32 s41, s41, s16
  ds_read_b64_tr_b16 v[92:93], v11 offset:23552
  ds_read_b64_tr_b16 v[94:95], v11 offset:23808
  s_waitcnt lgkmcnt(6)
  v_mfma_f32_32x32x16_bf16 v[48:63], v[80:83], a[80:83], v[48:63]
  v_mfma_f32_32x32x16_bf16 v[64:79], v[80:83], a[224:227], v[64:79]
  ds_read_b64_tr_b16 v[80:81], v11 offset:24576
  ds_read_b64_tr_b16 v[82:83], v11 offset:24832
  s_waitcnt lgkmcnt(6)
  v_mfma_f32_32x32x16_bf16 v[48:63], v[84:87], a[84:87], v[48:63]
  s_add_u32 m0, s24, 6144
  s_nop 0
  buffer_load_dwordx4 v10, s[8:11], s41 offen lds
  s_add_u32 s41, s41, s16
  v_mfma_f32_32x32x16_bf16 v[64:79], v[84:87], a[228:231], v[64:79]
  ds_read_b64_tr_b16 v[84:85], v11 offset:25600
  ds_read_b64_tr_b16 v[86:87], v11 offset:25856
  s_waitcnt lgkmcnt(6)
  v_mfma_f32_32x32x16_bf16 v[48:63], v[88:91], a[88:91], v[48:63]
  v_mfma_f32_32x32x16_bf16 v[64:79], v[88:91], a[232:235], v[64:79]
  s_add_u32 m0, s24, 7168
  s_nop 0
  buffer_load_dwordx4 v10, s[8:11], s41 offen lds
  s_add_u32 s41, s41, s16
  ds_read_b64_tr_b16 v[88:89], v11 offset:26624
  ds_read_b64_tr_b16 v[90:91], v11 offset:26880
  s_waitcnt lgkmcnt(6)
  v_mfma_f32_32x32x16_bf16 v[48:63], v[92:95], a[92:95], v[48:63]
  v_mfma_f32_32x32x16_bf16 v[64:79], v[92:95], a[236:239], v[64:79]
  ds_read_b64_tr_b16 v[92:93], v11 offset:27648
  ds_read_b64_tr_b16 v[94:95], v11 offset:27904
  s_waitcnt lgkmcnt(6)
  v_mfma_f32_32x32x16_bf16 v[48:63], v[80:83], a[96:99], v[48:63]
  s_add_u32 m0, s24, 8192
  s_nop 0
  buffer_load_dwordx4 v10, s[8:11], s41 offen lds
  s_add_u32 s41, s41, s16
  v_mfma_f32_32x32x16_bf16 v[64:79], v[80:83], a[240:243], v[64:79]
  s_add_u32 s38, s38, 1
  ds_read_b64_tr_b16 v[80:81], v11 offset:28672
  ds_read_b64_tr_b16 v[82:83], v11 offset:28928
  s_waitcnt lgkmcnt(6)
  v_mfma_f32_32x32x16_bf16 v[48:63], v[84:87], a[100:103], v[48:63]
  s_add_u32 s40, s40, 36864
  s_cmp_eq_u32 s40, 147456
  s_cselect_b32 s40, 0, s40
  v_mfma_f32_32x32x16_bf16 v[64:79], v[84:87], a[244:247], v[64:79]
  ds_read_b64_tr_b16 v[84:85], v11 offset:29696
  ds_read_b64_tr_b16 v[86:87], v11 offset:29952
  s_waitcnt lgkmcnt(6)
  v_mfma_f32_32x32x16_bf16 v[48:63], v[88:91], a[104:107], v[48:63]
  v_mfma_f32_32x32x16_bf16 v[64:79], v[88:91], a[248:251], v[64:79]
  ds_read_b64_tr_b16 v[88:89], v11 offset:30720
  ds_read_b64_tr_b16 v[90:91], v11 offset:30976
  s_waitcnt lgkmcnt(6)
  v_mfma_f32_32x32x16_bf16 v[48:63], v[92:95], a[108:111], v[48:63]
  v_mfma_f32_32x32x16_bf16 v[64:79], v[92:95], a[252:255], v[64:79]
  ds_read_b64_tr_b16 v[92:93], v11 offset:31744
  ds_read_b64_tr_b16 v[94:95], v11 offset:32000
  s_waitcnt lgkmcnt(6)
  v_mfma_f32_32x32x16_bf16 v[48:63], v[80:83], a[112:115], v[48:63]
  v_mfma_f32_32x32x16_bf16 v[64:79], v[80:83], v[224:227], v[64:79]
  ds_read_b64_tr_b16 v[80:81], v11 offset:32768
  ds_read_b64_tr_b16 v[82:83], v11 offset:33024
  s_waitcnt lgkmcnt(6)
  v_mfma_f32_32x32x16_bf16 v[48:63], v[84:87], a[116:119], v[48:63]
  v_mfma_f32_32x32x16_bf16 v[64:79], v[84:87], v[228:231], v[64:79]
  ds_read_b64_tr_b16 v[84:85], v11 offset:33792
  ds_read_b64_tr_b16 v[86:87], v11 offset:34048
  s_waitcnt lgkmcnt(6)
  v_mfma_f32_32x32x16_bf16 v[48:63], v[88:91], a[120:123], v[48:63]
  v_mfma_f32_32x32x16_bf16 v[64:79], v[88:91], v[232:235], v[64:79]
  ds_read_b64_tr_b16 v[88:89], v11 offset:34816
  ds_read_b64_tr_b16 v[90:91], v11 offset:35072
  s_waitcnt lgkmcnt(6)
  v_mfma_f32_32x32x16_bf16 v[48:63], v[92:95], a[124:127], v[48:63]
  v_mfma_f32_32x32x16_bf16 v[64:79], v[92:95], v[236:239], v[64:79]
  ds_read_b64_tr_b16 v[92:93], v11 offset:35840
  ds_read_b64_tr_b16 v[94:95], v11 offset:36096
  s_waitcnt lgkmcnt(6)
  v_mfma_f32_32x32x16_bf16 v[48:63], v[80:83], a[128:131], v[48:63]
  v_mfma_f32_32x32x16_bf16 v[64:79], v[80:83], v[240:243], v[64:79]
  s_waitcnt lgkmcnt(4)
  v_mfma_f32_32x32x16_bf16 v[48:63], v[84:87], a[132:135], v[48:63]
  v_mfma_f32_32x32x16_bf16 v[64:79], v[84:87], v[244:247], v[64:79]
  s_waitcnt lgkmcnt(2)
  v_mfma_f32_32x32x16_bf16 v[48:63], v[88:91], a[136:139], v[48:63]
  v_mfma_f32_32x32x16_bf16 v[64:79], v[88:91], v[248:251], v[64:79]
  s_waitcnt lgkmcnt(0)
  v_mfma_f32_32x32x16_bf16 v[48:63], v[92:95], a[140:143], v[48:63]
  v_mfma_f32_32x32x16_bf16 v[64:79], v[92:95], v[252:255], v[64:79]
  s_lshl_b32 s22, s14, 3
  s_lshl_b32 s29, s13, 1
  s_add_u32 s22, s22, s29
  s_mul_i32 s22, s22, 294912
  s_mul_i32 s28, s15, 24
  s_add_u32 s28, s28, s12
  s_lshl_b32 s28, s28, 11
  s_add_u32 s22, s22, s28
  s_add_u32 s22, s22, 67108864
  v_pk_mul_f32 v[112:113], v[16:17], v[16:17]
  v_pk_mul_f32 v[114:115], v[18:19], v[18:19]
  v_pk_mul_f32 v[112:113], v[112:113], s[34:35]
  v_pk_mul_f32 v[114:115], v[114:115], s[34:35]
  v_pk_add_f32 v[112:113], v[112:113], s[32:33]
  v_pk_add_f32 v[114:115], v[114:115], s[32:33]
  v_pk_mul_f32 v[112:113], v[112:113], v[16:17]
  v_pk_mul_f32 v[114:115], v[114:115], v[18:19]
  v_exp_f32 v112, v112
  v_exp_f32 v113, v113
  v_exp_f32 v114, v114
  v_exp_f32 v115, v115
  v_pk_add_f32 v[112:113], v[112:113], s[36:37]
  v_pk_add_f32 v[114:115], v[114:115], s[36:37]
  v_rcp_f32 v112, v112
  v_rcp_f32 v113, v113
  v_rcp_f32 v114, v114
  v_rcp_f32 v115, v115
  v_pk_mul_f32 v[16:17], v[16:17], v[48:49]
  v_pk_mul_f32 v[18:19], v[18:19], v[50:51]
  v_pk_mul_f32 v[16:17], v[16:17], v[112:113]
  v_pk_mul_f32 v[18:19], v[18:19], v[114:115]
  v_pk_mul_f32 v[112:113], v[20:21], v[20:21]
  v_pk_mul_f32 v[114:115], v[22:23], v[22:23]
  v_pk_mul_f32 v[112:113], v[112:113], s[34:35]
  v_pk_mul_f32 v[114:115], v[114:115], s[34:35]
  v_pk_add_f32 v[112:113], v[112:113], s[32:33]
  v_pk_add_f32 v[114:115], v[114:115], s[32:33]
  v_pk_mul_f32 v[112:113], v[112:113], v[20:21]
  v_pk_mul_f32 v[114:115], v[114:115], v[22:23]
  v_exp_f32 v112, v112
  v_exp_f32 v113, v113
  v_exp_f32 v114, v114
  v_exp_f32 v115, v115
  v_pk_add_f32 v[112:113], v[112:113], s[36:37]
  v_pk_add_f32 v[114:115], v[114:115], s[36:37]
  v_rcp_f32 v112, v112
  v_rcp_f32 v113, v113
  v_rcp_f32 v114, v114
  v_rcp_f32 v115, v115
  v_pk_mul_f32 v[20:21], v[20:21], v[52:53]
  v_pk_mul_f32 v[22:23], v[22:23], v[54:55]
  v_pk_mul_f32 v[20:21], v[20:21], v[112:113]
  v_pk_mul_f32 v[22:23], v[22:23], v[114:115]
  v_pk_mul_f32 v[112:113], v[24:25], v[24:25]
  v_pk_mul_f32 v[114:115], v[26:27], v[26:27]
  v_pk_mul_f32 v[112:113], v[112:113], s[34:35]
  v_pk_mul_f32 v[114:115], v[114:115], s[34:35]
  v_pk_add_f32 v[112:113], v[112:113], s[32:33]
  v_pk_add_f32 v[114:115], v[114:115], s[32:33]
  v_pk_mul_f32 v[112:113], v[112:113], v[24:25]
  v_pk_mul_f32 v[114:115], v[114:115], v[26:27]
  v_exp_f32 v112, v112
  v_exp_f32 v113, v113
  v_exp_f32 v114, v114
  v_exp_f32 v115, v115
  v_pk_add_f32 v[112:113], v[112:113], s[36:37]
  v_pk_add_f32 v[114:115], v[114:115], s[36:37]
  v_rcp_f32 v112, v112
  v_rcp_f32 v113, v113
  v_rcp_f32 v114, v114
  v_rcp_f32 v115, v115
  v_pk_mul_f32 v[24:25], v[24:25], v[56:57]
  v_pk_mul_f32 v[26:27], v[26:27], v[58:59]
  v_pk_mul_f32 v[24:25], v[24:25], v[112:113]
  v_pk_mul_f32 v[26:27], v[26:27], v[114:115]
  v_pk_mul_f32 v[112:113], v[28:29], v[28:29]
  v_pk_mul_f32 v[114:115], v[30:31], v[30:31]
  v_pk_mul_f32 v[112:113], v[112:113], s[34:35]
  v_pk_mul_f32 v[114:115], v[114:115], s[34:35]
  v_pk_add_f32 v[112:113], v[112:113], s[32:33]
  v_pk_add_f32 v[114:115], v[114:115], s[32:33]
  v_pk_mul_f32 v[112:113], v[112:113], v[28:29]
  v_pk_mul_f32 v[114:115], v[114:115], v[30:31]
  v_exp_f32 v112, v112
  v_exp_f32 v113, v113
  v_exp_f32 v114, v114
  v_exp_f32 v115, v115
  v_pk_add_f32 v[112:113], v[112:113], s[36:37]
  v_pk_add_f32 v[114:115], v[114:115], s[36:37]
  v_rcp_f32 v112, v112
  v_rcp_f32 v113, v113
  v_rcp_f32 v114, v114
  v_rcp_f32 v115, v115
  v_pk_mul_f32 v[28:29], v[28:29], v[60:61]
  v_pk_mul_f32 v[30:31], v[30:31], v[62:63]
  v_pk_mul_f32 v[28:29], v[28:29], v[112:113]
  v_pk_mul_f32 v[30:31], v[30:31], v[114:115]
  v_cvt_pk_bf16_f32 v96, v16, v17
  v_cvt_pk_bf16_f32 v97, v18, v19
  v_cvt_pk_bf16_f32 v98, v20, v21
  v_cvt_pk_bf16_f32 v99, v22, v23
  s_nop 0
  v_permlane32_swap_b32 v96, v98
  v_permlane32_swap_b32 v97, v99
  buffer_store_dwordx4 v[96:99], v7, s[4:7], s22 offen offset:0 sc1
  v_cvt_pk_bf16_f32 v100, v24, v25
  v_cvt_pk_bf16_f32 v101, v26, v27
  v_cvt_pk_bf16_f32 v102, v28, v29
  v_cvt_pk_bf16_f32 v103, v30, v31
  s_nop 0
  v_permlane32_swap_b32 v100, v102
  v_permlane32_swap_b32 v101, v103
  buffer_store_dwordx4 v[100:103], v7, s[4:7], s22 offen offset:1024 sc1
  s_add_u32 s22, s22, 294912
  v_pk_mul_f32 v[112:113], v[32:33], v[32:33]
  v_pk_mul_f32 v[114:115], v[34:35], v[34:35]
  v_pk_mul_f32 v[112:113], v[112:113], s[34:35]
  v_pk_mul_f32 v[114:115], v[114:115], s[34:35]
  v_pk_add_f32 v[112:113], v[112:113], s[32:33]
  v_pk_add_f32 v[114:115], v[114:115], s[32:33]
  v_pk_mul_f32 v[112:113], v[112:113], v[32:33]
  v_pk_mul_f32 v[114:115], v[114:115], v[34:35]
  v_exp_f32 v112, v112
  v_exp_f32 v113, v113
  v_exp_f32 v114, v114
  v_exp_f32 v115, v115
  v_pk_add_f32 v[112:113], v[112:113], s[36:37]
  v_pk_add_f32 v[114:115], v[114:115], s[36:37]
  v_rcp_f32 v112, v112
  v_rcp_f32 v113, v113
  v_rcp_f32 v114, v114
  v_rcp_f32 v115, v115
  v_pk_mul_f32 v[32:33], v[32:33], v[64:65]
  v_pk_mul_f32 v[34:35], v[34:35], v[66:67]
  v_pk_mul_f32 v[32:33], v[32:33], v[112:113]
  v_pk_mul_f32 v[34:35], v[34:35], v[114:115]
  v_pk_mul_f32 v[112:113], v[36:37], v[36:37]
  v_pk_mul_f32 v[114:115], v[38:39], v[38:39]
  v_pk_mul_f32 v[112:113], v[112:113], s[34:35]
  v_pk_mul_f32 v[114:115], v[114:115], s[34:35]
  v_pk_add_f32 v[112:113], v[112:113], s[32:33]
  v_pk_add_f32 v[114:115], v[114:115], s[32:33]
  v_pk_mul_f32 v[112:113], v[112:113], v[36:37]
  v_pk_mul_f32 v[114:115], v[114:115], v[38:39]
  v_exp_f32 v112, v112
  v_exp_f32 v113, v113
  v_exp_f32 v114, v114
  v_exp_f32 v115, v115
  v_pk_add_f32 v[112:113], v[112:113], s[36:37]
  v_pk_add_f32 v[114:115], v[114:115], s[36:37]
  v_rcp_f32 v112, v112
  v_rcp_f32 v113, v113
  v_rcp_f32 v114, v114
  v_rcp_f32 v115, v115
  v_pk_mul_f32 v[36:37], v[36:37], v[68:69]
  v_pk_mul_f32 v[38:39], v[38:39], v[70:71]
  v_pk_mul_f32 v[36:37], v[36:37], v[112:113]
  v_pk_mul_f32 v[38:39], v[38:39], v[114:115]
  v_pk_mul_f32 v[112:113], v[40:41], v[40:41]
  v_pk_mul_f32 v[114:115], v[42:43], v[42:43]
  v_pk_mul_f32 v[112:113], v[112:113], s[34:35]
  v_pk_mul_f32 v[114:115], v[114:115], s[34:35]
  v_pk_add_f32 v[112:113], v[112:113], s[32:33]
  v_pk_add_f32 v[114:115], v[114:115], s[32:33]
  v_pk_mul_f32 v[112:113], v[112:113], v[40:41]
  v_pk_mul_f32 v[114:115], v[114:115], v[42:43]
  v_exp_f32 v112, v112
  v_exp_f32 v113, v113
  v_exp_f32 v114, v114
  v_exp_f32 v115, v115
  v_pk_add_f32 v[112:113], v[112:113], s[36:37]
  v_pk_add_f32 v[114:115], v[114:115], s[36:37]
  v_rcp_f32 v112, v112
  v_rcp_f32 v113, v113
  v_rcp_f32 v114, v114
  v_rcp_f32 v115, v115
  v_pk_mul_f32 v[40:41], v[40:41], v[72:73]
  v_pk_mul_f32 v[42:43], v[42:43], v[74:75]
  v_pk_mul_f32 v[40:41], v[40:41], v[112:113]
  v_pk_mul_f32 v[42:43], v[42:43], v[114:115]
  v_pk_mul_f32 v[112:113], v[44:45], v[44:45]
  v_pk_mul_f32 v[114:115], v[46:47], v[46:47]
  v_pk_mul_f32 v[112:113], v[112:113], s[34:35]
  v_pk_mul_f32 v[114:115], v[114:115], s[34:35]
  v_pk_add_f32 v[112:113], v[112:113], s[32:33]
  v_pk_add_f32 v[114:115], v[114:115], s[32:33]
  v_pk_mul_f32 v[112:113], v[112:113], v[44:45]
  v_pk_mul_f32 v[114:115], v[114:115], v[46:47]
  v_exp_f32 v112, v112
  v_exp_f32 v113, v113
  v_exp_f32 v114, v114
  v_exp_f32 v115, v115
  v_pk_add_f32 v[112:113], v[112:113], s[36:37]
  v_pk_add_f32 v[114:115], v[114:115], s[36:37]
  v_rcp_f32 v112, v112
  v_rcp_f32 v113, v113
  v_rcp_f32 v114, v114
  v_rcp_f32 v115, v115
  v_pk_mul_f32 v[44:45], v[44:45], v[76:77]
  v_pk_mul_f32 v[46:47], v[46:47], v[78:79]
  v_pk_mul_f32 v[44:45], v[44:45], v[112:113]
  v_pk_mul_f32 v[46:47], v[46:47], v[114:115]
  v_cvt_pk_bf16_f32 v104, v32, v33
  v_cvt_pk_bf16_f32 v105, v34, v35
  v_cvt_pk_bf16_f32 v106, v36, v37
  v_cvt_pk_bf16_f32 v107, v38, v39
  s_nop 0
  v_permlane32_swap_b32 v104, v106
  v_permlane32_swap_b32 v105, v107
  buffer_store_dwordx4 v[104:107], v7, s[4:7], s22 offen offset:0 sc1
  v_cvt_pk_bf16_f32 v108, v40, v41
  v_cvt_pk_bf16_f32 v109, v42, v43
  v_cvt_pk_bf16_f32 v110, v44, v45
  v_cvt_pk_bf16_f32 v111, v46, v47
  s_nop 0
  v_permlane32_swap_b32 v108, v110
  v_permlane32_swap_b32 v109, v111
  buffer_store_dwordx4 v[108:111], v7, s[4:7], s22 offen offset:1024 sc1
  s_add_u32 s15, s15, 1
  s_cmp_lt_u32 s15, 6
  s_cbranch_scc1 G1G
  s_waitcnt vmcnt(0)
  s_barrier
  s_cmp_lg_u32 s13, 0
  s_cbranch_scc1 SIG_11
  s_lshl_b32 s29, s14, 2
  s_add_u32 s29, s29, 160
  v_mov_b32 v8, s29
  v_mov_b32 v9, 1
  s_mov_b64 exec, 1
  global_atomic_add v8, v9, s[92:93]
  s_mov_b64 exec, -1
SIG_11:
  s_cmp_lt_u32 s12, 12
  s_cbranch_scc1 R_FFN
  s_sub_u32 s24, s12, 12
  s_lshl_b32 s24, s24, 3
  s_add_u32 s24, s24, s14
  s_and_b32 s14, s24, 1
  s_bfe_u32 s12, s24, 0x30001
  s_lshr_b32 s15, s24, 4
  s_add_u32 s15, s15, 22
  s_barrier
  s_branch AO_ENTRY2
R_FFN:
  s_lshl_b32 s16, s14, 1
  s_and_b32 s24, s12, 1
  s_add_u32 s16, s16, s24
  s_lshr_b32 s17, s12, 1
  v_and_b32 v1, 63, v0
  v_lshlrev_b32 v2, 4, v1
  v_lshrrev_b32 v8, 2, v1
  v_and_b32 v9, 3, v1
  v_lshlrev_b32 v9, 4, v9
  v_mul_u32_u24 v3, 1152, v8
  v_add_u32 v3, v3, v9
  v_lshrrev_b32 v8, 5, v1
  v_bfe_u32 v9, v1, 2, 2
  v_lshl_add_u32 v8, v8, 3, v9
  v_lshlrev_b32 v8, 6, v8
  v_bfe_u32 v9, v1, 4, 1
  v_lshl_add_u32 v8, v9, 5, v8
  v_and_b32 v9, 3, v1
  v_lshl_add_u32 v4, v9, 3, v8
  s_mov_b32 s8, s88
  s_mov_b32 s9, s89
  s_mov_b32 s10, 5308416
  s_mov_b32 s11, 0x20000
  s_mul_i32 s20, s17, 192
  s_mul_i32 s24, s13, 36864
  s_add_u32 s20, s20, s24
  s_lshl_b32 s30, s13, 11
  s_mov_b32 s21, 0
  s_mov_b32 s22, 0
  s_mov_b32 s38, 0
  s_barrier
  s_add_u32 s24, s21, s30
  s_add_u32 m0, s24, 0
  s_add_u32 s25, s20, 0
  buffer_load_dwordx4 v3, s[8:11], s25 offen lds
  s_add_u32 m0, s24, 1024
  s_add_u32 s25, s20, 18432
  buffer_load_dwordx4 v3, s[8:11], s25 offen lds
  s_add_u32 m0, s24, 8192
  s_add_u32 s25, s20, 64
  buffer_load_dwordx4 v3, s[8:11], s25 offen lds
  s_add_u32 m0, s24, 9216
  s_add_u32 s25, s20, 18496
  buffer_load_dwordx4 v3, s[8:11], s25 offen lds
  s_add_u32 m0, s24, 16384
  s_add_u32 s25, s20, 128
  buffer_load_dwordx4 v3, s[8:11], s25 offen lds
  s_add_u32 m0, s24, 17408
  s_add_u32 s25, s20, 18560
  buffer_load_dwordx4 v3, s[8:11], s25 offen lds
  s_add_u32 s38, s38, 1
  s_cmp_lt_u32 s38, 36
  s_cselect_b32 s25, 147456, 0
  s_add_u32 s20, s20, s25
  s_add_u32 s21, s21, 24576
  s_cmp_eq_u32 s21, 147456
  s_cselect_b32 s21, 0, s21
  s_add_u32 s24, s21, s30
  s_add_u32 m0, s24, 0
  s_add_u32 s25, s20, 0
  buffer_load_dwordx4 v3, s[8:11], s25 offen lds
  s_add_u32 m0, s24, 1024
  s_add_u32 s25, s20, 18432
  buffer_load_dwordx4 v3, s[8:11], s25 offen lds
  s_add_u32 m0, s24, 8192
  s_add_u32 s25, s20, 64
  buffer_load_dwordx4 v3, s[8:11], s25 offen lds
  s_add_u32 m0, s24, 9216
  s_add_u32 s25, s20, 18496
  buffer_load_dwordx4 v3, s[8:11], s25 offen lds
  s_add_u32 m0, s24, 16384
  s_add_u32 s25, s20, 128
  buffer_load_dwordx4 v3, s[8:11], s25 offen lds
  s_add_u32 m0, s24, 17408
  s_add_u32 s25, s20, 18560
  buffer_load_dwordx4 v3, s[8:11], s25 offen lds
  s_add_u32 s38, s38, 1
  s_cmp_lt_u32 s38, 36
  s_cselect_b32 s25, 147456, 0
  s_add_u32 s20, s20, s25
  s_add_u32 s21, s21, 24576
  s_cmp_eq_u32 s21, 147456
  s_cselect_b32 s21, 0, s21
  s_add_u32 s24, s21, s30
  s_add_u32 m0, s24, 0
  s_add_u32 s25, s20, 0
  buffer_load_dwordx4 v3, s[8:11], s25 offen lds
  s_add_u32 m0, s24, 1024
  s_add_u32 s25, s20, 18432
  buffer_load_dwordx4 v3, s[8:11], s25 offen lds
  s_add_u32 m0, s24, 8192
  s_add_u32 s25, s20, 64
  buffer_load_dwordx4 v3, s[8:11], s25 offen lds
  s_add_u32 m0, s24, 9216
  s_add_u32 s25, s20, 18496
  buffer_load_dwordx4 v3, s[8:11], s25 offen lds
  s_add_u32 m0, s24, 16384
  s_add_u32 s25, s20, 128
  buffer_load_dwordx4 v3, s[8:11], s25 offen lds
  s_add_u32 m0, s24, 17408
  s_add_u32 s25, s20, 18560
  buffer_load_dwordx4 v3, s[8:11], s25 offen lds
  s_add_u32 s38, s38, 1
  s_cmp_lt_u32 s38, 36
  s_cselect_b32 s25, 147456, 0
  s_add_u32 s20, s20, s25
  s_add_u32 s21, s21, 24576
  s_cmp_eq_u32 s21, 147456
  s_cselect_b32 s21, 0, s21
  s_add_u32 s24, s21, s30
  s_add_u32 m0, s24, 0
  s_add_u32 s25, s20, 0
  buffer_load_dwordx4 v3, s[8:11], s25 offen lds
  s_add_u32 m0, s24, 1024
  s_add_u32 s25, s20, 18432
  buffer_load_dwordx4 v3, s[8:11], s25 offen lds
  s_add_u32 m0, s24, 8192
  s_add_u32 s25, s20, 64
  buffer_load_dwordx4 v3, s[8:11], s25 offen lds
  s_add_u32 m0, s24, 9216
  s_add_u32 s25, s20, 18496
  buffer_load_dwordx4 v3, s[8:11], s25 offen lds
  s_add_u32 m0, s24, 16384
  s_add_u32 s25, s20, 128
  buffer_load_dwordx4 v3, s[8:11], s25 offen lds
  s_add_u32 m0, s24, 17408
  s_add_u32 s25, s20, 18560
  buffer_load_dwordx4 v3, s[8:11], s25 offen lds
  s_add_u32 s38, s38, 1
  s_cmp_lt_u32 s38, 36
  s_cselect_b32 s25, 147456, 0
  s_add_u32 s20, s20, s25
  s_add_u32 s21, s21, 24576
  s_cmp_eq_u32 s21, 147456
  s_cselect_b32 s21, 0, s21
  s_add_u32 s24, s21, s30
  s_add_u32 m0, s24, 0
  s_add_u32 s25, s20, 0
  buffer_load_dwordx4 v3, s[8:11], s25 offen lds
  s_add_u32 m0, s24, 1024
  s_add_u32 s25, s20, 18432
  buffer_load_dwordx4 v3, s[8:11], s25 offen lds
  s_add_u32 m0, s24, 8192
  s_add_u32 s25, s20, 64
  buffer_load_dwordx4 v3, s[8:11], s25 offen lds
  s_add_u32 m0, s24, 9216
  s_add_u32 s25, s20, 18496
  buffer_load_dwordx4 v3, s[8:11], s25 offen lds
  s_add_u32 m0, s24, 16384
  s_add_u32 s25, s20, 128
  buffer_load_dwordx4 v3, s[8:11], s25 offen lds
  s_add_u32 m0, s24, 17408
  s_add_u32 s25, s20, 18560
  buffer_load_dwordx4 v3, s[8:11], s25 offen lds
  s_add_u32 s38, s38, 1
  s_cmp_lt_u32 s38, 36
  s_cselect_b32 s25, 147456, 0
  s_add_u32 s20, s20, s25
  s_add_u32 s21, s21, 24576
  s_cmp_eq_u32 s21, 147456
  s_cselect_b32 s21, 0, s21
  s_cmp_lg_u32 s13, 0
  s_cbranch_scc1 WFE_14
  s_lshl_b32 s29, s14, 2
  s_add_u32 s29, s29, 160
  v_mov_b32 v8, s29
  s_mov_b64 exec, 1
  s_mov_b32 s42, 0
WF_12:
  global_load_dword v9, v8, s[92:93] sc1
  s_add_u32 s42, s42, 1
  s_cmp_gt_u32 s42, 0x20000
  s_cbranch_scc1 WFD_13
  s_waitcnt vmcnt(0)
  v_cmp_gt_u32 vcc, 24, v9
  s_cbranch_vccz WFD_13
  s_sleep 8
  s_branch WF_12
WFD_13:
  s_waitcnt vmcnt(0)
  s_mov_b64 exec, -1
WFE_14:
  s_barrier
  s_lshl_b32 s19, s16, 2
  s_add_u32 s19, s19, s13
  s_mul_i32 s19, s19, 294912
  s_add_u32 s19, s19, 67108864
  s_add_u32 s26, s19, 0
  buffer_load_dwordx4 v[64:67], v2, s[4:7], s26 offen offset:0 sc1
  buffer_load_dwordx4 v[68:71], v2, s[4:7], s26 offen offset:1024 sc1
  buffer_load_dwordx4 v[72:75], v2, s[4:7], s26 offen offset:2048 sc1
  buffer_load_dwordx4 v[76:79], v2, s[4:7], s26 offen offset:3072 sc1
  s_add_u32 s26, s19, 4096
  buffer_load_dwordx4 v[80:83], v2, s[4:7], s26 offen offset:0 sc1
  buffer_load_dwordx4 v[84:87], v2, s[4:7], s26 offen offset:1024 sc1
  buffer_load_dwordx4 v[88:91], v2, s[4:7], s26 offen offset:2048 sc1
  buffer_load_dwordx4 v[92:95], v2, s[4:7], s26 offen offset:3072 sc1
  s_add_u32 s26, s19, 8192
  buffer_load_dwordx4 v[96:99], v2, s[4:7], s26 offen offset:0 sc1
  buffer_load_dwordx4 v[100:103], v2, s[4:7], s26 offen offset:1024 sc1
  buffer_load_dwordx4 v[104:107], v2, s[4:7], s26 offen offset:2048 sc1
  buffer_load_dwordx4 v[108:111], v2, s[4:7], s26 offen offset:3072 sc1
  s_add_u32 s26, s19, 12288
  buffer_load_dwordx4 v[112:115], v2, s[4:7], s26 offen offset:0 sc1
  buffer_load_dwordx4 v[116:119], v2, s[4:7], s26 offen offset:1024 sc1
  buffer_load_dwordx4 v[120:123], v2, s[4:7], s26 offen offset:2048 sc1
  buffer_load_dwordx4 v[124:127], v2, s[4:7], s26 offen offset:3072 sc1
  s_add_u32 s19, s19, 16384
  v_mov_b64 v[16:17], 0
  v_mov_b64 v[18:19], 0
  v_mov_b64 v[20:21], 0
  v_mov_b64 v[22:23], 0
  v_mov_b64 v[24:25], 0
  v_mov_b64 v[26:27], 0
  v_mov_b64 v[28:29], 0
  v_mov_b64 v[30:31], 0
  v_mov_b64 v[32:33], 0
  v_mov_b64 v[34:35], 0
  v_mov_b64 v[36:37], 0
  v_mov_b64 v[38:39], 0
  v_mov_b64 v[40:41], 0
  v_mov_b64 v[42:43], 0
  v_mov_b64 v[44:45], 0
  v_mov_b64 v[46:47], 0
  v_mov_b64 v[48:49], 0
  v_mov_b64 v[50:51], 0
  v_mov_b64 v[52:53], 0
  v_mov_b64 v[54:55], 0
  v_mov_b64 v[56:57], 0
  v_mov_b64 v[58:59], 0
  v_mov_b64 v[60:61], 0
  v_mov_b64 v[62:63], 0
  s_mov_b32 s18, 0
F2L:
  s_waitcnt vmcnt(40)
  s_barrier
  v_add_u32 v5, s22, v4
  s_add_u32 s22, s22, 24576
  s_cmp_eq_u32 s22, 147456
  s_cselect_b32 s22, 0, s22
  ds_read_b64_tr_b16 v[128:129], v5 offset:0
  ds_read_b64_tr_b16 v[130:131], v5 offset:256
  ds_read_b64_tr_b16 v[132:133], v5 offset:8192
  ds_read_b64_tr_b16 v[134:135], v5 offset:8448
  ds_read_b64_tr_b16 v[136:137], v5 offset:16384
  ds_read_b64_tr_b16 v[138:139], v5 offset:16640
  ds_read_b64_tr_b16 v[140:141], v5 offset:1024
  ds_read_b64_tr_b16 v[142:143], v5 offset:1280
  ds_read_b64_tr_b16 v[144:145], v5 offset:9216
  ds_read_b64_tr_b16 v[146:147], v5 offset:9472
  ds_read_b64_tr_b16 v[148:149], v5 offset:17408
  ds_read_b64_tr_b16 v[150:151], v5 offset:17664
  s_waitcnt vmcnt(15)
  s_waitcnt lgkmcnt(10)
  v_mfma_f32_32x32x16_bf16 v[16:31], v[128:131], v[64:67], v[16:31]
  s_add_u32 s24, s21, s30
  ds_read_b64_tr_b16 v[128:129], v5 offset:2048
  ds_read_b64_tr_b16 v[130:131], v5 offset:2304
  s_waitcnt lgkmcnt(10)
  v_mfma_f32_32x32x16_bf16 v[32:47], v[132:135], v[64:67], v[32:47]
  s_add_u32 m0, s24, 0
  s_add_u32 s25, s20, 0
  buffer_load_dwordx4 v3, s[8:11], s25 offen lds
  ds_read_b64_tr_b16 v[132:133], v5 offset:10240
  ds_read_b64_tr_b16 v[134:135], v5 offset:10496
  s_waitcnt lgkmcnt(10)
  v_mfma_f32_32x32x16_bf16 v[48:63], v[136:139], v[64:67], v[48:63]
  s_add_u32 s26, s19, 0
  buffer_load_dwordx4 v[64:67], v2, s[4:7], s26 offen offset:0 sc1
  ds_read_b64_tr_b16 v[136:137], v5 offset:18432
  ds_read_b64_tr_b16 v[138:139], v5 offset:18688
  s_waitcnt vmcnt(15)
  s_waitcnt lgkmcnt(10)
  v_mfma_f32_32x32x16_bf16 v[16:31], v[140:143], v[68:71], v[16:31]
  s_add_u32 m0, s24, 1024
  s_add_u32 s25, s20, 18432
  buffer_load_dwordx4 v3, s[8:11], s25 offen lds
  ds_read_b64_tr_b16 v[140:141], v5 offset:3072
  ds_read_b64_tr_b16 v[142:143], v5 offset:3328
  s_waitcnt lgkmcnt(10)
  v_mfma_f32_32x32x16_bf16 v[32:47], v[144:147], v[68:71], v[32:47]
  s_add_u32 m0, s24, 8192
  s_add_u32 s25, s20, 64
  buffer_load_dwordx4 v3, s[8:11], s25 offen lds
  ds_read_b64_tr_b16 v[144:145], v5 offset:11264
  ds_read_b64_tr_b16 v[146:147], v5 offset:11520
  s_waitcnt lgkmcnt(10)
  v_mfma_f32_32x32x16_bf16 v[48:63], v[148:151], v[68:71], v[48:63]
  buffer_load_dwordx4 v[68:71], v2, s[4:7], s26 offen offset:1024 sc1
  ds_read_b64_tr_b16 v[148:149], v5 offset:19456
  ds_read_b64_tr_b16 v[150:151], v5 offset:19712
  s_waitcnt vmcnt(15)
  s_waitcnt lgkmcnt(10)
  v_mfma_f32_32x32x16_bf16 v[16:31], v[128:131], v[72:75], v[16:31]
  s_add_u32 m0, s24, 9216
  s_add_u32 s25, s20, 18496
  buffer_load_dwordx4 v3, s[8:11], s25 offen lds
  ds_read_b64_tr_b16 v[128:129], v5 offset:4096
  ds_read_b64_tr_b16 v[130:131], v5 offset:4352
  s_waitcnt lgkmcnt(10)
  v_mfma_f32_32x32x16_bf16 v[32:47], v[132:135], v[72:75], v[32:47]
  s_add_u32 m0, s24, 16384
  s_add_u32 s25, s20, 128
  buffer_load_dwordx4 v3, s[8:11], s25 offen lds
  ds_read_b64_tr_b16 v[132:133], v5 offset:12288
  ds_read_b64_tr_b16 v[134:135], v5 offset:12544
  s_waitcnt lgkmcnt(10)
  v_mfma_f32_32x32x16_bf16 v[48:63], v[136:139], v[72:75], v[48:63]
  buffer_load_dwordx4 v[72:75], v2, s[4:7], s26 offen offset:2048 sc1
  ds_read_b64_tr_b16 v[136:137], v5 offset:20480
  ds_read_b64_tr_b16 v[138:139], v5 offset:20736
  s_waitcnt vmcnt(15)
  s_waitcnt lgkmcnt(10)
  v_mfma_f32_32x32x16_bf16 v[16:31], v[140:143], v[76:79], v[16:31]
  s_add_u32 m0, s24, 17408
  s_add_u32 s25, s20, 18560
  buffer_load_dwordx4 v3, s[8:11], s25 offen lds
  ds_read_b64_tr_b16 v[140:141], v5 offset:5120
  ds_read_b64_tr_b16 v[142:143], v5 offset:5376
  s_waitcnt lgkmcnt(10)
  v_mfma_f32_32x32x16_bf16 v[32:47], v[144:147], v[76:79], v[32:47]
  s_add_u32 s38, s38, 1
  s_cmp_lt_u32 s38, 36
  s_cselect_b32 s25, 147456, 0
  s_add_u32 s20, s20, s25
  ds_read_b64_tr_b16 v[144:145], v5 offset:13312
  ds_read_b64_tr_b16 v[146:147], v5 offset:13568
  s_waitcnt lgkmcnt(10)
  v_mfma_f32_32x32x16_bf16 v[48:63], v[148:151], v[76:79], v[48:63]
  buffer_load_dwordx4 v[76:79], v2, s[4:7], s26 offen offset:3072 sc1
  ds_read_b64_tr_b16 v[148:149], v5 offset:21504
  ds_read_b64_tr_b16 v[150:151], v5 offset:21760
  s_waitcnt vmcnt(15)
  s_waitcnt lgkmcnt(10)
  v_mfma_f32_32x32x16_bf16 v[16:31], v[128:131], v[80:83], v[16:31]
  s_add_u32 s21, s21, 24576
  s_cmp_eq_u32 s21, 147456
  s_cselect_b32 s21, 0, s21
  ds_read_b64_tr_b16 v[128:129], v5 offset:6144
  ds_read_b64_tr_b16 v[130:131], v5 offset:6400
  s_waitcnt lgkmcnt(10)
  v_mfma_f32_32x32x16_bf16 v[32:47], v[132:135], v[80:83], v[32:47]
  ds_read_b64_tr_b16 v[132:133], v5 offset:14336
  ds_read_b64_tr_b16 v[134:135], v5 offset:14592
  s_waitcnt lgkmcnt(10)
  v_mfma_f32_32x32x16_bf16 v[48:63], v[136:139], v[80:83], v[48:63]
  s_add_u32 s26, s19, 4096
  buffer_load_dwordx4 v[80:83], v2, s[4:7], s26 offen offset:0 sc1
  ds_read_b64_tr_b16 v[136:137], v5 offset:22528
  ds_read_b64_tr_b16 v[138:139], v5 offset:22784
  s_waitcnt vmcnt(15)
  s_waitcnt lgkmcnt(10)
  v_mfma_f32_32x32x16_bf16 v[16:31], v[140:143], v[84:87], v[16:31]
  ds_read_b64_tr_b16 v[140:141], v5 offset:7168
  ds_read_b64_tr_b16 v[142:143], v5 offset:7424
  s_waitcnt lgkmcnt(10)
  v_mfma_f32_32x32x16_bf16 v[32:47], v[144:147], v[84:87], v[32:47]
  ds_read_b64_tr_b16 v[144:145], v5 offset:15360
  ds_read_b64_tr_b16 v[146:147], v5 offset:15616
  s_waitcnt lgkmcnt(10)
  v_mfma_f32_32x32x16_bf16 v[48:63], v[148:151], v[84:87], v[48:63]
  buffer_load_dwordx4 v[84:87], v2, s[4:7], s26 offen offset:1024 sc1
  ds_read_b64_tr_b16 v[148:149], v5 offset:23552
  ds_read_b64_tr_b16 v[150:151], v5 offset:23808
  s_waitcnt vmcnt(15)
  s_waitcnt lgkmcnt(10)
  v_mfma_f32_32x32x16_bf16 v[16:31], v[128:131], v[88:91], v[16:31]
  s_waitcnt lgkmcnt(8)
  v_mfma_f32_32x32x16_bf16 v[32:47], v[132:135], v[88:91], v[32:47]
  s_waitcnt lgkmcnt(6)
  v_mfma_f32_32x32x16_bf16 v[48:63], v[136:139], v[88:91], v[48:63]
  buffer_load_dwordx4 v[88:91], v2, s[4:7], s26 offen offset:2048 sc1
  s_waitcnt vmcnt(15)
  s_waitcnt lgkmcnt(4)
  v_mfma_f32_32x32x16_bf16 v[16:31], v[140:143], v[92:95], v[16:31]
  s_waitcnt lgkmcnt(2)
  v_mfma_f32_32x32x16_bf16 v[32:47], v[144:147], v[92:95], v[32:47]
  s_waitcnt lgkmcnt(0)
  v_mfma_f32_32x32x16_bf16 v[48:63], v[148:151], v[92:95], v[48:63]
  buffer_load_dwordx4 v[92:95], v2, s[4:7], s26 offen offset:3072 sc1
  s_waitcnt vmcnt(40)
  s_barrier
  v_add_u32 v5, s22, v4
  s_add_u32 s22, s22, 24576
  s_cmp_eq_u32 s22, 147456
  s_cselect_b32 s22, 0, s22
  ds_read_b64_tr_b16 v[128:129], v5 offset:0
  ds_read_b64_tr_b16 v[130:131], v5 offset:256
  ds_read_b64_tr_b16 v[132:133], v5 offset:8192
  ds_read_b64_tr_b16 v[134:135], v5 offset:8448
  ds_read_b64_tr_b16 v[136:137], v5 offset:16384
  ds_read_b64_tr_b16 v[138:139], v5 offset:16640
  ds_read_b64_tr_b16 v[140:141], v5 offset:1024
  ds_read_b64_tr_b16 v[142:143], v5 offset:1280
  ds_read_b64_tr_b16 v[144:145], v5 offset:9216
  ds_read_b64_tr_b16 v[146:147], v5 offset:9472
  ds_read_b64_tr_b16 v[148:149], v5 offset:17408
  ds_read_b64_tr_b16 v[150:151], v5 offset:17664
  s_waitcnt vmcnt(15)
  s_waitcnt lgkmcnt(10)
  v_mfma_f32_32x32x16_bf16 v[16:31], v[128:131], v[96:99], v[16:31]
  s_add_u32 s24, s21, s30
  ds_read_b64_tr_b16 v[128:129], v5 offset:2048
  ds_read_b64_tr_b16 v[130:131], v5 offset:2304
  s_waitcnt lgkmcnt(10)
  v_mfma_f32_32x32x16_bf16 v[32:47], v[132:135], v[96:99], v[32:47]
  s_add_u32 m0, s24, 0
  s_add_u32 s25, s20, 0
  buffer_load_dwordx4 v3, s[8:11], s25 offen lds
  ds_read_b64_tr_b16 v[132:133], v5 offset:10240
  ds_read_b64_tr_b16 v[134:135], v5 offset:10496
  s_waitcnt lgkmcnt(10)
  v_mfma_f32_32x32x16_bf16 v[48:63], v[136:139], v[96:99], v[48:63]
  s_add_u32 s26, s19, 8192
  buffer_load_dwordx4 v[96:99], v2, s[4:7], s26 offen offset:0 sc1
  ds_read_b64_tr_b16 v[136:137], v5 offset:18432
  ds_read_b64_tr_b16 v[138:139], v5 offset:18688
  s_waitcnt vmcnt(15)
  s_waitcnt lgkmcnt(10)
  v_mfma_f32_32x32x16_bf16 v[16:31], v[140:143], v[100:103], v[16:31]
  s_add_u32 m0, s24, 1024
  s_add_u32 s25, s20, 18432
  buffer_load_dwordx4 v3, s[8:11], s25 offen lds
  ds_read_b64_tr_b16 v[140:141], v5 offset:3072
  ds_read_b64_tr_b16 v[142:143], v5 offset:3328
  s_waitcnt lgkmcnt(10)
  v_mfma_f32_32x32x16_bf16 v[32:47], v[144:147], v[100:103], v[32:47]
  s_add_u32 m0, s24, 8192
  s_add_u32 s25, s20, 64
  buffer_load_dwordx4 v3, s[8:11], s25 offen lds
  ds_read_b64_tr_b16 v[144:145], v5 offset:11264
  ds_read_b64_tr_b16 v[146:147], v5 offset:11520
  s_waitcnt lgkmcnt(10)
  v_mfma_f32_32x32x16_bf16 v[48:63], v[148:151], v[100:103], v[48:63]
  buffer_load_dwordx4 v[100:103], v2, s[4:7], s26 offen offset:1024 sc1
  ds_read_b64_tr_b16 v[148:149], v5 offset:19456
  ds_read_b64_tr_b16 v[150:151], v5 offset:19712
  s_waitcnt vmcnt(15)
  s_waitcnt lgkmcnt(10)
  v_mfma_f32_32x32x16_bf16 v[16:31], v[128:131], v[104:107], v[16:31]
  s_add_u32 m0, s24, 9216
  s_add_u32 s25, s20, 18496
  buffer_load_dwordx4 v3, s[8:11], s25 offen lds
  ds_read_b64_tr_b16 v[128:129], v5 offset:4096
  ds_read_b64_tr_b16 v[130:131], v5 offset:4352
  s_waitcnt lgkmcnt(10)
  v_mfma_f32_32x32x16_bf16 v[32:47], v[132:135], v[104:107], v[32:47]
  s_add_u32 m0, s24, 16384
  s_add_u32 s25, s20, 128
  buffer_load_dwordx4 v3, s[8:11], s25 offen lds
  ds_read_b64_tr_b16 v[132:133], v5 offset:12288
  ds_read_b64_tr_b16 v[134:135], v5 offset:12544
  s_waitcnt lgkmcnt(10)
  v_mfma_f32_32x32x16_bf16 v[48:63], v[136:139], v[104:107], v[48:63]
  buffer_load_dwordx4 v[104:107], v2, s[4:7], s26 offen offset:2048 sc1
  ds_read_b64_tr_b16 v[136:137], v5 offset:20480
  ds_read_b64_tr_b16 v[138:139], v5 offset:20736
  s_waitcnt vmcnt(15)
  s_waitcnt lgkmcnt(10)
  v_mfma_f32_32x32x16_bf16 v[16:31], v[140:143], v[108:111], v[16:31]
  s_add_u32 m0, s24, 17408
  s_add_u32 s25, s20, 18560
  buffer_load_dwordx4 v3, s[8:11], s25 offen lds
  ds_read_b64_tr_b16 v[140:141], v5 offset:5120
  ds_read_b64_tr_b16 v[142:143], v5 offset:5376
  s_waitcnt lgkmcnt(10)
  v_mfma_f32_32x32x16_bf16 v[32:47], v[144:147], v[108:111], v[32:47]
  s_add_u32 s38, s38, 1
  s_cmp_lt_u32 s38, 36
  s_cselect_b32 s25, 147456, 0
  s_add_u32 s20, s20, s25
  ds_read_b64_tr_b16 v[144:145], v5 offset:13312
  ds_read_b64_tr_b16 v[146:147], v5 offset:13568
  s_waitcnt lgkmcnt(10)
  v_mfma_f32_32x32x16_bf16 v[48:63], v[148:151], v[108:111], v[48:63]
  buffer_load_dwordx4 v[108:111], v2, s[4:7], s26 offen offset:3072 sc1
  ds_read_b64_tr_b16 v[148:149], v5 offset:21504
  ds_read_b64_tr_b16 v[150:151], v5 offset:21760
  s_waitcnt vmcnt(15)
  s_waitcnt lgkmcnt(10)
  v_mfma_f32_32x32x16_bf16 v[16:31], v[128:131], v[112:115], v[16:31]
  s_add_u32 s21, s21, 24576
  s_cmp_eq_u32 s21, 147456
  s_cselect_b32 s21, 0, s21
  ds_read_b64_tr_b16 v[128:129], v5 offset:6144
  ds_read_b64_tr_b16 v[130:131], v5 offset:6400
  s_waitcnt lgkmcnt(10)
  v_mfma_f32_32x32x16_bf16 v[32:47], v[132:135], v[112:115], v[32:47]
  ds_read_b64_tr_b16 v[132:133], v5 offset:14336
  ds_read_b64_tr_b16 v[134:135], v5 offset:14592
  s_waitcnt lgkmcnt(10)
  v_mfma_f32_32x32x16_bf16 v[48:63], v[136:139], v[112:115], v[48:63]
  s_add_u32 s26, s19, 12288
  buffer_load_dwordx4 v[112:115], v2, s[4:7], s26 offen offset:0 sc1
  ds_read_b64_tr_b16 v[136:137], v5 offset:22528
  ds_read_b64_tr_b16 v[138:139], v5 offset:22784
  s_waitcnt vmcnt(15)
  s_waitcnt lgkmcnt(10)
  v_mfma_f32_32x32x16_bf16 v[16:31], v[140:143], v[116:119], v[16:31]
  ds_read_b64_tr_b16 v[140:141], v5 offset:7168
  ds_read_b64_tr_b16 v[142:143], v5 offset:7424
  s_waitcnt lgkmcnt(10)
  v_mfma_f32_32x32x16_bf16 v[32:47], v[144:147], v[116:119], v[32:47]
  ds_read_b64_tr_b16 v[144:145], v5 offset:15360
  ds_read_b64_tr_b16 v[146:147], v5 offset:15616
  s_waitcnt lgkmcnt(10)
  v_mfma_f32_32x32x16_bf16 v[48:63], v[148:151], v[116:119], v[48:63]
  buffer_load_dwordx4 v[116:119], v2, s[4:7], s26 offen offset:1024 sc1
  ds_read_b64_tr_b16 v[148:149], v5 offset:23552
  ds_read_b64_tr_b16 v[150:151], v5 offset:23808
  s_waitcnt vmcnt(15)
  s_waitcnt lgkmcnt(10)
  v_mfma_f32_32x32x16_bf16 v[16:31], v[128:131], v[120:123], v[16:31]
  s_waitcnt lgkmcnt(8)
  v_mfma_f32_32x32x16_bf16 v[32:47], v[132:135], v[120:123], v[32:47]
  s_waitcnt lgkmcnt(6)
  v_mfma_f32_32x32x16_bf16 v[48:63], v[136:139], v[120:123], v[48:63]
  buffer_load_dwordx4 v[120:123], v2, s[4:7], s26 offen offset:2048 sc1
  s_waitcnt vmcnt(15)
  s_waitcnt lgkmcnt(4)
  v_mfma_f32_32x32x16_bf16 v[16:31], v[140:143], v[124:127], v[16:31]
  s_waitcnt lgkmcnt(2)
  v_mfma_f32_32x32x16_bf16 v[32:47], v[144:147], v[124:127], v[32:47]
  s_waitcnt lgkmcnt(0)
  v_mfma_f32_32x32x16_bf16 v[48:63], v[148:151], v[124:127], v[48:63]
  buffer_load_dwordx4 v[124:127], v2, s[4:7], s26 offen offset:3072 sc1
  s_add_u32 s19, s19, 16384
  s_add_u32 s18, s18, 2
  s_cmp_lt_u32 s18, 36
  s_cbranch_scc1 F2L
  s_waitcnt vmcnt(0)
  s_barrier
  v_and_b32 v8, 31, v1
  v_mul_u32_u24 v8, 400, v8
  v_lshrrev_b32 v9, 5, v1
  v_lshl_add_u32 v8, v9, 4, v8
  s_mul_i32 s24, s13, 12800
  v_add_u32 v8, s24, v8
  ds_write_b128 v8, v[16:19] offset:0
  ds_write_b128 v8, v[20:23] offset:32
  ds_write_b128 v8, v[24:27] offset:64
  ds_write_b128 v8, v[28:31] offset:96
  ds_write_b128 v8, v[32:35] offset:128
  ds_write_b128 v8, v[36:39] offset:160
  ds_write_b128 v8, v[40:43] offset:192
  ds_write_b128 v8, v[44:47] offset:224
  ds_write_b128 v8, v[48:51] offset:256
  ds_write_b128 v8, v[52:55] offset:288
  ds_write_b128 v8, v[56:59] offset:320
  ds_write_b128 v8, v[60:63] offset:352
  s_waitcnt lgkmcnt(0)
  s_barrier
  v_add_u32 v14, 0, v1
  v_mul_u32_u24 v8, 171, v14
  v_lshrrev_b32 v8, 12, v8
  v_mul_u32_u24 v15, 24, v8
  v_sub_u32 v11, v14, v15
  s_lshl_b32 s24, s13, 3
  v_add_u32 v8, s24, v8
  v_mul_u32_u24 v16, 2304, v8
  v_lshl_add_u32 v16, v11, 4, v16
  v_mul_u32_u24 v20, 400, v8
  v_lshl_add_u32 v20, v11, 4, v20
  v_mul_u32_u24 v24, 1152, v8
  v_lshl_add_u32 v24, v11, 3, v24
  v_add_u32 v14, 64, v1
  v_mul_u32_u24 v9, 171, v14
  v_lshrrev_b32 v9, 12, v9
  v_mul_u32_u24 v15, 24, v9
  v_sub_u32 v12, v14, v15
  s_lshl_b32 s24, s13, 3
  v_add_u32 v9, s24, v9
  v_mul_u32_u24 v17, 2304, v9
  v_lshl_add_u32 v17, v12, 4, v17
  v_mul_u32_u24 v21, 400, v9
  v_lshl_add_u32 v21, v12, 4, v21
  v_mul_u32_u24 v25, 1152, v9
  v_lshl_add_u32 v25, v12, 3, v25
  v_add_u32 v14, 128, v1
  v_mul_u32_u24 v10, 171, v14
  v_lshrrev_b32 v10, 12, v10
  v_mul_u32_u24 v15, 24, v10
  v_sub_u32 v13, v14, v15
  s_lshl_b32 s24, s13, 3
  v_add_u32 v10, s24, v10
  v_mul_u32_u24 v18, 2304, v10
  v_lshl_add_u32 v18, v13, 4, v18
  v_mul_u32_u24 v22, 400, v10
  v_lshl_add_u32 v22, v13, 4, v22
  v_mul_u32_u24 v26, 1152, v10
  v_lshl_add_u32 v26, v13, 3, v26
  s_mov_b32 s8, s72
  s_mov_b32 s9, s73
  s_mov_b32 s10, 2359296
  s_mov_b32 s11, 0x20000
  s_mov_b32 s32, s90
  s_mov_b32 s33, s91
  s_mov_b32 s34, 2359296
  s_mov_b32 s35, 0x20000
  s_mov_b32 s18, 0
F3L:
  s_lshl_b32 s23, s16, 2
  s_add_u32 s23, s23, s18
  s_mul_i32 s20, s23, 36864
  s_mul_i32 s24, s17, 192
  s_add_u32 s20, s20, s24
  buffer_load_dwordx2 v[32:33], v24, s[8:11], s20 offen
  buffer_load_dwordx2 v[34:35], v25, s[8:11], s20 offen
  buffer_load_dwordx2 v[36:37], v26, s[8:11], s20 offen
  s_mul_i32 s24, s18, 12800
  v_add_u32 v15, s24, v20
  ds_read_b128 v[40:43], v15
  v_add_u32 v15, s24, v21
  ds_read_b128 v[44:47], v15
  v_add_u32 v15, s24, v22
  ds_read_b128 v[48:51], v15
  s_cmp_ge_u32 s17, 3
  s_cselect_b32 s24, 1, 0
  s_lshl_b32 s25, s23, 1
  s_add_u32 s24, s24, s25
  s_lshr_b32 s25, s24, 3
  s_and_b32 s24, s24, 7
  s_lshl_b32 s24, s24, 2
  s_cmp_lg_u32 s13, 0
  s_cbranch_scc1 WFE_17
  s_lshl_b32 s29, s25, 2
  s_add_u32 s29, s29, 192
  v_mov_b32 v14, s29
  s_mov_b64 exec, 1
  s_mov_b32 s42, 0
WF_15:
  global_load_dword v15, v14, s[92:93] sc1
  s_add_u32 s42, s42, 1
  s_cmp_gt_u32 s42, 0x20000
  s_cbranch_scc1 WFD_16
  s_waitcnt vmcnt(0)
  v_lshrrev_b32 v15, s24, v15
  v_and_b32 v15, 15, v15
  v_cmp_gt_u32 vcc, 8, v15
  s_cbranch_vccz WFD_16
  s_sleep 2
  s_branch WF_15
WFD_16:
  s_waitcnt vmcnt(0)
  s_mov_b64 exec, -1
WFE_17:
  s_barrier
  s_mul_i32 s26, s23, 589824
  s_mul_i32 s24, s17, 384
  s_add_u32 s26, s26, s24
  s_add_u32 s26, s26, 100663296
  buffer_load_dwordx4 v[64:67], v16, s[4:7], s26 offen sc1
  buffer_load_dwordx4 v[68:71], v17, s[4:7], s26 offen sc1
  buffer_load_dwordx4 v[72:75], v18, s[4:7], s26 offen sc1
  s_add_u32 s26, s26, 73728
  buffer_load_dwordx4 v[76:79], v16, s[4:7], s26 offen sc1
  buffer_load_dwordx4 v[80:83], v17, s[4:7], s26 offen sc1
  buffer_load_dwordx4 v[84:87], v18, s[4:7], s26 offen sc1
  s_add_u32 s26, s26, 73728
  buffer_load_dwordx4 v[88:91], v16, s[4:7], s26 offen sc1
  buffer_load_dwordx4 v[92:95], v17, s[4:7], s26 offen sc1
  buffer_load_dwordx4 v[96:99], v18, s[4:7], s26 offen sc1
  s_add_u32 s26, s26, 73728
  buffer_load_dwordx4 v[100:103], v16, s[4:7], s26 offen sc1
  buffer_load_dwordx4 v[104:107], v17, s[4:7], s26 offen sc1
  buffer_load_dwordx4 v[108:111], v18, s[4:7], s26 offen sc1
  s_add_u32 s26, s26, 73728
  buffer_load_dwordx4 v[112:115], v16, s[4:7], s26 offen sc1
  buffer_load_dwordx4 v[116:119], v17, s[4:7], s26 offen sc1
  buffer_load_dwordx4 v[120:123], v18, s[4:7], s26 offen sc1
  s_add_u32 s26, s26, 73728
  buffer_load_dwordx4 v[124:127], v16, s[4:7], s26 offen sc1
  buffer_load_dwordx4 v[128:131], v17, s[4:7], s26 offen sc1
  buffer_load_dwordx4 v[132:135], v18, s[4:7], s26 offen sc1
  s_add_u32 s26, s26, 73728
  buffer_load_dwordx4 v[136:139], v16, s[4:7], s26 offen sc1
  buffer_load_dwordx4 v[140:143], v17, s[4:7], s26 offen sc1
  buffer_load_dwordx4 v[144:147], v18, s[4:7], s26 offen sc1
  s_add_u32 s26, s26, 73728
  buffer_load_dwordx4 v[148:151], v16, s[4:7], s26 offen sc1
  buffer_load_dwordx4 v[152:155], v17, s[4:7], s26 offen sc1
  buffer_load_dwordx4 v[156:159], v18, s[4:7], s26 offen sc1
  s_waitcnt lgkmcnt(0)
  s_waitcnt vmcnt(24)
  v_lshlrev_b32 v14, 16, v32
  v_and_b32 v15, 0xffff0000, v32
  v_pk_add_f32 v[40:41], v[40:41], v[14:15]
  v_lshlrev_b32 v14, 16, v33
  v_and_b32 v15, 0xffff0000, v33
  v_pk_add_f32 v[42:43], v[42:43], v[14:15]
  v_lshlrev_b32 v14, 16, v34
  v_and_b32 v15, 0xffff0000, v34
  v_pk_add_f32 v[44:45], v[44:45], v[14:15]
  v_lshlrev_b32 v14, 16, v35
  v_and_b32 v15, 0xffff0000, v35
  v_pk_add_f32 v[46:47], v[46:47], v[14:15]
  v_lshlrev_b32 v14, 16, v36
  v_and_b32 v15, 0xffff0000, v36
  v_pk_add_f32 v[48:49], v[48:49], v[14:15]
  v_lshlrev_b32 v14, 16, v37
  v_and_b32 v15, 0xffff0000, v37
  v_pk_add_f32 v[50:51], v[50:51], v[14:15]
  s_waitcnt vmcnt(21)
  v_pk_add_f32 v[40:41], v[40:41], v[64:65]
  v_pk_add_f32 v[42:43], v[42:43], v[66:67]
  v_pk_add_f32 v[44:45], v[44:45], v[68:69]
  v_pk_add_f32 v[46:47], v[46:47], v[70:71]
  v_pk_add_f32 v[48:49], v[48:49], v[72:73]
  v_pk_add_f32 v[50:51], v[50:51], v[74:75]
  s_waitcnt vmcnt(18)
  v_pk_add_f32 v[40:41], v[40:41], v[76:77]
  v_pk_add_f32 v[42:43], v[42:43], v[78:79]
  v_pk_add_f32 v[44:45], v[44:45], v[80:81]
  v_pk_add_f32 v[46:47], v[46:47], v[82:83]
  v_pk_add_f32 v[48:49], v[48:49], v[84:85]
  v_pk_add_f32 v[50:51], v[50:51], v[86:87]
  s_waitcnt vmcnt(15)
  v_pk_add_f32 v[40:41], v[40:41], v[88:89]
  v_pk_add_f32 v[42:43], v[42:43], v[90:91]
  v_pk_add_f32 v[44:45], v[44:45], v[92:93]
  v_pk_add_f32 v[46:47], v[46:47], v[94:95]
  v_pk_add_f32 v[48:49], v[48:49], v[96:97]
  v_pk_add_f32 v[50:51], v[50:51], v[98:99]
  s_waitcnt vmcnt(12)
  v_pk_add_f32 v[40:41], v[40:41], v[100:101]
  v_pk_add_f32 v[42:43], v[42:43], v[102:103]
  v_pk_add_f32 v[44:45], v[44:45], v[104:105]
  v_pk_add_f32 v[46:47], v[46:47], v[106:107]
  v_pk_add_f32 v[48:49], v[48:49], v[108:109]
  v_pk_add_f32 v[50:51], v[50:51], v[110:111]
  s_waitcnt vmcnt(9)
  v_pk_add_f32 v[40:41], v[40:41], v[112:113]
  v_pk_add_f32 v[42:43], v[42:43], v[114:115]
  v_pk_add_f32 v[44:45], v[44:45], v[116:117]
  v_pk_add_f32 v[46:47], v[46:47], v[118:119]
  v_pk_add_f32 v[48:49], v[48:49], v[120:121]
  v_pk_add_f32 v[50:51], v[50:51], v[122:123]
  s_waitcnt vmcnt(6)
  v_pk_add_f32 v[40:41], v[40:41], v[124:125]
  v_pk_add_f32 v[42:43], v[42:43], v[126:127]
  v_pk_add_f32 v[44:45], v[44:45], v[128:129]
  v_pk_add_f32 v[46:47], v[46:47], v[130:131]
  v_pk_add_f32 v[48:49], v[48:49], v[132:133]
  v_pk_add_f32 v[50:51], v[50:51], v[134:135]
  s_waitcnt vmcnt(3)
  v_pk_add_f32 v[40:41], v[40:41], v[136:137]
  v_pk_add_f32 v[42:43], v[42:43], v[138:139]
  v_pk_add_f32 v[44:45], v[44:45], v[140:141]
  v_pk_add_f32 v[46:47], v[46:47], v[142:143]
  v_pk_add_f32 v[48:49], v[48:49], v[144:145]
  v_pk_add_f32 v[50:51], v[50:51], v[146:147]
  s_waitcnt vmcnt(0)
  v_pk_add_f32 v[40:41], v[40:41], v[148:149]
  v_pk_add_f32 v[42:43], v[42:43], v[150:151]
  v_pk_add_f32 v[44:45], v[44:45], v[152:153]
  v_pk_add_f32 v[46:47], v[46:47], v[154:155]
  v_pk_add_f32 v[48:49], v[48:49], v[156:157]
  v_pk_add_f32 v[50:51], v[50:51], v[158:159]
  v_cvt_pk_bf16_f32 v40, v40, v41
  v_cvt_pk_bf16_f32 v41, v42, v43
  buffer_store_dwordx2 v[40:41], v24, s[32:35], s20 offen sc1
  v_cvt_pk_bf16_f32 v44, v44, v45
  v_cvt_pk_bf16_f32 v45, v46, v47
  buffer_store_dwordx2 v[44:45], v25, s[32:35], s20 offen sc1
  v_cvt_pk_bf16_f32 v48, v48, v49
  v_cvt_pk_bf16_f32 v49, v50, v51
  buffer_store_dwordx2 v[48:49], v26, s[32:35], s20 offen sc1
  s_add_u32 s18, s18, 1
  s_cmp_lt_u32 s18, 4
  s_cbranch_scc1 F3L
  s_branch K_DONE
R_AO:
  s_and_b32 s15, s28, 1
  s_bfe_u32 s14, s28, 0x10001
  s_lshr_b32 s12, s28, 2
  s_mov_b32 s46, s28
  v_and_b32 v1, 63, v0
  v_lshlrev_b32 v2, 4, v1
  v_lshlrev_b32 v3, 3, v1
  v_lshlrev_b32 v8, 4, v0
  v_mov_b32 v12, -1
  v_mov_b32 v13, -1
  v_mov_b32 v14, -1
  v_mov_b32 v15, -1
  s_sub_u32 s24, s28, 1
  s_cmp_gt_u32 s24, 1
  s_cbranch_scc1 AONM
  s_mul_i32 s24, s28, 16384
  s_add_u32 s24, s24, 1048576
  buffer_store_dwordx4 v[12:15], v8, s[4:7], s24 offen sc1
  s_add_u32 s24, s24, 4096
  buffer_store_dwordx4 v[12:15], v8, s[4:7], s24 offen sc1
  s_add_u32 s24, s24, 4096
  buffer_store_dwordx4 v[12:15], v8, s[4:7], s24 offen sc1
  s_add_u32 s24, s24, 4096
AONM:
  v_mov_b32 v24, 0
  v_mov_b32 v25, 0
  v_mov_b32 v26, 0
  v_mov_b32 v27, 0
  s_mul_i32 s25, s28, 12288
  s_add_u32 s24, s25, 65536
  buffer_store_dwordx4 v[24:27], v8, s[4:7], s24 offen sc1
  s_add_u32 s24, s24, 4096
  buffer_store_dwordx4 v[24:27], v8, s[4:7], s24 offen sc1
  s_add_u32 s24, s24, 4096
  buffer_store_dwordx4 v[24:27], v8, s[4:7], s24 offen sc1
  s_add_u32 s24, s24, 4096
  s_add_u32 s24, s25, 589824
  buffer_store_dwordx4 v[24:27], v8, s[4:7], s24 offen sc1
  s_add_u32 s24, s24, 4096
  buffer_store_dwordx4 v[24:27], v8, s[4:7], s24 offen sc1
  s_add_u32 s24, s24, 4096
  buffer_store_dwordx4 v[24:27], v8, s[4:7], s24 offen sc1
  s_add_u32 s24, s24, 4096
  s_cmp_lg_u32 s28, 0
  s_cbranch_scc1 AONM0
  s_mov_b32 s8, s74
  s_mov_b32 s9, s75
  s_mov_b32 s10, 9216
  s_mov_b32 s11, 0x20000
  s_mov_b32 s34, 1048576
  v_add_u32 v12, 0, v0
  v_mul_u32_u24 v13, 911, v12
  v_lshrrev_b32 v13, 16, v13
  v_mul_u32_u24 v14, 72, v13
  v_sub_u32 v14, v12, v14
  v_lshrrev_b32 v15, 1, v14
  v_mul_u32_u24 v16, 57, v15
  v_lshrrev_b32 v16, 9, v16
  v_mul_u32_u24 v17, 9, v16
  v_sub_u32 v17, v15, v17
  v_mul_u32_u24 v18, 43, v17
  v_lshrrev_b32 v18, 7, v18
  v_mul_u32_u24 v19, 3, v18
  v_sub_u32 v19, v17, v19
  v_sub_u32 v18, 2, v18
  v_lshrrev_b32 v20, 1, v13
  v_lshlrev_b32 v20, 8, v20
  v_lshl_add_u32 v20, v16, 6, v20
  v_mul_u32_u24 v21, 3072, v18
  v_add_u32 v20, v20, v21
  v_lshl_add_u32 v20, v19, 10, v20
  v_and_b32 v21, 1, v13
  v_lshl_add_u32 v20, v21, 5, v20
  v_and_b32 v21, 1, v14
  v_lshl_add_u32 v20, v21, 4, v20
  v_lshlrev_b32 v21, 4, v12
  v_cmp_gt_u32 vcc, 576, v12
  s_nop 0
  s_and_saveexec_b64 s[36:37], vcc
  buffer_load_dwordx4 v[8:11], v21, s[8:11], 0 offen
  s_waitcnt vmcnt(0)
  buffer_store_dwordx4 v[8:11], v20, s[4:7], s34 offen sc1
  s_mov_b64 exec, s[36:37]
  v_add_u32 v12, 256, v0
  v_mul_u32_u24 v13, 911, v12
  v_lshrrev_b32 v13, 16, v13
  v_mul_u32_u24 v14, 72, v13
  v_sub_u32 v14, v12, v14
  v_lshrrev_b32 v15, 1, v14
  v_mul_u32_u24 v16, 57, v15
  v_lshrrev_b32 v16, 9, v16
  v_mul_u32_u24 v17, 9, v16
  v_sub_u32 v17, v15, v17
  v_mul_u32_u24 v18, 43, v17
  v_lshrrev_b32 v18, 7, v18
  v_mul_u32_u24 v19, 3, v18
  v_sub_u32 v19, v17, v19
  v_sub_u32 v18, 2, v18
  v_lshrrev_b32 v20, 1, v13
  v_lshlrev_b32 v20, 8, v20
  v_lshl_add_u32 v20, v16, 6, v20
  v_mul_u32_u24 v21, 3072, v18
  v_add_u32 v20, v20, v21
  v_lshl_add_u32 v20, v19, 10, v20
  v_and_b32 v21, 1, v13
  v_lshl_add_u32 v20, v21, 5, v20
  v_and_b32 v21, 1, v14
  v_lshl_add_u32 v20, v21, 4, v20
  v_lshlrev_b32 v21, 4, v12
  v_cmp_gt_u32 vcc, 576, v12
  s_nop 0
  s_and_saveexec_b64 s[36:37], vcc
  buffer_load_dwordx4 v[8:11], v21, s[8:11], 0 offen
  s_waitcnt vmcnt(0)
  buffer_store_dwordx4 v[8:11], v20, s[4:7], s34 offen sc1
  s_mov_b64 exec, s[36:37]
  v_add_u32 v12, 512, v0
  v_mul_u32_u24 v13, 911, v12
  v_lshrrev_b32 v13, 16, v13
  v_mul_u32_u24 v14, 72, v13
  v_sub_u32 v14, v12, v14
  v_lshrrev_b32 v15, 1, v14
  v_mul_u32_u24 v16, 57, v15
  v_lshrrev_b32 v16, 9, v16
  v_mul_u32_u24 v17, 9, v16
  v_sub_u32 v17, v15, v17
  v_mul_u32_u24 v18, 43, v17
  v_lshrrev_b32 v18, 7, v18
  v_mul_u32_u24 v19, 3, v18
  v_sub_u32 v19, v17, v19
  v_sub_u32 v18, 2, v18
  v_lshrrev_b32 v20, 1, v13
  v_lshlrev_b32 v20, 8, v20
  v_lshl_add_u32 v20, v16, 6, v20
  v_mul_u32_u24 v21, 3072, v18
  v_add_u32 v20, v20, v21
  v_lshl_add_u32 v20, v19, 10, v20
  v_and_b32 v21, 1, v13
  v_lshl_add_u32 v20, v21, 5, v20
  v_and_b32 v21, 1, v14
  v_lshl_add_u32 v20, v21, 4, v20
  v_lshlrev_b32 v21, 4, v12
  v_cmp_gt_u32 vcc, 576, v12
  s_nop 0
  s_and_saveexec_b64 s[36:37], vcc
  buffer_load_dwordx4 v[8:11], v21, s[8:11], 0 offen
  s_waitcnt vmcnt(0)
  buffer_store_dwordx4 v[8:11], v20, s[4:7], s34 offen sc1
  s_mov_b64 exec, s[36:37]
AONM0:
  s_waitcnt vmcnt(0)
  s_barrier
  s_cmp_lg_u32 s13, 0
  s_cbranch_scc1 SIG_18
  v_mov_b32 v8, 44
  v_mov_b32 v9, 1
  s_mov_b64 exec, 1
  global_atomic_add v8, v9, s[92:93]
  s_mov_b64 exec, -1
SIG_18:
  s_add_u32 s28, s46, 16
  s_mov_b32 s45, 1
  s_branch LN_GO
LN_RET1:
  s_cmp_ge_u32 s46, 16
  s_cbranch_scc1 LN_RET2
  s_add_u32 s28, s46, 48
  s_mov_b32 s45, 2
  s_branch LN_GO
LN_RET2:
AO_ENTRY2:
  s_cmp_lg_u32 s13, 0
  s_cbranch_scc1 WFE_21
  v_mov_b32 v8, 40
  s_mov_b64 exec, 1
  s_mov_b32 s42, 0
WF_19:
  global_load_dword v9, v8, s[92:93] sc1
  s_add_u32 s42, s42, 1
  s_cmp_gt_u32 s42, 0x20000
  s_cbranch_scc1 WFD_20
  s_waitcnt vmcnt(0)
  v_cmp_gt_u32 vcc, 32, v9
  s_cbranch_vccz WFD_20
  s_sleep 16
  s_branch WF_19
WFD_20:
  s_waitcnt vmcnt(0)
  s_mov_b64 exec, -1
WFE_21:
  s_barrier
  s_cmp_lg_u32 s13, 0
  s_cbranch_scc1 WFE_24
  v_mbcnt_lo_u32_b32 v8, -1, 0
  v_lshlrev_b32 v8, 2, v8
  v_add_u32 v8, 96, v8
  s_mov_b64 exec, 3
  s_mov_b32 s42, 0
WF_22:
  global_load_dword v9, v8, s[92:93] sc1
  s_add_u32 s42, s42, 1
  s_cmp_gt_u32 s42, 0x20000
  s_cbranch_scc1 WFD_23
  s_waitcnt vmcnt(0)
  v_cmp_gt_u32 vcc, 96, v9
  s_cbranch_vccz WFD_23
  s_sleep 8
  s_branch WF_22
WFD_23:
  s_waitcnt vmcnt(0)
  s_mov_b64 exec, -1
WFE_24:
  s_barrier
  v_and_b32 v1, 63, v0
  v_lshlrev_b32 v2, 4, v1
  v_lshlrev_b32 v3, 3, v1
  s_mov_b32 s8, s82
  s_mov_b32 s9, s83
  s_mov_b32 s10, 4718592
  s_mov_b32 s11, 0x20000
  v_lshrrev_b32 v8, 1, v1
  v_and_b32 v9, 1, v1
  v_lshlrev_b32 v9, 4, v9
  v_mul_u32_u24 v10, 1152, v8
  v_add_u32 v10, v10, v9
  v_lshrrev_b32 v8, 4, v1
  v_bfe_u32 v9, v1, 2, 2
  v_lshl_add_u32 v8, v8, 2, v9
  v_lshlrev_b32 v8, 5, v8
  v_and_b32 v9, 3, v1
  v_lshl_add_u32 v11, v9, 3, v8
  s_mul_i32 s24, s13, 40960
  v_add_u32 v11, s24, v11
  s_mul_i32 s25, s12, 589824
  s_mul_i32 s26, s14, 576
  s_add_u32 s25, s25, s26
  s_lshl_b32 s26, s13, 5
  s_add_u32 s25, s25, s26
  s_mov_b32 s27, 384
  s_cmp_lt_u32 s13, 2
  s_cselect_b32 s27, 512, s27
  s_add_u32 m0, s24, 0
  s_add_u32 s26, s25, 0
  buffer_load_dwordx4 v10, s[8:11], s26 offen lds
  s_add_u32 m0, s24, 1024
  s_add_u32 s26, s25, 36864
  buffer_load_dwordx4 v10, s[8:11], s26 offen lds
  s_add_u32 m0, s24, 2048
  s_add_u32 s26, s25, 73728
  buffer_load_dwordx4 v10, s[8:11], s26 offen lds
  s_add_u32 m0, s24, 3072
  s_add_u32 s26, s25, 110592
  buffer_load_dwordx4 v10, s[8:11], s26 offen lds
  s_add_u32 m0, s24, 4096
  s_add_u32 s26, s25, 147456
  buffer_load_dwordx4 v10, s[8:11], s26 offen lds
  s_add_u32 m0, s24, 5120
  s_add_u32 s26, s25, 184320
  buffer_load_dwordx4 v10, s[8:11], s26 offen lds
  s_add_u32 m0, s24, 6144
  s_add_u32 s26, s25, 221184
  buffer_load_dwordx4 v10, s[8:11], s26 offen lds
  s_add_u32 m0, s24, 7168
  s_add_u32 s26, s25, 258048
  buffer_load_dwordx4 v10, s[8:11], s26 offen lds
  s_add_u32 m0, s24, 8192
  s_add_u32 s26, s25, 294912
  buffer_load_dwordx4 v10, s[8:11], s26 offen lds
  s_add_u32 m0, s24, 9216
  s_add_u32 s26, s25, 331776
  buffer_load_dwordx4 v10, s[8:11], s26 offen lds
  s_add_u32 m0, s24, 10240
  s_add_u32 s26, s25, 368640
  buffer_load_dwordx4 v10, s[8:11], s26 offen lds
  s_add_u32 m0, s24, 11264
  s_add_u32 s26, s25, 405504
  buffer_load_dwordx4 v10, s[8:11], s26 offen lds
  s_add_u32 m0, s24, 12288
  s_add_u32 s26, s25, 442368
  buffer_load_dwordx4 v10, s[8:11], s26 offen lds
  s_add_u32 m0, s24, 13312
  s_add_u32 s26, s25, 479232
  buffer_load_dwordx4 v10, s[8:11], s26 offen lds
  s_add_u32 m0, s24, 14336
  s_add_u32 s26, s25, 516096
  buffer_load_dwordx4 v10, s[8:11], s26 offen lds
  s_add_u32 m0, s24, 15360
  s_add_u32 s26, s25, 552960
  buffer_load_dwordx4 v10, s[8:11], s26 offen lds
  s_add_u32 m0, s24, 16384
  s_add_u32 s26, s25, 128
  buffer_load_dwordx4 v10, s[8:11], s26 offen lds
  s_add_u32 m0, s24, 17408
  s_add_u32 s26, s25, 36992
  buffer_load_dwordx4 v10, s[8:11], s26 offen lds
  s_add_u32 m0, s24, 18432
  s_add_u32 s26, s25, 73856
  buffer_load_dwordx4 v10, s[8:11], s26 offen lds
  s_add_u32 m0, s24, 19456
  s_add_u32 s26, s25, 110720
  buffer_load_dwordx4 v10, s[8:11], s26 offen lds
  s_add_u32 m0, s24, 20480
  s_add_u32 s26, s25, 147584
  buffer_load_dwordx4 v10, s[8:11], s26 offen lds
  s_add_u32 m0, s24, 21504
  s_add_u32 s26, s25, 184448
  buffer_load_dwordx4 v10, s[8:11], s26 offen lds
  s_add_u32 m0, s24, 22528
  s_add_u32 s26, s25, 221312
  buffer_load_dwordx4 v10, s[8:11], s26 offen lds
  s_add_u32 m0, s24, 23552
  s_add_u32 s26, s25, 258176
  buffer_load_dwordx4 v10, s[8:11], s26 offen lds
  s_add_u32 m0, s24, 24576
  s_add_u32 s26, s25, 295040
  buffer_load_dwordx4 v10, s[8:11], s26 offen lds
  s_add_u32 m0, s24, 25600
  s_add_u32 s26, s25, 331904
  buffer_load_dwordx4 v10, s[8:11], s26 offen lds
  s_add_u32 m0, s24, 26624
  s_add_u32 s26, s25, 368768
  buffer_load_dwordx4 v10, s[8:11], s26 offen lds
  s_add_u32 m0, s24, 27648
  s_add_u32 s26, s25, 405632
  buffer_load_dwordx4 v10, s[8:11], s26 offen lds
  s_add_u32 m0, s24, 28672
  s_add_u32 s26, s25, 442496
  buffer_load_dwordx4 v10, s[8:11], s26 offen lds
  s_add_u32 m0, s24, 29696
  s_add_u32 s26, s25, 479360
  buffer_load_dwordx4 v10, s[8:11], s26 offen lds
  s_add_u32 m0, s24, 30720
  s_add_u32 s26, s25, 516224
  buffer_load_dwordx4 v10, s[8:11], s26 offen lds
  s_add_u32 m0, s24, 31744
  s_add_u32 s26, s25, 553088
  buffer_load_dwordx4 v10, s[8:11], s26 offen lds
  s_add_u32 m0, s24, 32768
  s_add_u32 s26, s25, 256
  buffer_load_dwordx4 v10, s[8:11], s26 offen lds
  s_add_u32 m0, s24, 33792
  s_add_u32 s26, s25, 37120
  buffer_load_dwordx4 v10, s[8:11], s26 offen lds
  s_add_u32 m0, s24, 34816
  s_add_u32 s26, s25, 73984
  buffer_load_dwordx4 v10, s[8:11], s26 offen lds
  s_add_u32 m0, s24, 35840
  s_add_u32 s26, s25, 110848
  buffer_load_dwordx4 v10, s[8:11], s26 offen lds
  s_add_u32 m0, s24, 36864
  s_add_u32 s26, s25, 147712
  buffer_load_dwordx4 v10, s[8:11], s26 offen lds
  s_add_u32 m0, s24, 37888
  s_add_u32 s26, s25, 184576
  buffer_load_dwordx4 v10, s[8:11], s26 offen lds
  s_add_u32 m0, s24, 38912
  s_add_u32 s26, s25, 221440
  buffer_load_dwordx4 v10, s[8:11], s26 offen lds
  s_add_u32 m0, s24, 39936
  s_add_u32 s26, s25, 258304
  buffer_load_dwordx4 v10, s[8:11], s26 offen lds
  s_waitcnt vmcnt(36)
  ds_read_b64_tr_b16 a[0:1], v11 offset:0
  ds_read_b64_tr_b16 a[2:3], v11 offset:512
  ds_read_b64_tr_b16 a[4:5], v11 offset:1024
  ds_read_b64_tr_b16 a[6:7], v11 offset:1536
  ds_read_b64_tr_b16 a[8:9], v11 offset:2048
  ds_read_b64_tr_b16 a[10:11], v11 offset:2560
  ds_read_b64_tr_b16 a[12:13], v11 offset:3072
  ds_read_b64_tr_b16 a[14:15], v11 offset:3584
  s_waitcnt lgkmcnt(0)
  s_add_u32 m0, s24, 0
  s_add_u32 s26, s25, 295168
  buffer_load_dwordx4 v10, s[8:11], s26 offen lds
  s_add_u32 m0, s24, 1024
  s_add_u32 s26, s25, 332032
  buffer_load_dwordx4 v10, s[8:11], s26 offen lds
  s_add_u32 m0, s24, 2048
  s_add_u32 s26, s25, 368896
  buffer_load_dwordx4 v10, s[8:11], s26 offen lds
  s_add_u32 m0, s24, 3072
  s_add_u32 s26, s25, 405760
  buffer_load_dwordx4 v10, s[8:11], s26 offen lds
  s_waitcnt vmcnt(36)
  ds_read_b64_tr_b16 a[16:17], v11 offset:4096
  ds_read_b64_tr_b16 a[18:19], v11 offset:4608
  ds_read_b64_tr_b16 a[20:21], v11 offset:5120
  ds_read_b64_tr_b16 a[22:23], v11 offset:5632
  ds_read_b64_tr_b16 a[24:25], v11 offset:6144
  ds_read_b64_tr_b16 a[26:27], v11 offset:6656
  ds_read_b64_tr_b16 a[28:29], v11 offset:7168
  ds_read_b64_tr_b16 a[30:31], v11 offset:7680
  s_waitcnt lgkmcnt(0)
  s_add_u32 m0, s24, 4096
  s_add_u32 s26, s25, 442624
  buffer_load_dwordx4 v10, s[8:11], s26 offen lds
  s_add_u32 m0, s24, 5120
  s_add_u32 s26, s25, 479488
  buffer_load_dwordx4 v10, s[8:11], s26 offen lds
  s_add_u32 m0, s24, 6144
  s_add_u32 s26, s25, 516352
  buffer_load_dwordx4 v10, s[8:11], s26 offen lds
  s_add_u32 m0, s24, 7168
  s_add_u32 s26, s25, 553216
  buffer_load_dwordx4 v10, s[8:11], s26 offen lds
  s_waitcnt vmcnt(36)
  ds_read_b64_tr_b16 a[32:33], v11 offset:8192
  ds_read_b64_tr_b16 a[34:35], v11 offset:8704
  ds_read_b64_tr_b16 a[36:37], v11 offset:9216
  ds_read_b64_tr_b16 a[38:39], v11 offset:9728
  ds_read_b64_tr_b16 a[40:41], v11 offset:10240
  ds_read_b64_tr_b16 a[42:43], v11 offset:10752
  ds_read_b64_tr_b16 a[44:45], v11 offset:11264
  ds_read_b64_tr_b16 a[46:47], v11 offset:11776
  s_waitcnt lgkmcnt(0)
  s_add_u32 m0, s24, 8192
  s_add_u32 s26, s25, 384
  buffer_load_dwordx4 v10, s[8:11], s26 offen lds
  s_add_u32 m0, s24, 9216
  s_add_u32 s26, s25, 37248
  buffer_load_dwordx4 v10, s[8:11], s26 offen lds
  s_add_u32 m0, s24, 10240
  s_add_u32 s26, s25, 74112
  buffer_load_dwordx4 v10, s[8:11], s26 offen lds
  s_add_u32 m0, s24, 11264
  s_add_u32 s26, s25, 110976
  buffer_load_dwordx4 v10, s[8:11], s26 offen lds
  s_waitcnt vmcnt(36)
  ds_read_b64_tr_b16 a[48:49], v11 offset:12288
  ds_read_b64_tr_b16 a[50:51], v11 offset:12800
  ds_read_b64_tr_b16 a[52:53], v11 offset:13312
  ds_read_b64_tr_b16 a[54:55], v11 offset:13824
  ds_read_b64_tr_b16 a[56:57], v11 offset:14336
  ds_read_b64_tr_b16 a[58:59], v11 offset:14848
  ds_read_b64_tr_b16 a[60:61], v11 offset:15360
  ds_read_b64_tr_b16 a[62:63], v11 offset:15872
  s_waitcnt lgkmcnt(0)
  s_add_u32 m0, s24, 12288
  s_add_u32 s26, s25, 147840
  buffer_load_dwordx4 v10, s[8:11], s26 offen lds
  s_add_u32 m0, s24, 13312
  s_add_u32 s26, s25, 184704
  buffer_load_dwordx4 v10, s[8:11], s26 offen lds
  s_add_u32 m0, s24, 14336
  s_add_u32 s26, s25, 221568
  buffer_load_dwordx4 v10, s[8:11], s26 offen lds
  s_add_u32 m0, s24, 15360
  s_add_u32 s26, s25, 258432
  buffer_load_dwordx4 v10, s[8:11], s26 offen lds
  s_waitcnt vmcnt(36)
  ds_read_b64_tr_b16 a[64:65], v11 offset:16384
  ds_read_b64_tr_b16 a[66:67], v11 offset:16896
  ds_read_b64_tr_b16 a[68:69], v11 offset:17408
  ds_read_b64_tr_b16 a[70:71], v11 offset:17920
  ds_read_b64_tr_b16 a[72:73], v11 offset:18432
  ds_read_b64_tr_b16 a[74:75], v11 offset:18944
  ds_read_b64_tr_b16 a[76:77], v11 offset:19456
  ds_read_b64_tr_b16 a[78:79], v11 offset:19968
  s_waitcnt lgkmcnt(0)
  s_add_u32 m0, s24, 16384
  s_add_u32 s26, s25, 295296
  buffer_load_dwordx4 v10, s[8:11], s26 offen lds
  s_add_u32 m0, s24, 17408
  s_add_u32 s26, s25, 332160
  buffer_load_dwordx4 v10, s[8:11], s26 offen lds
  s_add_u32 m0, s24, 18432
  s_add_u32 s26, s25, 369024
  buffer_load_dwordx4 v10, s[8:11], s26 offen lds
  s_add_u32 m0, s24, 19456
  s_add_u32 s26, s25, 405888
  buffer_load_dwordx4 v10, s[8:11], s26 offen lds
  s_waitcnt vmcnt(36)
  ds_read_b64_tr_b16 a[80:81], v11 offset:20480
  ds_read_b64_tr_b16 a[82:83], v11 offset:20992
  ds_read_b64_tr_b16 a[84:85], v11 offset:21504
  ds_read_b64_tr_b16 a[86:87], v11 offset:22016
  ds_read_b64_tr_b16 a[88:89], v11 offset:22528
  ds_read_b64_tr_b16 a[90:91], v11 offset:23040
  ds_read_b64_tr_b16 a[92:93], v11 offset:23552
  ds_read_b64_tr_b16 a[94:95], v11 offset:24064
  s_waitcnt lgkmcnt(0)
  s_add_u32 m0, s24, 20480
  s_add_u32 s26, s25, 442752
  buffer_load_dwordx4 v10, s[8:11], s26 offen lds
  s_add_u32 m0, s24, 21504
  s_add_u32 s26, s25, 479616
  buffer_load_dwordx4 v10, s[8:11], s26 offen lds
  s_add_u32 m0, s24, 22528
  s_add_u32 s26, s25, 516480
  buffer_load_dwordx4 v10, s[8:11], s26 offen lds
  s_add_u32 m0, s24, 23552
  s_add_u32 s26, s25, 553344
  buffer_load_dwordx4 v10, s[8:11], s26 offen lds
  s_waitcnt vmcnt(36)
  ds_read_b64_tr_b16 a[96:97], v11 offset:24576
  ds_read_b64_tr_b16 a[98:99], v11 offset:25088
  ds_read_b64_tr_b16 a[100:101], v11 offset:25600
  ds_read_b64_tr_b16 a[102:103], v11 offset:26112
  ds_read_b64_tr_b16 a[104:105], v11 offset:26624
  ds_read_b64_tr_b16 a[106:107], v11 offset:27136
  ds_read_b64_tr_b16 a[108:109], v11 offset:27648
  ds_read_b64_tr_b16 a[110:111], v11 offset:28160
  s_waitcnt lgkmcnt(0)
  s_add_u32 m0, s24, 24576
  s_add_u32 s26, s25, 0
  s_add_u32 s26, s26, s27
  buffer_load_dwordx4 v10, s[8:11], s26 offen lds
  s_add_u32 m0, s24, 25600
  s_add_u32 s26, s25, 36864
  s_add_u32 s26, s26, s27
  buffer_load_dwordx4 v10, s[8:11], s26 offen lds
  s_add_u32 m0, s24, 26624
  s_add_u32 s26, s25, 73728
  s_add_u32 s26, s26, s27
  buffer_load_dwordx4 v10, s[8:11], s26 offen lds
  s_add_u32 m0, s24, 27648
  s_add_u32 s26, s25, 110592
  s_add_u32 s26, s26, s27
  buffer_load_dwordx4 v10, s[8:11], s26 offen lds
  s_waitcnt vmcnt(36)
  ds_read_b64_tr_b16 a[112:113], v11 offset:28672
  ds_read_b64_tr_b16 a[114:115], v11 offset:29184
  ds_read_b64_tr_b16 a[116:117], v11 offset:29696
  ds_read_b64_tr_b16 a[118:119], v11 offset:30208
  ds_read_b64_tr_b16 a[120:121], v11 offset:30720
  ds_read_b64_tr_b16 a[122:123], v11 offset:31232
  ds_read_b64_tr_b16 a[124:125], v11 offset:31744
  ds_read_b64_tr_b16 a[126:127], v11 offset:32256
  s_waitcnt lgkmcnt(0)
  s_add_u32 m0, s24, 28672
  s_add_u32 s26, s25, 147456
  s_add_u32 s26, s26, s27
  buffer_load_dwordx4 v10, s[8:11], s26 offen lds
  s_add_u32 m0, s24, 29696
  s_add_u32 s26, s25, 184320
  s_add_u32 s26, s26, s27
  buffer_load_dwordx4 v10, s[8:11], s26 offen lds
  s_add_u32 m0, s24, 30720
  s_add_u32 s26, s25, 221184
  s_add_u32 s26, s26, s27
  buffer_load_dwordx4 v10, s[8:11], s26 offen lds
  s_add_u32 m0, s24, 31744
  s_add_u32 s26, s25, 258048
  s_add_u32 s26, s26, s27
  buffer_load_dwordx4 v10, s[8:11], s26 offen lds
  s_waitcnt vmcnt(36)
  ds_read_b64_tr_b16 a[128:129], v11 offset:32768
  ds_read_b64_tr_b16 a[130:131], v11 offset:33280
  ds_read_b64_tr_b16 a[132:133], v11 offset:33792
  ds_read_b64_tr_b16 a[134:135], v11 offset:34304
  ds_read_b64_tr_b16 a[136:137], v11 offset:34816
  ds_read_b64_tr_b16 a[138:139], v11 offset:35328
  ds_read_b64_tr_b16 a[140:141], v11 offset:35840
  ds_read_b64_tr_b16 a[142:143], v11 offset:36352
  s_waitcnt lgkmcnt(0)
  s_add_u32 m0, s24, 32768
  s_add_u32 s26, s25, 294912
  s_add_u32 s26, s26, s27
  buffer_load_dwordx4 v10, s[8:11], s26 offen lds
  s_add_u32 m0, s24, 33792
  s_add_u32 s26, s25, 331776
  s_add_u32 s26, s26, s27
  buffer_load_dwordx4 v10, s[8:11], s26 offen lds
  s_add_u32 m0, s24, 34816
  s_add_u32 s26, s25, 368640
  s_add_u32 s26, s26, s27
  buffer_load_dwordx4 v10, s[8:11], s26 offen lds
  s_add_u32 m0, s24, 35840
  s_add_u32 s26, s25, 405504
  s_add_u32 s26, s26, s27
  buffer_load_dwordx4 v10, s[8:11], s26 offen lds
  s_waitcnt vmcnt(36)
  ds_read_b64_tr_b16 a[144:145], v11 offset:36864
  ds_read_b64_tr_b16 a[146:147], v11 offset:37376
  ds_read_b64_tr_b16 a[148:149], v11 offset:37888
  ds_read_b64_tr_b16 a[150:151], v11 offset:38400
  ds_read_b64_tr_b16 a[152:153], v11 offset:38912
  ds_read_b64_tr_b16 a[154:155], v11 offset:39424
  ds_read_b64_tr_b16 a[156:157], v11 offset:39936
  ds_read_b64_tr_b16 a[158:159], v11 offset:40448
  s_waitcnt lgkmcnt(0)
  s_add_u32 m0, s24, 36864
  s_add_u32 s26, s25, 442368
  s_add_u32 s26, s26, s27
  buffer_load_dwordx4 v10, s[8:11], s26 offen lds
  s_add_u32 m0, s24, 37888
  s_add_u32 s26, s25, 479232
  s_add_u32 s26, s26, s27
  buffer_load_dwordx4 v10, s[8:11], s26 offen lds
  s_add_u32 m0, s24, 38912
  s_add_u32 s26, s25, 516096
  s_add_u32 s26, s26, s27
  buffer_load_dwordx4 v10, s[8:11], s26 offen lds
  s_add_u32 m0, s24, 39936
  s_add_u32 s26, s25, 552960
  s_add_u32 s26, s26, s27
  buffer_load_dwordx4 v10, s[8:11], s26 offen lds
  s_waitcnt vmcnt(36)
  ds_read_b64_tr_b16 a[160:161], v11 offset:0
  ds_read_b64_tr_b16 a[162:163], v11 offset:512
  ds_read_b64_tr_b16 a[164:165], v11 offset:1024
  ds_read_b64_tr_b16 a[166:167], v11 offset:1536
  ds_read_b64_tr_b16 a[168:169], v11 offset:2048
  ds_read_b64_tr_b16 a[170:171], v11 offset:2560
  ds_read_b64_tr_b16 a[172:173], v11 offset:3072
  ds_read_b64_tr_b16 a[174:175], v11 offset:3584
  s_waitcnt lgkmcnt(0)
  s_waitcnt vmcnt(32)
  ds_read_b64_tr_b16 a[176:177], v11 offset:4096
  ds_read_b64_tr_b16 a[178:179], v11 offset:4608
  ds_read_b64_tr_b16 a[180:181], v11 offset:5120
  ds_read_b64_tr_b16 a[182:183], v11 offset:5632
  ds_read_b64_tr_b16 a[184:185], v11 offset:6144
  ds_read_b64_tr_b16 a[186:187], v11 offset:6656
  ds_read_b64_tr_b16 a[188:189], v11 offset:7168
  ds_read_b64_tr_b16 a[190:191], v11 offset:7680
  s_waitcnt lgkmcnt(0)
  s_waitcnt vmcnt(28)
  ds_read_b64_tr_b16 a[192:193], v11 offset:8192
  ds_read_b64_tr_b16 a[194:195], v11 offset:8704
  ds_read_b64_tr_b16 a[196:197], v11 offset:9216
  ds_read_b64_tr_b16 a[198:199], v11 offset:9728
  ds_read_b64_tr_b16 a[200:201], v11 offset:10240
  ds_read_b64_tr_b16 a[202:203], v11 offset:10752
  ds_read_b64_tr_b16 a[204:205], v11 offset:11264
  ds_read_b64_tr_b16 a[206:207], v11 offset:11776
  s_waitcnt lgkmcnt(0)
  s_waitcnt vmcnt(24)
  ds_read_b64_tr_b16 a[208:209], v11 offset:12288
  ds_read_b64_tr_b16 a[210:211], v11 offset:12800
  ds_read_b64_tr_b16 a[212:213], v11 offset:13312
  ds_read_b64_tr_b16 a[214:215], v11 offset:13824
  ds_read_b64_tr_b16 a[216:217], v11 offset:14336
  ds_read_b64_tr_b16 a[218:219], v11 offset:14848
  ds_read_b64_tr_b16 a[220:221], v11 offset:15360
  ds_read_b64_tr_b16 a[222:223], v11 offset:15872
  s_waitcnt lgkmcnt(0)
  s_waitcnt vmcnt(20)
  ds_read_b64_tr_b16 a[224:225], v11 offset:16384
  ds_read_b64_tr_b16 a[226:227], v11 offset:16896
  ds_read_b64_tr_b16 a[228:229], v11 offset:17408
  ds_read_b64_tr_b16 a[230:231], v11 offset:17920
  ds_read_b64_tr_b16 a[232:233], v11 offset:18432
  ds_read_b64_tr_b16 a[234:235], v11 offset:18944
  ds_read_b64_tr_b16 a[236:237], v11 offset:19456
  ds_read_b64_tr_b16 a[238:239], v11 offset:19968
  s_waitcnt lgkmcnt(0)
  s_waitcnt vmcnt(16)
  ds_read_b64_tr_b16 a[240:241], v11 offset:20480
  ds_read_b64_tr_b16 a[242:243], v11 offset:20992
  ds_read_b64_tr_b16 a[244:245], v11 offset:21504
  ds_read_b64_tr_b16 a[246:247], v11 offset:22016
  ds_read_b64_tr_b16 a[248:249], v11 offset:22528
  ds_read_b64_tr_b16 a[250:251], v11 offset:23040
  ds_read_b64_tr_b16 a[252:253], v11 offset:23552
  ds_read_b64_tr_b16 a[254:255], v11 offset:24064
  s_waitcnt lgkmcnt(0)
  s_waitcnt vmcnt(12)
  ds_read_b64_tr_b16 v[192:193], v11 offset:24576
  ds_read_b64_tr_b16 v[194:195], v11 offset:25088
  ds_read_b64_tr_b16 v[196:197], v11 offset:25600
  ds_read_b64_tr_b16 v[198:199], v11 offset:26112
  ds_read_b64_tr_b16 v[200:201], v11 offset:26624
  ds_read_b64_tr_b16 v[202:203], v11 offset:27136
  ds_read_b64_tr_b16 v[204:205], v11 offset:27648
  ds_read_b64_tr_b16 v[206:207], v11 offset:28160
  s_waitcnt lgkmcnt(0)
  s_waitcnt vmcnt(8)
  ds_read_b64_tr_b16 v[208:209], v11 offset:28672
  ds_read_b64_tr_b16 v[210:211], v11 offset:29184
  ds_read_b64_tr_b16 v[212:213], v11 offset:29696
  ds_read_b64_tr_b16 v[214:215], v11 offset:30208
  ds_read_b64_tr_b16 v[216:217], v11 offset:30720
  ds_read_b64_tr_b16 v[218:219], v11 offset:31232
  ds_read_b64_tr_b16 v[220:221], v11 offset:31744
  ds_read_b64_tr_b16 v[222:223], v11 offset:32256
  s_waitcnt lgkmcnt(0)
  s_waitcnt vmcnt(4)
  ds_read_b64_tr_b16 v[224:225], v11 offset:32768
  ds_read_b64_tr_b16 v[226:227], v11 offset:33280
  ds_read_b64_tr_b16 v[228:229], v11 offset:33792
  ds_read_b64_tr_b16 v[230:231], v11 offset:34304
  ds_read_b64_tr_b16 v[232:233], v11 offset:34816
  ds_read_b64_tr_b16 v[234:235], v11 offset:35328
  ds_read_b64_tr_b16 v[236:237], v11 offset:35840
  ds_read_b64_tr_b16 v[238:239], v11 offset:36352
  s_waitcnt lgkmcnt(0)
  s_waitcnt vmcnt(0)
  ds_read_b64_tr_b16 v[240:241], v11 offset:36864
  ds_read_b64_tr_b16 v[242:243], v11 offset:37376
  ds_read_b64_tr_b16 v[244:245], v11 offset:37888
  ds_read_b64_tr_b16 v[246:247], v11 offset:38400
  ds_read_b64_tr_b16 v[248:249], v11 offset:38912
  ds_read_b64_tr_b16 v[250:251], v11 offset:39424
  ds_read_b64_tr_b16 v[252:253], v11 offset:39936
  ds_read_b64_tr_b16 v[254:255], v11 offset:40448
  s_waitcnt lgkmcnt(0)
  s_barrier
  s_mov_b32 s22, 0x3e0293ee
  s_mov_b32 s23, s22
  s_mov_b32 s40, 0xff800000
  s_mov_b32 s21, 0
  v_lshrrev_b32 v8, 4, v1
  v_lshlrev_b32 v8, 2, v8
  v_and_b32 v9, 15, v1
  v_add_u32 v10, 0, v8
  v_cmp_le_u32 s[32:33], v10, v9
  v_add_u32 v10, 1, v8
  v_cmp_le_u32 s[34:35], v10, v9
  v_add_u32 v10, 2, v8
  v_cmp_le_u32 s[36:37], v10, v9
  v_add_u32 v10, 3, v8
  v_cmp_le_u32 s[38:39], v10, v9
  s_lshl_b32 s24, s13, 12
  v_lshlrev_b32 v4, 5, v9
  v_lshrrev_b32 v10, 4, v1
  v_lshl_add_u32 v4, v10, 3, v4
  v_add_u32 v4, s24, v4
  v_bfe_u32 v8, v1, 2, 2
  v_lshl_add_u32 v8, v10, 3, v8
  v_lshlrev_b32 v8, 5, v8
  v_and_b32 v11, 3, v1
  v_lshl_add_u32 v5, v11, 3, v8
  v_add_u32 v5, s24, v5
  v_mul_u32_u24 v6, 2304, v9
  v_lshl_add_u32 v6, v10, 4, v6
  s_lshl_b32 s45, s12, 2
  s_add_u32 s45, s45, s13
  s_mov_b32 s46, -1
  s_lshl_b32 s25, s15, 5
  s_add_u32 s25, s25, s45
  s_lshl_b32 s17, s25, 12
  s_add_u32 s17, s17, 88080384
  s_lshl_b32 s25, s15, 3
  s_add_u32 s25, s25, s12
  s_mul_i32 s18, s25, 73728
  s_mul_i32 s25, s14, 1152
  s_add_u32 s18, s18, s25
  s_lshl_b32 s25, s13, 6
  s_add_u32 s18, s18, s25
  s_add_u32 s18, s18, 100663296
  s_mov_b32 s19, 16384
  s_mul_i32 s41, s13, 24576
  s_add_u32 s41, s41, 49152
  v_add_u32 v184, s41, v2
  s_mov_b32 s43, s15
  s_cmp_ge_u32 s43, 64
  s_cbranch_scc1 AOPF_26
  s_lshr_b32 s24, s43, 3
  s_cmp_eq_u32 s24, s46
  s_cbranch_scc1 AOPF_25
  s_mov_b32 s46, s24
  s_cmp_lt_u32 s24, 2
  s_cselect_b32 s25, 96, 24
  s_cmp_lg_u32 s13, 0
  s_cbranch_scc1 WFE_29
  s_lshl_b32 s29, s24, 2
  s_add_u32 s29, s29, 96
  v_mov_b32 v172, s29
  s_mov_b64 exec, 1
  s_mov_b32 s42, 0
WF_27:
  global_load_dword v173, v172, s[92:93] sc1
  s_add_u32 s42, s42, 1
  s_cmp_gt_u32 s42, 0x20000
  s_cbranch_scc1 WFD_28
  s_waitcnt vmcnt(0)
  v_cmp_gt_u32 vcc, s25, v173
  s_cbranch_vccz WFD_28
  s_sleep 8
  s_branch WF_27
WFD_28:
  s_waitcnt vmcnt(0)
  s_mov_b64 exec, -1
WFE_29:
  s_barrier
  s_cmp_lg_u32 s13, 0
  s_cbranch_scc1 WFE_32
  s_lshl_b32 s29, s24, 2
  s_add_u32 s29, s29, 128
  v_mov_b32 v172, s29
  s_mov_b64 exec, 1
  s_mov_b32 s42, 0
WF_30:
  global_load_dword v173, v172, s[92:93] sc1
  s_add_u32 s42, s42, 1
  s_cmp_gt_u32 s42, 0x20000
  s_cbranch_scc1 WFD_31
  s_waitcnt vmcnt(0)
  v_cmp_gt_u32 vcc, 24, v173
  s_cbranch_vccz WFD_31
  s_sleep 8
  s_branch WF_30
WFD_31:
  s_waitcnt vmcnt(0)
  s_mov_b64 exec, -1
WFE_32:
  s_barrier
AOPF_25:
  s_lshl_b32 s44, s43, 5
  s_add_u32 s44, s44, s45
  s_lshl_b32 s44, s44, 13
  s_add_u32 s24, s44, 50331648
  s_add_u32 m0, s41, 0
  s_nop 0
  buffer_load_dwordx4 v2, s[4:7], s24 offen offset:0 sc1 lds
  buffer_load_dwordx4 v2, s[4:7], s24 offen offset:1024 sc1 lds
  buffer_load_dwordx4 v2, s[4:7], s24 offen offset:2048 sc1 lds
  buffer_load_dwordx4 v2, s[4:7], s24 offen offset:3072 sc1 lds
  s_add_u32 s24, s44, 50335744
  s_add_u32 m0, s41, 4096
  s_nop 0
  buffer_load_dwordx4 v2, s[4:7], s24 offen offset:0 sc1 lds
  buffer_load_dwordx4 v2, s[4:7], s24 offen offset:1024 sc1 lds
  buffer_load_dwordx4 v2, s[4:7], s24 offen offset:2048 sc1 lds
  buffer_load_dwordx4 v2, s[4:7], s24 offen offset:3072 sc1 lds
  s_add_u32 s24, s44, 16777216
  s_add_u32 m0, s41, 8192
  s_nop 0
  buffer_load_dwordx4 v2, s[4:7], s24 offen offset:0 sc1 lds
  buffer_load_dwordx4 v2, s[4:7], s24 offen offset:1024 sc1 lds
  buffer_load_dwordx4 v2, s[4:7], s24 offen offset:2048 sc1 lds
  buffer_load_dwordx4 v2, s[4:7], s24 offen offset:3072 sc1 lds
  s_add_u32 s24, s44, 16781312
  s_add_u32 m0, s41, 12288
  s_nop 0
  buffer_load_dwordx4 v2, s[4:7], s24 offen offset:0 sc1 lds
  buffer_load_dwordx4 v2, s[4:7], s24 offen offset:1024 sc1 lds
  buffer_load_dwordx4 v2, s[4:7], s24 offen offset:2048 sc1 lds
  buffer_load_dwordx4 v2, s[4:7], s24 offen offset:3072 sc1 lds
  s_add_u32 s24, s44, 33554432
  s_add_u32 m0, s41, 16384
  s_nop 0
  buffer_load_dwordx4 v2, s[4:7], s24 offen offset:0 sc1 lds
  buffer_load_dwordx4 v2, s[4:7], s24 offen offset:1024 sc1 lds
  buffer_load_dwordx4 v2, s[4:7], s24 offen offset:2048 sc1 lds
  buffer_load_dwordx4 v2, s[4:7], s24 offen offset:3072 sc1 lds
  s_add_u32 s24, s44, 33558528
  s_add_u32 m0, s41, 20480
  s_nop 0
  buffer_load_dwordx4 v2, s[4:7], s24 offen offset:0 sc1 lds
  buffer_load_dwordx4 v2, s[4:7], s24 offen offset:1024 sc1 lds
  buffer_load_dwordx4 v2, s[4:7], s24 offen offset:2048 sc1 lds
  buffer_load_dwordx4 v2, s[4:7], s24 offen offset:3072 sc1 lds
AOPF_26:
  s_cmp_lt_u32 s43, 20
  s_cselect_b32 s24, 2, 8
  s_add_u32 s43, s43, s24
  s_waitcnt vmcnt(0)
AOL:
  ds_read_b128 v[8:11], v184 offset:0
  ds_read_b128 v[12:15], v184 offset:1024
  ds_read_b128 v[16:19], v184 offset:2048
  ds_read_b128 v[20:23], v184 offset:3072
  ds_read_b128 v[24:27], v184 offset:4096
  ds_read_b128 v[28:31], v184 offset:5120
  ds_read_b128 v[32:35], v184 offset:6144
  ds_read_b128 v[36:39], v184 offset:7168
  ds_read_b128 v[40:43], v184 offset:8192
  ds_read_b128 v[44:47], v184 offset:9216
  ds_read_b128 v[48:51], v184 offset:10240
  ds_read_b128 v[52:55], v184 offset:11264
  ds_read_b128 v[56:59], v184 offset:12288
  ds_read_b128 v[60:63], v184 offset:13312
  ds_read_b128 v[64:67], v184 offset:14336
  s_waitcnt lgkmcnt(7)
  ds_read_b128 v[68:71], v184 offset:15360
  ds_read_b128 v[72:75], v184 offset:16384
  ds_read_b128 v[76:79], v184 offset:17408
  ds_read_b128 v[80:83], v184 offset:18432
  ds_read_b128 v[84:87], v184 offset:19456
  ds_read_b128 v[88:91], v184 offset:20480
  ds_read_b128 v[92:95], v184 offset:21504
  ds_read_b128 v[96:99], v184 offset:22528
  ds_read_b128 v[100:103], v184 offset:23552
  s_waitcnt lgkmcnt(0)
  v_mfma_f32_16x16x32_bf16 v[136:139], v[40:43], v[8:11], 0
  v_mfma_f32_16x16x32_bf16 v[144:147], v[40:43], v[24:27], 0
  v_mfma_f32_16x16x32_bf16 v[148:151], v[56:59], v[24:27], 0
  v_mfma_f32_16x16x32_bf16 v[136:139], v[44:47], v[12:15], v[136:139]
  v_mfma_f32_16x16x32_bf16 v[144:147], v[44:47], v[28:31], v[144:147]
  v_mfma_f32_16x16x32_bf16 v[148:151], v[60:63], v[28:31], v[148:151]
  v_mfma_f32_16x16x32_bf16 v[136:139], v[48:51], v[16:19], v[136:139]
  v_mfma_f32_16x16x32_bf16 v[144:147], v[48:51], v[32:35], v[144:147]
  v_mfma_f32_16x16x32_bf16 v[148:151], v[64:67], v[32:35], v[148:151]
  v_mfma_f32_16x16x32_bf16 v[136:139], v[52:55], v[20:23], v[136:139]
  v_mfma_f32_16x16x32_bf16 v[144:147], v[52:55], v[36:39], v[144:147]
  v_mfma_f32_16x16x32_bf16 v[148:151], v[68:71], v[36:39], v[148:151]
  s_mov_b32 s20, 0
AOP:
  buffer_load_dwordx2 v[128:129], v3, s[4:7], s17 offen offset:0 sc1
  buffer_load_dwordx2 v[120:121], v3, s[4:7], s17 offen offset:512 sc1
  buffer_load_dwordx2 v[130:131], v3, s[4:7], s17 offen offset:1024 sc1
  buffer_load_dwordx2 v[122:123], v3, s[4:7], s17 offen offset:1536 sc1
  buffer_load_dwordx2 v[132:133], v3, s[4:7], s17 offen offset:2048 sc1
  buffer_load_dwordx2 v[124:125], v3, s[4:7], s17 offen offset:2560 sc1
  buffer_load_dwordx2 v[134:135], v3, s[4:7], s17 offen offset:3072 sc1
  buffer_load_dwordx2 v[126:127], v3, s[4:7], s17 offen offset:3584 sc1
  s_add_u32 s20, s20, 1
  s_cmp_gt_u32 s20, 0x40000
  s_cselect_b32 s21, 1, s21
  s_waitcnt vmcnt(0)
  v_max3_u32 v172, v120, v121, v122
  v_max3_u32 v172, v172, v123, v124
  v_max3_u32 v172, v172, v125, v126
  v_max3_u32 v172, v172, v127, v128
  v_max3_u32 v172, v172, v129, v130
  v_max3_u32 v172, v172, v131, v132
  v_max3_u32 v172, v172, v133, v134
  v_max_u32 v172, v172, v135
  v_cmp_eq_u32 vcc, -1, v172
  s_cmp_lg_u32 s21, 0
  s_cbranch_scc1 AOG
  s_cbranch_vccz AOG
  s_sleep 2
  s_branch AOP
AOG:
  ds_write2st64_b32 v4, v128, v129 offset0:0 offset1:2
  ds_write2st64_b32 v4, v130, v131 offset0:4 offset1:6
  ds_write2st64_b32 v4, v132, v133 offset0:8 offset1:10
  ds_write2st64_b32 v4, v134, v135 offset0:12 offset1:14
  s_waitcnt lgkmcnt(0)
  ds_read_b64_tr_b16 v[104:105], v5 offset:0
  ds_read_b64_tr_b16 v[106:107], v5 offset:128
  ds_read_b64_tr_b16 v[108:109], v5 offset:1024
  ds_read_b64_tr_b16 v[110:111], v5 offset:1152
  ds_read_b64_tr_b16 v[112:113], v5 offset:2048
  ds_read_b64_tr_b16 v[114:115], v5 offset:2176
  ds_read_b64_tr_b16 v[116:117], v5 offset:3072
  ds_read_b64_tr_b16 v[118:119], v5 offset:3200
  v_mov_b32 v172, s40
  v_cndmask_b32 v136, v172, v136, s[32:33]
  v_cndmask_b32 v148, v172, v148, s[32:33]
  v_mov_b32 v172, s40
  v_cndmask_b32 v137, v172, v137, s[34:35]
  v_cndmask_b32 v149, v172, v149, s[34:35]
  v_mov_b32 v172, s40
  v_cndmask_b32 v138, v172, v138, s[36:37]
  v_cndmask_b32 v150, v172, v150, s[36:37]
  v_mov_b32 v172, s40
  v_cndmask_b32 v139, v172, v139, s[38:39]
  v_cndmask_b32 v151, v172, v151, s[38:39]
  s_waitcnt lgkmcnt(6)
  v_mfma_f32_16x16x32_bf16 v[140:143], v[104:107], v[8:11], 0
  v_mfma_f32_16x16x32_bf16 v[152:155], v[104:107], v[24:27], 0
  s_waitcnt lgkmcnt(4)
  v_mfma_f32_16x16x32_bf16 v[140:143], v[108:111], v[12:15], v[140:143]
  v_mfma_f32_16x16x32_bf16 v[152:155], v[108:111], v[28:31], v[152:155]
  s_waitcnt lgkmcnt(2)
  v_mfma_f32_16x16x32_bf16 v[140:143], v[112:115], v[16:19], v[140:143]
  v_mfma_f32_16x16x32_bf16 v[152:155], v[112:115], v[32:35], v[152:155]
  s_waitcnt lgkmcnt(0)
  v_mfma_f32_16x16x32_bf16 v[140:143], v[116:119], v[20:23], v[140:143]
  v_mfma_f32_16x16x32_bf16 v[152:155], v[116:119], v[36:39], v[152:155]
  v_max3_f32 v172, v136, v137, v138
  s_nop 5
  v_max3_f32 v173, v139, v140, v141
  v_max_f32 v172, v172, v173
  v_max_f32 v173, v172, v173
  s_nop 1
  v_permlane32_swap_b32 v172, v173
  v_max_f32 v172, v172, v173
  v_max_f32 v173, v172, v173
  s_nop 1
  v_permlane16_swap_b32 v172, v173
  v_max_f32 v172, v172, v173
  v_pk_add_f32 v[136:137], v[136:137], v[172:173] op_sel_hi:[1,0] neg_lo:[0,1] neg_hi:[0,1]
  v_pk_add_f32 v[138:139], v[138:139], v[172:173] op_sel_hi:[1,0] neg_lo:[0,1] neg_hi:[0,1]
  v_pk_add_f32 v[140:141], v[140:141], v[172:173] op_sel_hi:[1,0] neg_lo:[0,1] neg_hi:[0,1]
  v_exp_f32 v136, v136
  v_exp_f32 v137, v137
  v_exp_f32 v138, v138
  v_exp_f32 v139, v139
  v_exp_f32 v140, v140
  v_exp_f32 v141, v141
  v_cvt_pk_bf16_f32 v156, v136, v137
  v_cvt_pk_bf16_f32 v157, v138, v139
  v_mov_b64 v[158:159], 0
  v_cvt_pk_bf16_f32 v164, v140, v141
  v_mov_b64 v[166:167], 0
  v_mov_b32 v165, 0
  v_cvt_pk_bf16_f32 v167, v140, v141
  v_pk_add_f32 v[176:177], v[136:137], v[138:139]
  v_pk_add_f32 v[176:177], v[176:177], v[140:141]
  v_add_f32 v172, v176, v177
  v_add_f32 v173, v176, v177
  s_nop 1
  v_permlane32_swap_b32 v172, v173
  v_add_f32 v176, v172, v173
  v_add_f32 v177, v172, v173
  s_nop 1
  v_permlane16_swap_b32 v176, v177
  v_add_f32 v176, v176, v177
  v_rcp_f32 v176, v176
  v_max3_f32 v172, v144, v145, v146
  v_max3_f32 v173, v147, v152, v153
  v_max3_f32 v172, v172, v148, v149
  v_max3_f32 v173, v173, v150, v151
  v_max_f32 v172, v172, v173
  v_max_f32 v173, v172, v173
  s_nop 1
  v_permlane32_swap_b32 v172, v173
  v_max_f32 v172, v172, v173
  v_max_f32 v173, v172, v173
  s_nop 1
  v_permlane16_swap_b32 v172, v173
  v_max_f32 v172, v172, v173
  v_pk_add_f32 v[144:145], v[144:145], v[172:173] op_sel_hi:[1,0] neg_lo:[0,1] neg_hi:[0,1]
  v_pk_add_f32 v[146:147], v[146:147], v[172:173] op_sel_hi:[1,0] neg_lo:[0,1] neg_hi:[0,1]
  v_pk_add_f32 v[148:149], v[148:149], v[172:173] op_sel_hi:[1,0] neg_lo:[0,1] neg_hi:[0,1]
  v_pk_add_f32 v[150:151], v[150:151], v[172:173] op_sel_hi:[1,0] neg_lo:[0,1] neg_hi:[0,1]
  v_pk_add_f32 v[152:153], v[152:153], v[172:173] op_sel_hi:[1,0] neg_lo:[0,1] neg_hi:[0,1]
  v_exp_f32 v144, v144
  v_exp_f32 v145, v145
  v_exp_f32 v146, v146
  v_exp_f32 v147, v147
  v_exp_f32 v148, v148
  v_exp_f32 v149, v149
  v_exp_f32 v150, v150
  v_exp_f32 v151, v151
  v_exp_f32 v152, v152
  v_exp_f32 v153, v153
  v_cvt_pk_bf16_f32 v160, v144, v145
  v_cvt_pk_bf16_f32 v161, v146, v147
  v_cvt_pk_bf16_f32 v162, v148, v149
  v_cvt_pk_bf16_f32 v163, v150, v151
  v_cvt_pk_bf16_f32 v168, v152, v153
  v_mov_b64 v[170:171], 0
  v_mov_b32 v169, 0
  v_cvt_pk_bf16_f32 v171, v152, v153
  v_pk_add_f32 v[178:179], v[144:145], v[146:147]
  v_pk_add_f32 v[178:179], v[178:179], v[148:149]
  v_pk_add_f32 v[178:179], v[178:179], v[150:151]
  v_pk_add_f32 v[178:179], v[178:179], v[152:153]
  v_add_f32 v172, v178, v179
  v_add_f32 v173, v178, v179
  s_nop 1
  v_permlane32_swap_b32 v172, v173
  v_add_f32 v178, v172, v173
  v_add_f32 v179, v172, v173
  s_nop 1
  v_permlane16_swap_b32 v178, v179
  v_add_f32 v178, v178, v179
  v_rcp_f32 v178, v178
  s_cmp_ge_u32 s43, 64
  s_cbranch_scc1 AOPF_34
  s_lshr_b32 s24, s43, 3
  s_cmp_eq_u32 s24, s46
  s_cbranch_scc1 AOPF_33
  s_mov_b32 s46, s24
  s_cmp_lt_u32 s24, 2
  s_cselect_b32 s25, 96, 24
  s_cmp_lg_u32 s13, 0
  s_cbranch_scc1 WFE_37
  s_lshl_b32 s29, s24, 2
  s_add_u32 s29, s29, 96
  v_mov_b32 v186, s29
  s_mov_b64 exec, 1
  s_mov_b32 s42, 0
WF_35:
  global_load_dword v187, v186, s[92:93] sc1
  s_add_u32 s42, s42, 1
  s_cmp_gt_u32 s42, 0x20000
  s_cbranch_scc1 WFD_36
  s_waitcnt vmcnt(0)
  v_cmp_gt_u32 vcc, s25, v187
  s_cbranch_vccz WFD_36
  s_sleep 8
  s_branch WF_35
WFD_36:
  s_waitcnt vmcnt(0)
  s_mov_b64 exec, -1
WFE_37:
  s_barrier
  s_cmp_lg_u32 s13, 0
  s_cbranch_scc1 WFE_40
  s_lshl_b32 s29, s24, 2
  s_add_u32 s29, s29, 128
  v_mov_b32 v186, s29
  s_mov_b64 exec, 1
  s_mov_b32 s42, 0
WF_38:
  global_load_dword v187, v186, s[92:93] sc1
  s_add_u32 s42, s42, 1
  s_cmp_gt_u32 s42, 0x20000
  s_cbranch_scc1 WFD_39
  s_waitcnt vmcnt(0)
  v_cmp_gt_u32 vcc, 24, v187
  s_cbranch_vccz WFD_39
  s_sleep 8
  s_branch WF_38
WFD_39:
  s_waitcnt vmcnt(0)
  s_mov_b64 exec, -1
WFE_40:
  s_barrier
AOPF_33:
  s_lshl_b32 s44, s43, 5
  s_add_u32 s44, s44, s45
  s_lshl_b32 s44, s44, 13
  s_add_u32 s24, s44, 50331648
  s_add_u32 m0, s41, 0
  s_nop 0
  buffer_load_dwordx4 v2, s[4:7], s24 offen offset:0 sc1 lds
  buffer_load_dwordx4 v2, s[4:7], s24 offen offset:1024 sc1 lds
  buffer_load_dwordx4 v2, s[4:7], s24 offen offset:2048 sc1 lds
  buffer_load_dwordx4 v2, s[4:7], s24 offen offset:3072 sc1 lds
  s_add_u32 s24, s44, 50335744
  s_add_u32 m0, s41, 4096
  s_nop 0
  buffer_load_dwordx4 v2, s[4:7], s24 offen offset:0 sc1 lds
  buffer_load_dwordx4 v2, s[4:7], s24 offen offset:1024 sc1 lds
  buffer_load_dwordx4 v2, s[4:7], s24 offen offset:2048 sc1 lds
  buffer_load_dwordx4 v2, s[4:7], s24 offen offset:3072 sc1 lds
  s_add_u32 s24, s44, 16777216
  s_add_u32 m0, s41, 8192
  s_nop 0
  buffer_load_dwordx4 v2, s[4:7], s24 offen offset:0 sc1 lds
  buffer_load_dwordx4 v2, s[4:7], s24 offen offset:1024 sc1 lds
  buffer_load_dwordx4 v2, s[4:7], s24 offen offset:2048 sc1 lds
  buffer_load_dwordx4 v2, s[4:7], s24 offen offset:3072 sc1 lds
  s_add_u32 s24, s44, 16781312
  s_add_u32 m0, s41, 12288
  s_nop 0
  buffer_load_dwordx4 v2, s[4:7], s24 offen offset:0 sc1 lds
  buffer_load_dwordx4 v2, s[4:7], s24 offen offset:1024 sc1 lds
  buffer_load_dwordx4 v2, s[4:7], s24 offen offset:2048 sc1 lds
  buffer_load_dwordx4 v2, s[4:7], s24 offen offset:3072 sc1 lds
  s_add_u32 s24, s44, 33554432
  s_add_u32 m0, s41, 16384
  s_nop 0
  buffer_load_dwordx4 v2, s[4:7], s24 offen offset:0 sc1 lds
  buffer_load_dwordx4 v2, s[4:7], s24 offen offset:1024 sc1 lds
  buffer_load_dwordx4 v2, s[4:7], s24 offen offset:2048 sc1 lds
  buffer_load_dwordx4 v2, s[4:7], s24 offen offset:3072 sc1 lds
  s_add_u32 s24, s44, 33558528
  s_add_u32 m0, s41, 20480
  s_nop 0
  buffer_load_dwordx4 v2, s[4:7], s24 offen offset:0 sc1 lds
  buffer_load_dwordx4 v2, s[4:7], s24 offen offset:1024 sc1 lds
  buffer_load_dwordx4 v2, s[4:7], s24 offen offset:2048 sc1 lds
  buffer_load_dwordx4 v2, s[4:7], s24 offen offset:3072 sc1 lds
AOPF_34:
  s_cmp_lt_u32 s43, 20
  s_cselect_b32 s24, 2, 8
  s_add_u32 s43, s43, s24
  v_mfma_f32_16x16x32_bf16 v[8:11], v[72:75], v[156:159], 0
  v_mfma_f32_16x16x32_bf16 v[12:15], v[76:79], v[156:159], 0
  v_mfma_f32_16x16x32_bf16 v[16:19], v[80:83], v[156:159], 0
  v_mfma_f32_16x16x32_bf16 v[20:23], v[84:87], v[156:159], 0
  v_mfma_f32_16x16x32_bf16 v[24:27], v[88:91], v[156:159], 0
  v_mfma_f32_16x16x32_bf16 v[28:31], v[92:95], v[156:159], 0
  v_mfma_f32_16x16x32_bf16 v[32:35], v[96:99], v[156:159], 0
  v_mfma_f32_16x16x32_bf16 v[36:39], v[100:103], v[156:159], 0
  v_mfma_f32_16x16x16_bf16 v[8:11], v[120:121], v[164:165], v[8:11]
  v_mfma_f32_16x16x16_bf16 v[12:15], v[120:121], v[166:167], v[12:15]
  v_mfma_f32_16x16x16_bf16 v[16:19], v[122:123], v[164:165], v[16:19]
  v_mfma_f32_16x16x16_bf16 v[20:23], v[122:123], v[166:167], v[20:23]
  v_mfma_f32_16x16x16_bf16 v[24:27], v[124:125], v[164:165], v[24:27]
  v_mfma_f32_16x16x16_bf16 v[28:31], v[124:125], v[166:167], v[28:31]
  v_mfma_f32_16x16x16_bf16 v[32:35], v[126:127], v[164:165], v[32:35]
  v_mfma_f32_16x16x16_bf16 v[36:39], v[126:127], v[166:167], v[36:39]
  v_mfma_f32_16x16x32_bf16 v[40:43], v[72:75], v[160:163], 0
  v_mfma_f32_16x16x32_bf16 v[44:47], v[76:79], v[160:163], 0
  v_mfma_f32_16x16x32_bf16 v[48:51], v[80:83], v[160:163], 0
  v_mfma_f32_16x16x32_bf16 v[52:55], v[84:87], v[160:163], 0
  v_mfma_f32_16x16x32_bf16 v[56:59], v[88:91], v[160:163], 0
  v_mfma_f32_16x16x32_bf16 v[60:63], v[92:95], v[160:163], 0
  v_mfma_f32_16x16x32_bf16 v[64:67], v[96:99], v[160:163], 0
  v_mfma_f32_16x16x32_bf16 v[68:71], v[100:103], v[160:163], 0
  v_mfma_f32_16x16x16_bf16 v[40:43], v[120:121], v[168:169], v[40:43]
  v_mfma_f32_16x16x16_bf16 v[44:47], v[120:121], v[170:171], v[44:47]
  v_mfma_f32_16x16x16_bf16 v[48:51], v[122:123], v[168:169], v[48:51]
  v_mfma_f32_16x16x16_bf16 v[52:55], v[122:123], v[170:171], v[52:55]
  v_mfma_f32_16x16x16_bf16 v[56:59], v[124:125], v[168:169], v[56:59]
  v_mfma_f32_16x16x16_bf16 v[60:63], v[124:125], v[170:171], v[60:63]
  v_mfma_f32_16x16x16_bf16 v[64:67], v[126:127], v[168:169], v[64:67]
  v_mfma_f32_16x16x16_bf16 v[68:71], v[126:127], v[170:171], v[68:71]
  s_lshl_b32 s24, s13, 13
  s_add_u32 s24, s24, s19
  v_add_u32 v7, s24, v2
  v_pk_mul_f32 v[8:9], v[8:9], v[176:177] op_sel_hi:[1,0]
  v_pk_mul_f32 v[10:11], v[10:11], v[176:177] op_sel_hi:[1,0]
  v_pk_mul_f32 v[12:13], v[12:13], v[176:177] op_sel_hi:[1,0]
  v_pk_mul_f32 v[14:15], v[14:15], v[176:177] op_sel_hi:[1,0]
  v_cvt_pk_bf16_f32 v8, v8, v9
  v_cvt_pk_bf16_f32 v9, v10, v11
  v_cvt_pk_bf16_f32 v10, v12, v13
  v_cvt_pk_bf16_f32 v11, v14, v15
  ds_write_b128 v7, v[8:11] offset:0
  v_pk_mul_f32 v[16:17], v[16:17], v[176:177] op_sel_hi:[1,0]
  v_pk_mul_f32 v[18:19], v[18:19], v[176:177] op_sel_hi:[1,0]
  v_pk_mul_f32 v[20:21], v[20:21], v[176:177] op_sel_hi:[1,0]
  v_pk_mul_f32 v[22:23], v[22:23], v[176:177] op_sel_hi:[1,0]
  v_cvt_pk_bf16_f32 v16, v16, v17
  v_cvt_pk_bf16_f32 v17, v18, v19
  v_cvt_pk_bf16_f32 v18, v20, v21
  v_cvt_pk_bf16_f32 v19, v22, v23
  ds_write_b128 v7, v[16:19] offset:1024
  v_pk_mul_f32 v[24:25], v[24:25], v[176:177] op_sel_hi:[1,0]
  v_pk_mul_f32 v[26:27], v[26:27], v[176:177] op_sel_hi:[1,0]
  v_pk_mul_f32 v[28:29], v[28:29], v[176:177] op_sel_hi:[1,0]
  v_pk_mul_f32 v[30:31], v[30:31], v[176:177] op_sel_hi:[1,0]
  v_cvt_pk_bf16_f32 v24, v24, v25
  v_cvt_pk_bf16_f32 v25, v26, v27
  v_cvt_pk_bf16_f32 v26, v28, v29
  v_cvt_pk_bf16_f32 v27, v30, v31
  ds_write_b128 v7, v[24:27] offset:2048
  v_pk_mul_f32 v[32:33], v[32:33], v[176:177] op_sel_hi:[1,0]
  v_pk_mul_f32 v[34:35], v[34:35], v[176:177] op_sel_hi:[1,0]
  v_pk_mul_f32 v[36:37], v[36:37], v[176:177] op_sel_hi:[1,0]
  v_pk_mul_f32 v[38:39], v[38:39], v[176:177] op_sel_hi:[1,0]
  v_cvt_pk_bf16_f32 v32, v32, v33
  v_cvt_pk_bf16_f32 v33, v34, v35
  v_cvt_pk_bf16_f32 v34, v36, v37
  v_cvt_pk_bf16_f32 v35, v38, v39
  ds_write_b128 v7, v[32:35] offset:3072
  v_pk_mul_f32 v[40:41], v[40:41], v[178:179] op_sel_hi:[1,0]
  v_pk_mul_f32 v[42:43], v[42:43], v[178:179] op_sel_hi:[1,0]
  v_pk_mul_f32 v[44:45], v[44:45], v[178:179] op_sel_hi:[1,0]
  v_pk_mul_f32 v[46:47], v[46:47], v[178:179] op_sel_hi:[1,0]
  v_cvt_pk_bf16_f32 v40, v40, v41
  v_cvt_pk_bf16_f32 v41, v42, v43
  v_cvt_pk_bf16_f32 v42, v44, v45
  v_cvt_pk_bf16_f32 v43, v46, v47
  ds_write_b128 v7, v[40:43] offset:4096
  v_pk_mul_f32 v[48:49], v[48:49], v[178:179] op_sel_hi:[1,0]
  v_pk_mul_f32 v[50:51], v[50:51], v[178:179] op_sel_hi:[1,0]
  v_pk_mul_f32 v[52:53], v[52:53], v[178:179] op_sel_hi:[1,0]
  v_pk_mul_f32 v[54:55], v[54:55], v[178:179] op_sel_hi:[1,0]
  v_cvt_pk_bf16_f32 v48, v48, v49
  v_cvt_pk_bf16_f32 v49, v50, v51
  v_cvt_pk_bf16_f32 v50, v52, v53
  v_cvt_pk_bf16_f32 v51, v54, v55
  ds_write_b128 v7, v[48:51] offset:5120
  v_pk_mul_f32 v[56:57], v[56:57], v[178:179] op_sel_hi:[1,0]
  v_pk_mul_f32 v[58:59], v[58:59], v[178:179] op_sel_hi:[1,0]
  v_pk_mul_f32 v[60:61], v[60:61], v[178:179] op_sel_hi:[1,0]
  v_pk_mul_f32 v[62:63], v[62:63], v[178:179] op_sel_hi:[1,0]
  v_cvt_pk_bf16_f32 v56, v56, v57
  v_cvt_pk_bf16_f32 v57, v58, v59
  v_cvt_pk_bf16_f32 v58, v60, v61
  v_cvt_pk_bf16_f32 v59, v62, v63
  ds_write_b128 v7, v[56:59] offset:6144
  v_pk_mul_f32 v[64:65], v[64:65], v[178:179] op_sel_hi:[1,0]
  v_pk_mul_f32 v[66:67], v[66:67], v[178:179] op_sel_hi:[1,0]
  v_pk_mul_f32 v[68:69], v[68:69], v[178:179] op_sel_hi:[1,0]
  v_pk_mul_f32 v[70:71], v[70:71], v[178:179] op_sel_hi:[1,0]
  v_cvt_pk_bf16_f32 v64, v64, v65
  v_cvt_pk_bf16_f32 v65, v66, v67
  v_cvt_pk_bf16_f32 v66, v68, v69
  v_cvt_pk_bf16_f32 v67, v70, v71
  ds_write_b128 v7, v[64:67] offset:7168
  s_waitcnt lgkmcnt(0)
  s_barrier
  v_add_u32 v7, s19, v2
  ds_read_b128 v[48:51], v7 offset:0
  ds_read_b128 v[52:55], v7 offset:4096
  ds_read_b128 v[56:59], v7 offset:1024
  ds_read_b128 v[60:63], v7 offset:5120
  ds_read_b128 v[64:67], v7 offset:2048
  ds_read_b128 v[68:71], v7 offset:6144
  ds_read_b128 v[72:75], v7 offset:3072
  s_waitcnt lgkmcnt(6)
  v_mfma_f32_16x16x32_bf16 v[8:11], a[0:3], v[48:51], 0
  v_mfma_f32_16x16x32_bf16 v[16:19], a[64:67], v[48:51], 0
  v_mfma_f32_16x16x32_bf16 v[24:27], a[128:131], v[48:51], 0
  v_mfma_f32_16x16x32_bf16 v[32:35], a[192:195], v[48:51], 0
  v_mfma_f32_16x16x32_bf16 v[40:43], v[192:195], v[48:51], 0
  ds_read_b128 v[76:79], v7 offset:7168
  s_waitcnt lgkmcnt(6)
  v_mfma_f32_16x16x32_bf16 v[12:15], a[0:3], v[52:55], 0
  v_mfma_f32_16x16x32_bf16 v[20:23], a[64:67], v[52:55], 0
  v_mfma_f32_16x16x32_bf16 v[28:31], a[128:131], v[52:55], 0
  v_mfma_f32_16x16x32_bf16 v[36:39], a[192:195], v[52:55], 0
  v_mfma_f32_16x16x32_bf16 v[44:47], v[192:195], v[52:55], 0
  ds_read_b128 v[48:51], v7 offset:8192
  s_waitcnt lgkmcnt(6)
  v_mfma_f32_16x16x32_bf16 v[8:11], a[4:7], v[56:59], v[8:11]
  v_mfma_f32_16x16x32_bf16 v[16:19], a[68:71], v[56:59], v[16:19]
  v_mfma_f32_16x16x32_bf16 v[24:27], a[132:135], v[56:59], v[24:27]
  v_mfma_f32_16x16x32_bf16 v[32:35], a[196:199], v[56:59], v[32:35]
  v_mfma_f32_16x16x32_bf16 v[40:43], v[196:199], v[56:59], v[40:43]
  ds_read_b128 v[52:55], v7 offset:12288
  s_waitcnt lgkmcnt(6)
  v_mfma_f32_16x16x32_bf16 v[12:15], a[4:7], v[60:63], v[12:15]
  v_mfma_f32_16x16x32_bf16 v[20:23], a[68:71], v[60:63], v[20:23]
  v_mfma_f32_16x16x32_bf16 v[28:31], a[132:135], v[60:63], v[28:31]
  v_mfma_f32_16x16x32_bf16 v[36:39], a[196:199], v[60:63], v[36:39]
  v_mfma_f32_16x16x32_bf16 v[44:47], v[196:199], v[60:63], v[44:47]
  ds_read_b128 v[56:59], v7 offset:9216
  s_waitcnt lgkmcnt(6)
  v_mfma_f32_16x16x32_bf16 v[8:11], a[8:11], v[64:67], v[8:11]
  v_mfma_f32_16x16x32_bf16 v[16:19], a[72:75], v[64:67], v[16:19]
  v_mfma_f32_16x16x32_bf16 v[24:27], a[136:139], v[64:67], v[24:27]
  v_mfma_f32_16x16x32_bf16 v[32:35], a[200:203], v[64:67], v[32:35]
  v_mfma_f32_16x16x32_bf16 v[40:43], v[200:203], v[64:67], v[40:43]
  ds_read_b128 v[60:63], v7 offset:13312
  s_waitcnt lgkmcnt(6)
  v_mfma_f32_16x16x32_bf16 v[12:15], a[8:11], v[68:71], v[12:15]
  v_mfma_f32_16x16x32_bf16 v[20:23], a[72:75], v[68:71], v[20:23]
  v_mfma_f32_16x16x32_bf16 v[28:31], a[136:139], v[68:71], v[28:31]
  v_mfma_f32_16x16x32_bf16 v[36:39], a[200:203], v[68:71], v[36:39]
  v_mfma_f32_16x16x32_bf16 v[44:47], v[200:203], v[68:71], v[44:47]
  ds_read_b128 v[64:67], v7 offset:10240
  s_waitcnt lgkmcnt(6)
  v_mfma_f32_16x16x32_bf16 v[8:11], a[12:15], v[72:75], v[8:11]
  v_mfma_f32_16x16x32_bf16 v[16:19], a[76:79], v[72:75], v[16:19]
  v_mfma_f32_16x16x32_bf16 v[24:27], a[140:143], v[72:75], v[24:27]
  v_mfma_f32_16x16x32_bf16 v[32:35], a[204:207], v[72:75], v[32:35]
  v_mfma_f32_16x16x32_bf16 v[40:43], v[204:207], v[72:75], v[40:43]
  ds_read_b128 v[68:71], v7 offset:14336
  s_waitcnt lgkmcnt(6)
  v_mfma_f32_16x16x32_bf16 v[12:15], a[12:15], v[76:79], v[12:15]
  v_mfma_f32_16x16x32_bf16 v[20:23], a[76:79], v[76:79], v[20:23]
  v_mfma_f32_16x16x32_bf16 v[28:31], a[140:143], v[76:79], v[28:31]
  v_mfma_f32_16x16x32_bf16 v[36:39], a[204:207], v[76:79], v[36:39]
  v_mfma_f32_16x16x32_bf16 v[44:47], v[204:207], v[76:79], v[44:47]
  ds_read_b128 v[72:75], v7 offset:11264
  s_waitcnt lgkmcnt(6)
  v_mfma_f32_16x16x32_bf16 v[8:11], a[16:19], v[48:51], v[8:11]
  v_mfma_f32_16x16x32_bf16 v[16:19], a[80:83], v[48:51], v[16:19]
  v_mfma_f32_16x16x32_bf16 v[24:27], a[144:147], v[48:51], v[24:27]
  v_mfma_f32_16x16x32_bf16 v[32:35], a[208:211], v[48:51], v[32:35]
  v_mfma_f32_16x16x32_bf16 v[40:43], v[208:211], v[48:51], v[40:43]
  ds_read_b128 v[76:79], v7 offset:15360
  s_waitcnt lgkmcnt(6)
  v_mfma_f32_16x16x32_bf16 v[12:15], a[16:19], v[52:55], v[12:15]
  v_mfma_f32_16x16x32_bf16 v[20:23], a[80:83], v[52:55], v[20:23]
  v_mfma_f32_16x16x32_bf16 v[28:31], a[144:147], v[52:55], v[28:31]
  v_mfma_f32_16x16x32_bf16 v[36:39], a[208:211], v[52:55], v[36:39]
  v_mfma_f32_16x16x32_bf16 v[44:47], v[208:211], v[52:55], v[44:47]
  ds_read_b128 v[48:51], v7 offset:16384
  s_waitcnt lgkmcnt(6)
  v_mfma_f32_16x16x32_bf16 v[8:11], a[20:23], v[56:59], v[8:11]
  v_mfma_f32_16x16x32_bf16 v[16:19], a[84:87], v[56:59], v[16:19]
  v_mfma_f32_16x16x32_bf16 v[24:27], a[148:151], v[56:59], v[24:27]
  v_mfma_f32_16x16x32_bf16 v[32:35], a[212:215], v[56:59], v[32:35]
  v_mfma_f32_16x16x32_bf16 v[40:43], v[212:215], v[56:59], v[40:43]
  ds_read_b128 v[52:55], v7 offset:20480
  s_waitcnt lgkmcnt(6)
  v_mfma_f32_16x16x32_bf16 v[12:15], a[20:23], v[60:63], v[12:15]
  v_mfma_f32_16x16x32_bf16 v[20:23], a[84:87], v[60:63], v[20:23]
  v_mfma_f32_16x16x32_bf16 v[28:31], a[148:151], v[60:63], v[28:31]
  v_mfma_f32_16x16x32_bf16 v[36:39], a[212:215], v[60:63], v[36:39]
  v_mfma_f32_16x16x32_bf16 v[44:47], v[212:215], v[60:63], v[44:47]
  ds_read_b128 v[56:59], v7 offset:17408
  s_waitcnt lgkmcnt(6)
  v_mfma_f32_16x16x32_bf16 v[8:11], a[24:27], v[64:67], v[8:11]
  v_mfma_f32_16x16x32_bf16 v[16:19], a[88:91], v[64:67], v[16:19]
  v_mfma_f32_16x16x32_bf16 v[24:27], a[152:155], v[64:67], v[24:27]
  v_mfma_f32_16x16x32_bf16 v[32:35], a[216:219], v[64:67], v[32:35]
  v_mfma_f32_16x16x32_bf16 v[40:43], v[216:219], v[64:67], v[40:43]
  ds_read_b128 v[60:63], v7 offset:21504
  s_waitcnt lgkmcnt(6)
  v_mfma_f32_16x16x32_bf16 v[12:15], a[24:27], v[68:71], v[12:15]
  v_mfma_f32_16x16x32_bf16 v[20:23], a[88:91], v[68:71], v[20:23]
  v_mfma_f32_16x16x32_bf16 v[28:31], a[152:155], v[68:71], v[28:31]
  v_mfma_f32_16x16x32_bf16 v[36:39], a[216:219], v[68:71], v[36:39]
  v_mfma_f32_16x16x32_bf16 v[44:47], v[216:219], v[68:71], v[44:47]
  ds_read_b128 v[64:67], v7 offset:18432
  s_waitcnt lgkmcnt(6)
  v_mfma_f32_16x16x32_bf16 v[8:11], a[28:31], v[72:75], v[8:11]
  v_mfma_f32_16x16x32_bf16 v[16:19], a[92:95], v[72:75], v[16:19]
  v_mfma_f32_16x16x32_bf16 v[24:27], a[156:159], v[72:75], v[24:27]
  v_mfma_f32_16x16x32_bf16 v[32:35], a[220:223], v[72:75], v[32:35]
  v_mfma_f32_16x16x32_bf16 v[40:43], v[220:223], v[72:75], v[40:43]
  ds_read_b128 v[68:71], v7 offset:22528
  s_waitcnt lgkmcnt(6)
  v_mfma_f32_16x16x32_bf16 v[12:15], a[28:31], v[76:79], v[12:15]
  v_mfma_f32_16x16x32_bf16 v[20:23], a[92:95], v[76:79], v[20:23]
  v_mfma_f32_16x16x32_bf16 v[28:31], a[156:159], v[76:79], v[28:31]
  v_mfma_f32_16x16x32_bf16 v[36:39], a[220:223], v[76:79], v[36:39]
  v_mfma_f32_16x16x32_bf16 v[44:47], v[220:223], v[76:79], v[44:47]
  ds_read_b128 v[72:75], v7 offset:19456
  s_waitcnt lgkmcnt(6)
  v_mfma_f32_16x16x32_bf16 v[8:11], a[32:35], v[48:51], v[8:11]
  v_mfma_f32_16x16x32_bf16 v[16:19], a[96:99], v[48:51], v[16:19]
  v_mfma_f32_16x16x32_bf16 v[24:27], a[160:163], v[48:51], v[24:27]
  v_mfma_f32_16x16x32_bf16 v[32:35], a[224:227], v[48:51], v[32:35]
  v_mfma_f32_16x16x32_bf16 v[40:43], v[224:227], v[48:51], v[40:43]
  ds_read_b128 v[76:79], v7 offset:23552
  s_waitcnt lgkmcnt(6)
  v_mfma_f32_16x16x32_bf16 v[12:15], a[32:35], v[52:55], v[12:15]
  v_mfma_f32_16x16x32_bf16 v[20:23], a[96:99], v[52:55], v[20:23]
  v_mfma_f32_16x16x32_bf16 v[28:31], a[160:163], v[52:55], v[28:31]
  v_mfma_f32_16x16x32_bf16 v[36:39], a[224:227], v[52:55], v[36:39]
  v_mfma_f32_16x16x32_bf16 v[44:47], v[224:227], v[52:55], v[44:47]
  ds_read_b128 v[48:51], v7 offset:24576
  s_waitcnt lgkmcnt(6)
  v_mfma_f32_16x16x32_bf16 v[8:11], a[36:39], v[56:59], v[8:11]
  v_mfma_f32_16x16x32_bf16 v[16:19], a[100:103], v[56:59], v[16:19]
  v_mfma_f32_16x16x32_bf16 v[24:27], a[164:167], v[56:59], v[24:27]
  v_mfma_f32_16x16x32_bf16 v[32:35], a[228:231], v[56:59], v[32:35]
  v_mfma_f32_16x16x32_bf16 v[40:43], v[228:231], v[56:59], v[40:43]
  ds_read_b128 v[52:55], v7 offset:28672
  s_waitcnt lgkmcnt(6)
  v_mfma_f32_16x16x32_bf16 v[12:15], a[36:39], v[60:63], v[12:15]
  v_mfma_f32_16x16x32_bf16 v[20:23], a[100:103], v[60:63], v[20:23]
  v_mfma_f32_16x16x32_bf16 v[28:31], a[164:167], v[60:63], v[28:31]
  v_mfma_f32_16x16x32_bf16 v[36:39], a[228:231], v[60:63], v[36:39]
  v_mfma_f32_16x16x32_bf16 v[44:47], v[228:231], v[60:63], v[44:47]
  ds_read_b128 v[56:59], v7 offset:25600
  s_waitcnt lgkmcnt(6)
  v_mfma_f32_16x16x32_bf16 v[8:11], a[40:43], v[64:67], v[8:11]
  v_mfma_f32_16x16x32_bf16 v[16:19], a[104:107], v[64:67], v[16:19]
  v_mfma_f32_16x16x32_bf16 v[24:27], a[168:171], v[64:67], v[24:27]
  v_mfma_f32_16x16x32_bf16 v[32:35], a[232:235], v[64:67], v[32:35]
  v_mfma_f32_16x16x32_bf16 v[40:43], v[232:235], v[64:67], v[40:43]
  ds_read_b128 v[60:63], v7 offset:29696
  s_waitcnt lgkmcnt(6)
  v_mfma_f32_16x16x32_bf16 v[12:15], a[40:43], v[68:71], v[12:15]
  v_mfma_f32_16x16x32_bf16 v[20:23], a[104:107], v[68:71], v[20:23]
  v_mfma_f32_16x16x32_bf16 v[28:31], a[168:171], v[68:71], v[28:31]
  v_mfma_f32_16x16x32_bf16 v[36:39], a[232:235], v[68:71], v[36:39]
  v_mfma_f32_16x16x32_bf16 v[44:47], v[232:235], v[68:71], v[44:47]
  ds_read_b128 v[64:67], v7 offset:26624
  s_waitcnt lgkmcnt(6)
  v_mfma_f32_16x16x32_bf16 v[8:11], a[44:47], v[72:75], v[8:11]
  v_mfma_f32_16x16x32_bf16 v[16:19], a[108:111], v[72:75], v[16:19]
  v_mfma_f32_16x16x32_bf16 v[24:27], a[172:175], v[72:75], v[24:27]
  v_mfma_f32_16x16x32_bf16 v[32:35], a[236:239], v[72:75], v[32:35]
  v_mfma_f32_16x16x32_bf16 v[40:43], v[236:239], v[72:75], v[40:43]
  ds_read_b128 v[68:71], v7 offset:30720
  s_waitcnt lgkmcnt(6)
  v_mfma_f32_16x16x32_bf16 v[12:15], a[44:47], v[76:79], v[12:15]
  v_mfma_f32_16x16x32_bf16 v[20:23], a[108:111], v[76:79], v[20:23]
  v_mfma_f32_16x16x32_bf16 v[28:31], a[172:175], v[76:79], v[28:31]
  v_mfma_f32_16x16x32_bf16 v[36:39], a[236:239], v[76:79], v[36:39]
  v_mfma_f32_16x16x32_bf16 v[44:47], v[236:239], v[76:79], v[44:47]
  ds_read_b128 v[72:75], v7 offset:27648
  s_waitcnt lgkmcnt(6)
  v_mfma_f32_16x16x32_bf16 v[8:11], a[48:51], v[48:51], v[8:11]
  v_mfma_f32_16x16x32_bf16 v[16:19], a[112:115], v[48:51], v[16:19]
  v_mfma_f32_16x16x32_bf16 v[24:27], a[176:179], v[48:51], v[24:27]
  v_mfma_f32_16x16x32_bf16 v[32:35], a[240:243], v[48:51], v[32:35]
  v_mfma_f32_16x16x32_bf16 v[40:43], v[240:243], v[48:51], v[40:43]
  ds_read_b128 v[76:79], v7 offset:31744
  s_waitcnt lgkmcnt(6)
  v_mfma_f32_16x16x32_bf16 v[12:15], a[48:51], v[52:55], v[12:15]
  v_mfma_f32_16x16x32_bf16 v[20:23], a[112:115], v[52:55], v[20:23]
  v_mfma_f32_16x16x32_bf16 v[28:31], a[176:179], v[52:55], v[28:31]
  v_mfma_f32_16x16x32_bf16 v[36:39], a[240:243], v[52:55], v[36:39]
  v_mfma_f32_16x16x32_bf16 v[44:47], v[240:243], v[52:55], v[44:47]
  s_waitcnt lgkmcnt(5)
  v_mfma_f32_16x16x32_bf16 v[8:11], a[52:55], v[56:59], v[8:11]
  v_mfma_f32_16x16x32_bf16 v[16:19], a[116:119], v[56:59], v[16:19]
  v_mfma_f32_16x16x32_bf16 v[24:27], a[180:183], v[56:59], v[24:27]
  v_mfma_f32_16x16x32_bf16 v[32:35], a[244:247], v[56:59], v[32:35]
  v_mfma_f32_16x16x32_bf16 v[40:43], v[244:247], v[56:59], v[40:43]
  s_waitcnt lgkmcnt(4)
  v_mfma_f32_16x16x32_bf16 v[12:15], a[52:55], v[60:63], v[12:15]
  v_mfma_f32_16x16x32_bf16 v[20:23], a[116:119], v[60:63], v[20:23]
  v_mfma_f32_16x16x32_bf16 v[28:31], a[180:183], v[60:63], v[28:31]
  v_mfma_f32_16x16x32_bf16 v[36:39], a[244:247], v[60:63], v[36:39]
  v_mfma_f32_16x16x32_bf16 v[44:47], v[244:247], v[60:63], v[44:47]
  s_waitcnt lgkmcnt(3)
  v_mfma_f32_16x16x32_bf16 v[8:11], a[56:59], v[64:67], v[8:11]
  v_mfma_f32_16x16x32_bf16 v[16:19], a[120:123], v[64:67], v[16:19]
  v_mfma_f32_16x16x32_bf16 v[24:27], a[184:187], v[64:67], v[24:27]
  v_mfma_f32_16x16x32_bf16 v[32:35], a[248:251], v[64:67], v[32:35]
  v_mfma_f32_16x16x32_bf16 v[40:43], v[248:251], v[64:67], v[40:43]
  s_waitcnt lgkmcnt(2)
  v_mfma_f32_16x16x32_bf16 v[12:15], a[56:59], v[68:71], v[12:15]
  v_mfma_f32_16x16x32_bf16 v[20:23], a[120:123], v[68:71], v[20:23]
  v_mfma_f32_16x16x32_bf16 v[28:31], a[184:187], v[68:71], v[28:31]
  v_mfma_f32_16x16x32_bf16 v[36:39], a[248:251], v[68:71], v[36:39]
  v_mfma_f32_16x16x32_bf16 v[44:47], v[248:251], v[68:71], v[44:47]
  s_waitcnt lgkmcnt(1)
  v_mfma_f32_16x16x32_bf16 v[8:11], a[60:63], v[72:75], v[8:11]
  v_mfma_f32_16x16x32_bf16 v[16:19], a[124:127], v[72:75], v[16:19]
  v_mfma_f32_16x16x32_bf16 v[24:27], a[188:191], v[72:75], v[24:27]
  v_mfma_f32_16x16x32_bf16 v[32:35], a[252:255], v[72:75], v[32:35]
  v_mfma_f32_16x16x32_bf16 v[40:43], v[252:255], v[72:75], v[40:43]
  s_waitcnt lgkmcnt(0)
  v_mfma_f32_16x16x32_bf16 v[12:15], a[60:63], v[76:79], v[12:15]
  v_mfma_f32_16x16x32_bf16 v[20:23], a[124:127], v[76:79], v[20:23]
  v_mfma_f32_16x16x32_bf16 v[28:31], a[188:191], v[76:79], v[28:31]
  v_mfma_f32_16x16x32_bf16 v[36:39], a[252:255], v[76:79], v[36:39]
  v_mfma_f32_16x16x32_bf16 v[44:47], v[252:255], v[76:79], v[44:47]
  s_add_u32 s24, s18, 36864
  buffer_store_dwordx4 v[8:11], v6, s[4:7], s18 offen offset:0 sc1
  s_nop 1
  buffer_store_dwordx4 v[12:15], v6, s[4:7], s24 offen offset:0 sc1
  buffer_store_dwordx4 v[16:19], v6, s[4:7], s18 offen offset:256 sc1
  buffer_store_dwordx4 v[20:23], v6, s[4:7], s24 offen offset:256 sc1
  buffer_store_dwordx4 v[24:27], v6, s[4:7], s18 offen offset:512 sc1
  buffer_store_dwordx4 v[28:31], v6, s[4:7], s24 offen offset:512 sc1
  buffer_store_dwordx4 v[32:35], v6, s[4:7], s18 offen offset:768 sc1
  buffer_store_dwordx4 v[36:39], v6, s[4:7], s24 offen offset:768 sc1
  s_cmp_ge_u32 s13, 2
  s_cbranch_scc1 AON5
  buffer_store_dwordx4 v[40:43], v6, s[4:7], s18 offen offset:1024 sc1
  buffer_store_dwordx4 v[44:47], v6, s[4:7], s24 offen offset:1024 sc1
AON5:
  s_waitcnt vmcnt(0)
  s_barrier
  s_lshl_b32 s24, s15, 1
  s_add_u32 s24, s24, s14
  s_lshr_b32 s25, s24, 3
  s_and_b32 s24, s24, 7
  s_lshl_b32 s24, s24, 2
  s_lshl_b32 s24, 1, s24
  s_cmp_lg_u32 s13, 0
  s_cbranch_scc1 SIG_41
  s_lshl_b32 s29, s25, 2
  s_add_u32 s29, s29, 192
  v_mov_b32 v8, s29
  v_mov_b32 v9, s24
  s_mov_b64 exec, 1
  global_atomic_add v8, v9, s[92:93]
  s_mov_b64 exec, -1
SIG_41:
  s_cmp_lt_u32 s15, 20
  s_cselect_b32 s24, 2, 8
  s_add_u32 s15, s15, s24
  s_lshl_b32 s25, s15, 5
  s_add_u32 s25, s25, s45
  s_lshl_b32 s17, s25, 12
  s_add_u32 s17, s17, 88080384
  s_lshl_b32 s25, s15, 3
  s_add_u32 s25, s25, s12
  s_mul_i32 s18, s25, 73728
  s_mul_i32 s25, s14, 1152
  s_add_u32 s18, s18, s25
  s_lshl_b32 s25, s13, 6
  s_add_u32 s18, s18, s25
  s_add_u32 s18, s18, 100663296
  s_cmp_lt_u32 s15, 64
  s_cbranch_scc1 AOL
  s_branch K_DONE
R_CHAIN:
  s_mov_b32 s12, s28
  s_mov_b32 s52, 0
R_CHAIN2:
  v_and_b32 v4, 63, v0
  v_lshlrev_b32 v0, 4, v4
  v_lshrrev_b32 v8, 3, v4
  v_and_b32 v9, 7, v4
  v_lshlrev_b32 v9, 4, v9
  v_lshl_add_u32 v5, v8, 13, v9
  v_lshrrev_b32 v8, 5, v4
  v_lshlrev_b32 v10, 4, v8
  v_bfe_u32 v8, v4, 3, 1
  v_lshl_add_u32 v10, v8, 3, v10
  v_bfe_u32 v8, v4, 4, 1
  v_lshl_add_u32 v10, v8, 2, v10
  v_bfe_u32 v8, v4, 2, 1
  v_add_u32 v10, v10, v8
  v_and_b32 v9, 3, v4
  v_lshlrev_b32 v9, 3, v9
  s_and_b32 s27, s13, 1
  s_lshl_b32 s27, s27, 6
  v_lshl_add_u32 v11, v10, 7, v9
  v_add_u32 v11, s27, v11
  s_mul_i32 s34, s13, 36864
  s_add_u32 s34, s34, 16384
  s_lshl_b32 s35, s13, 12
  s_and_b32 s27, s13, 2
  s_lshl_b32 s37, s27, 12
  v_add_u32 v14, s37, v11
  s_mul_i32 s37, s27, 36864
  s_add_u32 s37, s37, 16384
  v_add_u32 v13, s37, v11
  v_add_u32 v15, 36864, v13
  v_mul_u32_u24 v12, 1152, v10
  v_add_u32 v12, v12, v9
  s_mul_i32 s37, s13, 288
  s_add_u32 s37, s37, 16384
  v_add_u32 v12, s37, v12
  v_add_u32 v16, 73728, v12
  v_add_u32 v2, s34, v0
  v_add_u32 v17, s35, v0
  v_bfe_u32 v8, v4, 1, 1
  v_mul_u32_u24 v8, 0xAAAA, v8
  v_add_u32 v1, 0x4444, v8
  s_lshl_b32 s43, s12, 8
  s_lshl_b32 s27, s27, 6
  s_add_u32 s43, s43, s27
  s_mul_i32 s36, s12, 147456
  s_mul_i32 s37, s13, 36864
  s_add_u32 s36, s36, s37
  s_mov_b32 s51, 0
  s_and_b32 s37, s13, 1
  s_mov_b32 s8, s82
  s_mov_b32 s9, s83
  s_mov_b32 s10, 4718592
  s_mov_b32 s11, 0x20000
  s_add_u32 m0, s34, 0
  s_add_u32 s27, s36, 0
  s_nop 0
  buffer_load_dwordx4 v0, s[8:11], s27 offen offset:0 lds
  buffer_load_dwordx4 v0, s[8:11], s27 offen offset:1024 lds
  buffer_load_dwordx4 v0, s[8:11], s27 offen offset:2048 lds
  buffer_load_dwordx4 v0, s[8:11], s27 offen offset:3072 lds
  s_add_u32 m0, s34, 4096
  s_add_u32 s27, s36, 4096
  s_nop 0
  buffer_load_dwordx4 v0, s[8:11], s27 offen offset:0 lds
  buffer_load_dwordx4 v0, s[8:11], s27 offen offset:1024 lds
  buffer_load_dwordx4 v0, s[8:11], s27 offen offset:2048 lds
  buffer_load_dwordx4 v0, s[8:11], s27 offen offset:3072 lds
  s_add_u32 m0, s34, 8192
  s_add_u32 s27, s36, 8192
  s_nop 0
  buffer_load_dwordx4 v0, s[8:11], s27 offen offset:0 lds
  buffer_load_dwordx4 v0, s[8:11], s27 offen offset:1024 lds
  buffer_load_dwordx4 v0, s[8:11], s27 offen offset:2048 lds
  buffer_load_dwordx4 v0, s[8:11], s27 offen offset:3072 lds
  s_add_u32 m0, s34, 12288
  s_add_u32 s27, s36, 12288
  s_nop 0
  buffer_load_dwordx4 v0, s[8:11], s27 offen offset:0 lds
  buffer_load_dwordx4 v0, s[8:11], s27 offen offset:1024 lds
  buffer_load_dwordx4 v0, s[8:11], s27 offen offset:2048 lds
  buffer_load_dwordx4 v0, s[8:11], s27 offen offset:3072 lds
  s_add_u32 m0, s34, 16384
  s_add_u32 s27, s36, 16384
  s_nop 0
  buffer_load_dwordx4 v0, s[8:11], s27 offen offset:0 lds
  buffer_load_dwordx4 v0, s[8:11], s27 offen offset:1024 lds
  buffer_load_dwordx4 v0, s[8:11], s27 offen offset:2048 lds
  buffer_load_dwordx4 v0, s[8:11], s27 offen offset:3072 lds
  s_add_u32 m0, s34, 20480
  s_add_u32 s27, s36, 20480
  s_nop 0
  buffer_load_dwordx4 v0, s[8:11], s27 offen offset:0 lds
  buffer_load_dwordx4 v0, s[8:11], s27 offen offset:1024 lds
  buffer_load_dwordx4 v0, s[8:11], s27 offen offset:2048 lds
  buffer_load_dwordx4 v0, s[8:11], s27 offen offset:3072 lds
  s_add_u32 m0, s34, 24576
  s_add_u32 s27, s36, 24576
  s_nop 0
  buffer_load_dwordx4 v0, s[8:11], s27 offen offset:0 lds
  buffer_load_dwordx4 v0, s[8:11], s27 offen offset:1024 lds
  buffer_load_dwordx4 v0, s[8:11], s27 offen offset:2048 lds
  buffer_load_dwordx4 v0, s[8:11], s27 offen offset:3072 lds
  s_add_u32 m0, s34, 28672
  s_add_u32 s27, s36, 28672
  s_nop 0
  buffer_load_dwordx4 v0, s[8:11], s27 offen offset:0 lds
  buffer_load_dwordx4 v0, s[8:11], s27 offen offset:1024 lds
  buffer_load_dwordx4 v0, s[8:11], s27 offen offset:2048 lds
  buffer_load_dwordx4 v0, s[8:11], s27 offen offset:3072 lds
  s_add_u32 m0, s34, 32768
  s_add_u32 s27, s36, 32768
  s_nop 0
  buffer_load_dwordx4 v0, s[8:11], s27 offen offset:0 lds
  buffer_load_dwordx4 v0, s[8:11], s27 offen offset:1024 lds
  buffer_load_dwordx4 v0, s[8:11], s27 offen offset:2048 lds
  buffer_load_dwordx4 v0, s[8:11], s27 offen offset:3072 lds
  s_mov_b32 s8, s76
  s_mov_b32 s9, s77
  s_mov_b32 s10, 4718592
  s_mov_b32 s11, 0x20000
  s_mov_b32 s27, 917504
  s_cmp_eq_u32 s37, 1
  s_cselect_b32 s27, 3276800, s27
  s_add_u32 s27, s27, s43
  buffer_load_dwordx4 a[0:3], v5, s[8:11], s27 offen
  s_mov_b32 s27, 983040
  s_cmp_eq_u32 s37, 1
  s_cselect_b32 s27, 3342336, s27
  s_add_u32 s27, s27, s43
  buffer_load_dwordx4 a[4:7], v5, s[8:11], s27 offen
  s_mov_b32 s27, 2097152
  s_cmp_eq_u32 s37, 1
  s_cselect_b32 s27, 4456448, s27
  s_add_u32 s27, s27, s43
  buffer_load_dwordx4 a[8:11], v5, s[8:11], s27 offen
  s_mov_b32 s27, 2162688
  s_cmp_eq_u32 s37, 1
  s_cselect_b32 s27, 4521984, s27
  s_add_u32 s27, s27, s43
  buffer_load_dwordx4 a[12:15], v5, s[8:11], s27 offen
  s_mov_b32 s27, 1048576
  s_cmp_eq_u32 s37, 1
  s_cselect_b32 s27, 3407872, s27
  s_add_u32 s27, s27, s43
  buffer_load_dwordx4 a[16:19], v5, s[8:11], s27 offen
  s_mov_b32 s27, 1114112
  s_cmp_eq_u32 s37, 1
  s_cselect_b32 s27, 3473408, s27
  s_add_u32 s27, s27, s43
  buffer_load_dwordx4 a[20:23], v5, s[8:11], s27 offen
  s_mov_b32 s27, 2228224
  s_cmp_eq_u32 s37, 1
  s_cselect_b32 s27, 4587520, s27
  s_add_u32 s27, s27, s43
  buffer_load_dwordx4 a[24:27], v5, s[8:11], s27 offen
  s_mov_b32 s27, 2293760
  s_cmp_eq_u32 s37, 1
  s_cselect_b32 s27, 4653056, s27
  s_add_u32 s27, s27, s43
  buffer_load_dwordx4 a[28:31], v5, s[8:11], s27 offen
  s_mov_b32 s27, 393216
  s_cmp_eq_u32 s37, 1
  s_cselect_b32 s27, 2752512, s27
  s_add_u32 s27, s27, s43
  buffer_load_dwordx4 a[32:35], v5, s[8:11], s27 offen
  s_mov_b32 s27, 458752
  s_cmp_eq_u32 s37, 1
  s_cselect_b32 s27, 2818048, s27
  s_add_u32 s27, s27, s43
  buffer_load_dwordx4 a[36:39], v5, s[8:11], s27 offen
  s_mov_b32 s27, 1572864
  s_cmp_eq_u32 s37, 1
  s_cselect_b32 s27, 3932160, s27
  s_add_u32 s27, s27, s43
  buffer_load_dwordx4 a[40:43], v5, s[8:11], s27 offen
  s_mov_b32 s27, 1638400
  s_cmp_eq_u32 s37, 1
  s_cselect_b32 s27, 3997696, s27
  s_add_u32 s27, s27, s43
  buffer_load_dwordx4 a[44:47], v5, s[8:11], s27 offen
  s_mov_b32 s27, 655360
  s_cmp_eq_u32 s37, 1
  s_cselect_b32 s27, 3014656, s27
  s_add_u32 s27, s27, s43
  buffer_load_dwordx4 a[48:51], v5, s[8:11], s27 offen
  s_mov_b32 s27, 720896
  s_cmp_eq_u32 s37, 1
  s_cselect_b32 s27, 3080192, s27
  s_add_u32 s27, s27, s43
  buffer_load_dwordx4 a[52:55], v5, s[8:11], s27 offen
  s_mov_b32 s27, 1835008
  s_cmp_eq_u32 s37, 1
  s_cselect_b32 s27, 4194304, s27
  s_add_u32 s27, s27, s43
  buffer_load_dwordx4 a[56:59], v5, s[8:11], s27 offen
  s_mov_b32 s27, 1900544
  s_cmp_eq_u32 s37, 1
  s_cselect_b32 s27, 4259840, s27
  s_add_u32 s27, s27, s43
  buffer_load_dwordx4 a[60:63], v5, s[8:11], s27 offen
  s_mov_b32 s27, 0
  s_cmp_eq_u32 s37, 1
  s_cselect_b32 s27, 2359296, s27
  s_add_u32 s27, s27, s43
  buffer_load_dwordx4 a[64:67], v5, s[8:11], s27 offen
  s_mov_b32 s27, 65536
  s_cmp_eq_u32 s37, 1
  s_cselect_b32 s27, 2424832, s27
  s_add_u32 s27, s27, s43
  buffer_load_dwordx4 a[68:71], v5, s[8:11], s27 offen
  s_mov_b32 s27, 1179648
  s_cmp_eq_u32 s37, 1
  s_cselect_b32 s27, 3538944, s27
  s_add_u32 s27, s27, s43
  buffer_load_dwordx4 a[72:75], v5, s[8:11], s27 offen
  s_mov_b32 s27, 1245184
  s_cmp_eq_u32 s37, 1
  s_cselect_b32 s27, 3604480, s27
  s_add_u32 s27, s27, s43
  buffer_load_dwordx4 a[76:79], v5, s[8:11], s27 offen
  s_mov_b32 s27, 131072
  s_cmp_eq_u32 s37, 1
  s_cselect_b32 s27, 2490368, s27
  s_add_u32 s27, s27, s43
  buffer_load_dwordx4 a[80:83], v5, s[8:11], s27 offen
  s_mov_b32 s27, 196608
  s_cmp_eq_u32 s37, 1
  s_cselect_b32 s27, 2555904, s27
  s_add_u32 s27, s27, s43
  buffer_load_dwordx4 a[84:87], v5, s[8:11], s27 offen
  s_mov_b32 s27, 1310720
  s_cmp_eq_u32 s37, 1
  s_cselect_b32 s27, 3670016, s27
  s_add_u32 s27, s27, s43
  buffer_load_dwordx4 a[88:91], v5, s[8:11], s27 offen
  s_mov_b32 s27, 1376256
  s_cmp_eq_u32 s37, 1
  s_cselect_b32 s27, 3735552, s27
  s_add_u32 s27, s27, s43
  buffer_load_dwordx4 a[92:95], v5, s[8:11], s27 offen
  s_cmp_eq_u32 s52, 0
  s_cbranch_scc1 CH_OK
  s_cmp_lg_u32 s13, 0
  s_cbranch_scc1 CL_WAITB
  s_mov_b32 s25, s55
  s_mov_b32 s26, s54
  s_mov_b32 s28, 0
  s_lshl_b32 s27, 1, s25
  s_lshr_b32 s53, s2, 2
  s_mov_b64 exec, 1
  s_waitcnt vmcnt(60)
  s_branch CL_CHKB
CL_TRYB:
  s_lshl_b32 s27, 1, s25
  s_lshl_b32 s29, s26, 2
  v_mov_b32 v248, s29
  v_mov_b32 v249, s27
  global_atomic_or v250, v248, v249, s[92:93] sc0
  s_waitcnt vmcnt(0)
CL_CHKB:
  v_readfirstlane_b32 s30, v250
  s_nop 0
  s_and_b32 s31, s30, s27
  s_cbranch_scc0 CL_GOTB
  s_not_b32 s31, s30
  s_cbranch_scc0 CL_FULLB
  s_mul_i32 s53, s53, 13
  s_add_u32 s53, s53, s2
  s_add_u32 s53, s53, 7
  s_and_b32 s29, s53, 31
  s_mov_b32 s30, s31
  s_lshr_b64 s[30:31], s[30:31], s29
  s_ff1_i32_b32 s25, s30
  s_add_u32 s25, s25, s29
  s_and_b32 s25, s25, 31
  s_branch CL_TRYB
CL_FULLB:
  s_add_u32 s28, s28, 1
  s_sub_u32 s26, 8, s28
  s_cmp_gt_u32 s28, 8
  s_cbranch_scc1 CL_NONEB
  s_mov_b32 s25, 0
  s_cmp_lg_u32 s26, 0
  s_cbranch_scc1 CL_TRYB
  v_mov_b32 v248, 48
  v_mov_b32 v249, 1
  global_atomic_or v250, v248, v249, s[92:93] sc0
  s_waitcnt vmcnt(0)
  s_branch CL_TRYB
CL_NONEB:
  s_mov_b32 s26, 8
  s_mov_b32 s25, 0
CL_GOTB:
  s_lshl_b32 s26, s26, 5
  s_add_u32 s26, s26, s25
  v_mov_b32 v248, 0
  v_mov_b32 v249, s26
  ds_write_b32 v248, v249
  s_waitcnt lgkmcnt(0)
  s_mov_b64 exec, -1
CL_WAITB:
  s_barrier
  v_mov_b32 v248, 0
  ds_read_b32 v249, v248
  s_waitcnt lgkmcnt(0)
  v_readfirstlane_b32 s26, v249
  s_barrier
  s_cmp_eq_u32 s26, s12
  s_cbranch_scc1 CH_OK
  s_waitcnt vmcnt(0)
  s_barrier
  s_lshl_b32 s24, s13, 6
  v_lshrrev_b32 v0, 4, v0
  v_or_b32 v0, s24, v0
  s_branch ROLE
CH_OK:
  s_waitcnt vmcnt(24)
  s_barrier
  s_mov_b32 s8, s78
  s_mov_b32 s9, s79
  s_mov_b32 s10, 4718592
  s_mov_b32 s11, 0x20000
  s_mov_b32 s27, 786432
  s_cmp_eq_u32 s37, 1
  s_cselect_b32 s27, 3145728, s27
  s_add_u32 s27, s27, s43
  buffer_load_dwordx4 a[96:99], v5, s[8:11], s27 offen
  s_mov_b32 s27, 851968
  s_cmp_eq_u32 s37, 1
  s_cselect_b32 s27, 3211264, s27
  s_add_u32 s27, s27, s43
  buffer_load_dwordx4 a[100:103], v5, s[8:11], s27 offen
  s_mov_b32 s27, 1966080
  s_cmp_eq_u32 s37, 1
  s_cselect_b32 s27, 4325376, s27
  s_add_u32 s27, s27, s43
  buffer_load_dwordx4 a[104:107], v5, s[8:11], s27 offen
  s_mov_b32 s27, 2031616
  s_cmp_eq_u32 s37, 1
  s_cselect_b32 s27, 4390912, s27
  s_add_u32 s27, s27, s43
  buffer_load_dwordx4 a[108:111], v5, s[8:11], s27 offen
  s_mov_b32 s27, 917504
  s_cmp_eq_u32 s37, 1
  s_cselect_b32 s27, 3276800, s27
  s_add_u32 s27, s27, s43
  buffer_load_dwordx4 a[112:115], v5, s[8:11], s27 offen
  s_mov_b32 s27, 983040
  s_cmp_eq_u32 s37, 1
  s_cselect_b32 s27, 3342336, s27
  s_add_u32 s27, s27, s43
  buffer_load_dwordx4 a[116:119], v5, s[8:11], s27 offen
  s_mov_b32 s27, 2097152
  s_cmp_eq_u32 s37, 1
  s_cselect_b32 s27, 4456448, s27
  s_add_u32 s27, s27, s43
  buffer_load_dwordx4 a[120:123], v5, s[8:11], s27 offen
  s_mov_b32 s27, 2162688
  s_cmp_eq_u32 s37, 1
  s_cselect_b32 s27, 4521984, s27
  s_add_u32 s27, s27, s43
  buffer_load_dwordx4 a[124:127], v5, s[8:11], s27 offen
  s_mov_b32 s27, 393216
  s_cmp_eq_u32 s37, 1
  s_cselect_b32 s27, 2752512, s27
  s_add_u32 s27, s27, s43
  buffer_load_dwordx4 a[128:131], v5, s[8:11], s27 offen
  s_mov_b32 s27, 458752
  s_cmp_eq_u32 s37, 1
  s_cselect_b32 s27, 2818048, s27
  s_add_u32 s27, s27, s43
  buffer_load_dwordx4 a[132:135], v5, s[8:11], s27 offen
  s_mov_b32 s27, 1572864
  s_cmp_eq_u32 s37, 1
  s_cselect_b32 s27, 3932160, s27
  s_add_u32 s27, s27, s43
  buffer_load_dwordx4 a[136:139], v5, s[8:11], s27 offen
  s_mov_b32 s27, 1638400
  s_cmp_eq_u32 s37, 1
  s_cselect_b32 s27, 3997696, s27
  s_add_u32 s27, s27, s43
  buffer_load_dwordx4 a[140:143], v5, s[8:11], s27 offen
  s_mov_b32 s27, 524288
  s_cmp_eq_u32 s37, 1
  s_cselect_b32 s27, 2883584, s27
  s_add_u32 s27, s27, s43
  buffer_load_dwordx4 a[144:147], v5, s[8:11], s27 offen
  s_mov_b32 s27, 589824
  s_cmp_eq_u32 s37, 1
  s_cselect_b32 s27, 2949120, s27
  s_add_u32 s27, s27, s43
  buffer_load_dwordx4 a[148:151], v5, s[8:11], s27 offen
  s_mov_b32 s27, 1703936
  s_cmp_eq_u32 s37, 1
  s_cselect_b32 s27, 4063232, s27
  s_add_u32 s27, s27, s43
  buffer_load_dwordx4 a[152:155], v5, s[8:11], s27 offen
  s_mov_b32 s27, 1769472
  s_cmp_eq_u32 s37, 1
  s_cselect_b32 s27, 4128768, s27
  s_add_u32 s27, s27, s43
  buffer_load_dwordx4 a[156:159], v5, s[8:11], s27 offen
  s_mov_b32 s27, 655360
  s_cmp_eq_u32 s37, 1
  s_cselect_b32 s27, 3014656, s27
  s_add_u32 s27, s27, s43
  buffer_load_dwordx4 a[160:163], v5, s[8:11], s27 offen
  s_mov_b32 s27, 720896
  s_cmp_eq_u32 s37, 1
  s_cselect_b32 s27, 3080192, s27
  s_add_u32 s27, s27, s43
  buffer_load_dwordx4 a[164:167], v5, s[8:11], s27 offen
  s_mov_b32 s27, 1835008
  s_cmp_eq_u32 s37, 1
  s_cselect_b32 s27, 4194304, s27
  s_add_u32 s27, s27, s43
  buffer_load_dwordx4 a[168:171], v5, s[8:11], s27 offen
  s_mov_b32 s27, 1900544
  s_cmp_eq_u32 s37, 1
  s_cselect_b32 s27, 4259840, s27
  s_add_u32 s27, s27, s43
  buffer_load_dwordx4 a[172:175], v5, s[8:11], s27 offen
  s_mov_b32 s27, 131072
  s_cmp_eq_u32 s37, 1
  s_cselect_b32 s27, 2490368, s27
  s_add_u32 s27, s27, s43
  buffer_load_dwordx4 a[176:179], v5, s[8:11], s27 offen
  s_mov_b32 s27, 196608
  s_cmp_eq_u32 s37, 1
  s_cselect_b32 s27, 2555904, s27
  s_add_u32 s27, s27, s43
  buffer_load_dwordx4 a[180:183], v5, s[8:11], s27 offen
  s_mov_b32 s27, 1310720
  s_cmp_eq_u32 s37, 1
  s_cselect_b32 s27, 3670016, s27
  s_add_u32 s27, s27, s43
  buffer_load_dwordx4 a[184:187], v5, s[8:11], s27 offen
  s_mov_b32 s27, 1376256
  s_cmp_eq_u32 s37, 1
  s_cselect_b32 s27, 3735552, s27
  s_add_u32 s27, s27, s43
  buffer_load_dwordx4 a[188:191], v5, s[8:11], s27 offen
  s_mov_b32 s27, 262144
  s_cmp_eq_u32 s37, 1
  s_cselect_b32 s27, 2621440, s27
  s_add_u32 s27, s27, s43
  buffer_load_dwordx4 a[192:195], v5, s[8:11], s27 offen
  s_mov_b32 s27, 327680
  s_cmp_eq_u32 s37, 1
  s_cselect_b32 s27, 2686976, s27
  s_add_u32 s27, s27, s43
  buffer_load_dwordx4 a[196:199], v5, s[8:11], s27 offen
  s_mov_b32 s27, 1441792
  s_cmp_eq_u32 s37, 1
  s_cselect_b32 s27, 3801088, s27
  s_add_u32 s27, s27, s43
  buffer_load_dwordx4 a[200:203], v5, s[8:11], s27 offen
  s_mov_b32 s27, 1507328
  s_cmp_eq_u32 s37, 1
  s_cselect_b32 s27, 3866624, s27
  s_add_u32 s27, s27, s43
  buffer_load_dwordx4 a[204:207], v5, s[8:11], s27 offen
  ds_read_b64_tr_b16 v[176:177], v12 offset:0
  ds_read_b64_tr_b16 v[178:179], v12 offset:2304
  ds_read_b64_tr_b16 v[180:181], v12 offset:36864
  ds_read_b64_tr_b16 v[182:183], v12 offset:39168
  ds_read_b64_tr_b16 v[112:113], v16 offset:0
  ds_read_b64_tr_b16 v[114:115], v16 offset:2304
  ds_read_b64_tr_b16 v[116:117], v16 offset:36864
  ds_read_b64_tr_b16 v[118:119], v16 offset:39168
  ds_read_b64_tr_b16 v[184:185], v12 offset:32
  ds_read_b64_tr_b16 v[186:187], v12 offset:2336
  ds_read_b64_tr_b16 v[188:189], v12 offset:36896
  ds_read_b64_tr_b16 v[190:191], v12 offset:39200
  s_waitcnt lgkmcnt(0)
  ds_read_b64_tr_b16 v[120:121], v16 offset:32
  ds_read_b64_tr_b16 v[122:123], v16 offset:2336
  ds_read_b64_tr_b16 v[124:125], v16 offset:36896
  ds_read_b64_tr_b16 v[126:127], v16 offset:39200
  ds_read_b64_tr_b16 v[192:193], v12 offset:64
  ds_read_b64_tr_b16 v[194:195], v12 offset:2368
  ds_read_b64_tr_b16 v[196:197], v12 offset:36928
  ds_read_b64_tr_b16 v[198:199], v12 offset:39232
  ds_read_b64_tr_b16 v[128:129], v16 offset:64
  ds_read_b64_tr_b16 v[130:131], v16 offset:2368
  ds_read_b64_tr_b16 v[132:133], v16 offset:36928
  ds_read_b64_tr_b16 v[134:135], v16 offset:39232
  s_waitcnt lgkmcnt(0)
  ds_read_b64_tr_b16 v[200:201], v12 offset:96
  ds_read_b64_tr_b16 v[202:203], v12 offset:2400
  ds_read_b64_tr_b16 v[204:205], v12 offset:36960
  ds_read_b64_tr_b16 v[206:207], v12 offset:39264
  ds_read_b64_tr_b16 v[136:137], v16 offset:96
  ds_read_b64_tr_b16 v[138:139], v16 offset:2400
  ds_read_b64_tr_b16 v[140:141], v16 offset:36960
  ds_read_b64_tr_b16 v[142:143], v16 offset:39264
  ds_read_b64_tr_b16 v[208:209], v12 offset:128
  ds_read_b64_tr_b16 v[210:211], v12 offset:2432
  ds_read_b64_tr_b16 v[212:213], v12 offset:36992
  ds_read_b64_tr_b16 v[214:215], v12 offset:39296
  s_waitcnt lgkmcnt(0)
  ds_read_b64_tr_b16 v[144:145], v16 offset:128
  ds_read_b64_tr_b16 v[146:147], v16 offset:2432
  ds_read_b64_tr_b16 v[148:149], v16 offset:36992
  ds_read_b64_tr_b16 v[150:151], v16 offset:39296
  ds_read_b64_tr_b16 v[216:217], v12 offset:160
  ds_read_b64_tr_b16 v[218:219], v12 offset:2464
  ds_read_b64_tr_b16 v[220:221], v12 offset:37024
  ds_read_b64_tr_b16 v[222:223], v12 offset:39328
  ds_read_b64_tr_b16 v[152:153], v16 offset:160
  ds_read_b64_tr_b16 v[154:155], v16 offset:2464
  ds_read_b64_tr_b16 v[156:157], v16 offset:37024
  ds_read_b64_tr_b16 v[158:159], v16 offset:39328
  s_waitcnt lgkmcnt(0)
  ds_read_b64_tr_b16 v[224:225], v12 offset:192
  ds_read_b64_tr_b16 v[226:227], v12 offset:2496
  ds_read_b64_tr_b16 v[228:229], v12 offset:37056
  ds_read_b64_tr_b16 v[230:231], v12 offset:39360
  ds_read_b64_tr_b16 v[160:161], v16 offset:192
  ds_read_b64_tr_b16 v[162:163], v16 offset:2496
  ds_read_b64_tr_b16 v[164:165], v16 offset:37056
  ds_read_b64_tr_b16 v[166:167], v16 offset:39360
  ds_read_b64_tr_b16 v[232:233], v12 offset:224
  ds_read_b64_tr_b16 v[234:235], v12 offset:2528
  ds_read_b64_tr_b16 v[236:237], v12 offset:37088
  ds_read_b64_tr_b16 v[238:239], v12 offset:39392
  s_waitcnt lgkmcnt(0)
  ds_read_b64_tr_b16 v[168:169], v16 offset:224
  ds_read_b64_tr_b16 v[170:171], v16 offset:2528
  ds_read_b64_tr_b16 v[172:173], v16 offset:37088
  ds_read_b64_tr_b16 v[174:175], v16 offset:39392
  ds_read_b64_tr_b16 v[240:241], v12 offset:256
  ds_read_b64_tr_b16 v[242:243], v12 offset:2560
  ds_read_b64_tr_b16 v[244:245], v12 offset:37120
  ds_read_b64_tr_b16 v[246:247], v12 offset:39424
  ds_read_b64_tr_b16 v[248:249], v16 offset:256
  ds_read_b64_tr_b16 v[250:251], v16 offset:2560
  ds_read_b64_tr_b16 v[252:253], v16 offset:37120
  ds_read_b64_tr_b16 v[254:255], v16 offset:39424
  s_waitcnt lgkmcnt(0)
  s_waitcnt lgkmcnt(0)
  s_barrier
  ds_write_b128 v2, v[112:115] offset:20480
  ds_write_b128 v2, v[116:119] offset:21504
  ds_write_b128 v2, v[120:123] offset:22528
  ds_write_b128 v2, v[124:127] offset:23552
  ds_write_b128 v2, v[128:131] offset:24576
  ds_write_b128 v2, v[132:135] offset:25600
  ds_write_b128 v2, v[136:139] offset:26624
  ds_write_b128 v2, v[140:143] offset:27648
  ds_write_b128 v2, v[144:147] offset:28672
  ds_write_b128 v2, v[148:151] offset:29696
  ds_write_b128 v2, v[152:155] offset:30720
  ds_write_b128 v2, v[156:159] offset:31744
  ds_write_b128 v2, v[160:163] offset:32768
  ds_write_b128 v2, v[164:167] offset:33792
  ds_write_b128 v2, v[168:171] offset:34816
  ds_write_b128 v2, v[172:175] offset:35840
  s_waitcnt lgkmcnt(0)
  s_mov_b32 s8, s76
  s_mov_b32 s9, s77
  s_mov_b32 s10, 4718592
  s_mov_b32 s11, 0x20000
  s_mov_b32 s27, 786432
  s_cmp_eq_u32 s37, 1
  s_cselect_b32 s27, 3145728, s27
  s_add_u32 s27, s27, s43
  s_add_u32 m0, s34, 0
  s_nop 0
  buffer_load_dwordx4 v5, s[8:11], s27 offen lds
  s_mov_b32 s27, 851968
  s_cmp_eq_u32 s37, 1
  s_cselect_b32 s27, 3211264, s27
  s_add_u32 s27, s27, s43
  s_add_u32 m0, s34, 1024
  s_nop 0
  buffer_load_dwordx4 v5, s[8:11], s27 offen lds
  s_mov_b32 s27, 1966080
  s_cmp_eq_u32 s37, 1
  s_cselect_b32 s27, 4325376, s27
  s_add_u32 s27, s27, s43
  s_add_u32 m0, s34, 2048
  s_nop 0
  buffer_load_dwordx4 v5, s[8:11], s27 offen lds
  s_mov_b32 s27, 2031616
  s_cmp_eq_u32 s37, 1
  s_cselect_b32 s27, 4390912, s27
  s_add_u32 s27, s27, s43
  s_add_u32 m0, s34, 3072
  s_nop 0
  buffer_load_dwordx4 v5, s[8:11], s27 offen lds
  s_waitcnt vmcnt(52)
  ds_write_b128 v17, a[0:3] offset:0
  ds_write_b128 v17, a[4:7] offset:1024
  ds_write_b128 v17, a[8:11] offset:2048
  ds_write_b128 v17, a[12:15] offset:3072
  s_waitcnt lgkmcnt(0)
  s_barrier
  ds_read_b64_tr_b16 a[0:1], v14 offset:0
  ds_read_b64_tr_b16 a[2:3], v14 offset:256
  ds_read_b64_tr_b16 a[4:5], v14 offset:4096
  ds_read_b64_tr_b16 a[6:7], v14 offset:4352
  ds_read_b64_tr_b16 a[8:9], v14 offset:32
  ds_read_b64_tr_b16 a[10:11], v14 offset:288
  ds_read_b64_tr_b16 a[12:13], v14 offset:4128
  ds_read_b64_tr_b16 a[14:15], v14 offset:4384
  s_waitcnt lgkmcnt(0)
  s_barrier
  s_mov_b32 s8, s78
  s_mov_b32 s9, s79
  s_mov_b32 s10, 4718592
  s_mov_b32 s11, 0x20000
  s_mov_b32 s27, 1048576
  s_cmp_eq_u32 s37, 1
  s_cselect_b32 s27, 3407872, s27
  s_add_u32 s27, s27, s43
  s_add_u32 m0, s34, 4096
  s_nop 0
  buffer_load_dwordx4 v5, s[8:11], s27 offen lds
  s_mov_b32 s27, 1114112
  s_cmp_eq_u32 s37, 1
  s_cselect_b32 s27, 3473408, s27
  s_add_u32 s27, s27, s43
  s_add_u32 m0, s34, 5120
  s_nop 0
  buffer_load_dwordx4 v5, s[8:11], s27 offen lds
  s_mov_b32 s27, 2228224
  s_cmp_eq_u32 s37, 1
  s_cselect_b32 s27, 4587520, s27
  s_add_u32 s27, s27, s43
  s_add_u32 m0, s34, 6144
  s_nop 0
  buffer_load_dwordx4 v5, s[8:11], s27 offen lds
  s_mov_b32 s27, 2293760
  s_cmp_eq_u32 s37, 1
  s_cselect_b32 s27, 4653056, s27
  s_add_u32 s27, s27, s43
  s_add_u32 m0, s34, 7168
  s_nop 0
  buffer_load_dwordx4 v5, s[8:11], s27 offen lds
  s_waitcnt vmcnt(52)
  ds_write_b128 v17, a[16:19] offset:0
  ds_write_b128 v17, a[20:23] offset:1024
  ds_write_b128 v17, a[24:27] offset:2048
  ds_write_b128 v17, a[28:31] offset:3072
  s_waitcnt lgkmcnt(0)
  s_barrier
  ds_read_b64_tr_b16 a[16:17], v14 offset:0
  ds_read_b64_tr_b16 a[18:19], v14 offset:256
  ds_read_b64_tr_b16 a[20:21], v14 offset:4096
  ds_read_b64_tr_b16 a[22:23], v14 offset:4352
  ds_read_b64_tr_b16 a[24:25], v14 offset:32
  ds_read_b64_tr_b16 a[26:27], v14 offset:288
  ds_read_b64_tr_b16 a[28:29], v14 offset:4128
  ds_read_b64_tr_b16 a[30:31], v14 offset:4384
  s_waitcnt lgkmcnt(0)
  s_barrier
  s_mov_b32 s8, s76
  s_mov_b32 s9, s77
  s_mov_b32 s10, 4718592
  s_mov_b32 s11, 0x20000
  s_mov_b32 s27, 524288
  s_cmp_eq_u32 s37, 1
  s_cselect_b32 s27, 2883584, s27
  s_add_u32 s27, s27, s43
  s_add_u32 m0, s34, 8192
  s_nop 0
  buffer_load_dwordx4 v5, s[8:11], s27 offen lds
  s_mov_b32 s27, 589824
  s_cmp_eq_u32 s37, 1
  s_cselect_b32 s27, 2949120, s27
  s_add_u32 s27, s27, s43
  s_add_u32 m0, s34, 9216
  s_nop 0
  buffer_load_dwordx4 v5, s[8:11], s27 offen lds
  s_mov_b32 s27, 1703936
  s_cmp_eq_u32 s37, 1
  s_cselect_b32 s27, 4063232, s27
  s_add_u32 s27, s27, s43
  s_add_u32 m0, s34, 10240
  s_nop 0
  buffer_load_dwordx4 v5, s[8:11], s27 offen lds
  s_mov_b32 s27, 1769472
  s_cmp_eq_u32 s37, 1
  s_cselect_b32 s27, 4128768, s27
  s_add_u32 s27, s27, s43
  s_add_u32 m0, s34, 11264
  s_nop 0
  buffer_load_dwordx4 v5, s[8:11], s27 offen lds
  s_waitcnt vmcnt(52)
  ds_write_b128 v17, a[32:35] offset:0
  ds_write_b128 v17, a[36:39] offset:1024
  ds_write_b128 v17, a[40:43] offset:2048
  ds_write_b128 v17, a[44:47] offset:3072
  s_waitcnt lgkmcnt(0)
  s_barrier
  ds_read_b64_tr_b16 a[32:33], v14 offset:0
  ds_read_b64_tr_b16 a[34:35], v14 offset:256
  ds_read_b64_tr_b16 a[36:37], v14 offset:4096
  ds_read_b64_tr_b16 a[38:39], v14 offset:4352
  ds_read_b64_tr_b16 a[40:41], v14 offset:32
  ds_read_b64_tr_b16 a[42:43], v14 offset:288
  ds_read_b64_tr_b16 a[44:45], v14 offset:4128
  ds_read_b64_tr_b16 a[46:47], v14 offset:4384
  s_waitcnt lgkmcnt(0)
  s_barrier
  s_mov_b32 s8, s78
  s_mov_b32 s9, s79
  s_mov_b32 s10, 4718592
  s_mov_b32 s11, 0x20000
  s_mov_b32 s27, 0
  s_cmp_eq_u32 s37, 1
  s_cselect_b32 s27, 2359296, s27
  s_add_u32 s27, s27, s43
  s_add_u32 m0, s34, 12288
  s_nop 0
  buffer_load_dwordx4 v5, s[8:11], s27 offen lds
  s_mov_b32 s27, 65536
  s_cmp_eq_u32 s37, 1
  s_cselect_b32 s27, 2424832, s27
  s_add_u32 s27, s27, s43
  s_add_u32 m0, s34, 13312
  s_nop 0
  buffer_load_dwordx4 v5, s[8:11], s27 offen lds
  s_mov_b32 s27, 1179648
  s_cmp_eq_u32 s37, 1
  s_cselect_b32 s27, 3538944, s27
  s_add_u32 s27, s27, s43
  s_add_u32 m0, s34, 14336
  s_nop 0
  buffer_load_dwordx4 v5, s[8:11], s27 offen lds
  s_mov_b32 s27, 1245184
  s_cmp_eq_u32 s37, 1
  s_cselect_b32 s27, 3604480, s27
  s_add_u32 s27, s27, s43
  s_add_u32 m0, s34, 15360
  s_nop 0
  buffer_load_dwordx4 v5, s[8:11], s27 offen lds
  s_waitcnt vmcnt(52)
  ds_write_b128 v17, a[48:51] offset:0
  ds_write_b128 v17, a[52:55] offset:1024
  ds_write_b128 v17, a[56:59] offset:2048
  ds_write_b128 v17, a[60:63] offset:3072
  s_waitcnt lgkmcnt(0)
  s_barrier
  ds_read_b64_tr_b16 a[48:49], v14 offset:0
  ds_read_b64_tr_b16 a[50:51], v14 offset:256
  ds_read_b64_tr_b16 a[52:53], v14 offset:4096
  ds_read_b64_tr_b16 a[54:55], v14 offset:4352
  ds_read_b64_tr_b16 a[56:57], v14 offset:32
  ds_read_b64_tr_b16 a[58:59], v14 offset:288
  ds_read_b64_tr_b16 a[60:61], v14 offset:4128
  ds_read_b64_tr_b16 a[62:63], v14 offset:4384
  s_waitcnt lgkmcnt(0)
  s_barrier
  s_mov_b32 s8, s76
  s_mov_b32 s9, s77
  s_mov_b32 s10, 4718592
  s_mov_b32 s11, 0x20000
  s_mov_b32 s27, 262144
  s_cmp_eq_u32 s37, 1
  s_cselect_b32 s27, 2621440, s27
  s_add_u32 s27, s27, s43
  s_add_u32 m0, s34, 16384
  s_nop 0
  buffer_load_dwordx4 v5, s[8:11], s27 offen lds
  s_mov_b32 s27, 327680
  s_cmp_eq_u32 s37, 1
  s_cselect_b32 s27, 2686976, s27
  s_add_u32 s27, s27, s43
  s_add_u32 m0, s34, 17408
  s_nop 0
  buffer_load_dwordx4 v5, s[8:11], s27 offen lds
  s_mov_b32 s27, 1441792
  s_cmp_eq_u32 s37, 1
  s_cselect_b32 s27, 3801088, s27
  s_add_u32 s27, s27, s43
  s_add_u32 m0, s34, 18432
  s_nop 0
  buffer_load_dwordx4 v5, s[8:11], s27 offen lds
  s_mov_b32 s27, 1507328
  s_cmp_eq_u32 s37, 1
  s_cselect_b32 s27, 3866624, s27
  s_add_u32 s27, s27, s43
  s_add_u32 m0, s34, 19456
  s_nop 0
  buffer_load_dwordx4 v5, s[8:11], s27 offen lds
  s_waitcnt vmcnt(52)
  ds_write_b128 v17, a[64:67] offset:0
  ds_write_b128 v17, a[68:71] offset:1024
  ds_write_b128 v17, a[72:75] offset:2048
  ds_write_b128 v17, a[76:79] offset:3072
  s_waitcnt lgkmcnt(0)
  s_barrier
  ds_read_b64_tr_b16 a[64:65], v14 offset:0
  ds_read_b64_tr_b16 a[66:67], v14 offset:256
  ds_read_b64_tr_b16 a[68:69], v14 offset:4096
  ds_read_b64_tr_b16 a[70:71], v14 offset:4352
  ds_read_b64_tr_b16 a[72:73], v14 offset:32
  ds_read_b64_tr_b16 a[74:75], v14 offset:288
  ds_read_b64_tr_b16 a[76:77], v14 offset:4128
  ds_read_b64_tr_b16 a[78:79], v14 offset:4384
  s_waitcnt lgkmcnt(0)
  s_barrier
  s_mov_b32 s8, s80
  s_mov_b32 s9, s81
  s_mov_b32 s10, 4718592
  s_mov_b32 s11, 0x20000
  s_mov_b32 s27, 786432
  s_cmp_eq_u32 s37, 1
  s_cselect_b32 s27, 3145728, s27
  s_add_u32 s27, s27, s43
  buffer_load_dwordx4 a[208:211], v5, s[8:11], s27 offen
  s_mov_b32 s27, 851968
  s_cmp_eq_u32 s37, 1
  s_cselect_b32 s27, 3211264, s27
  s_add_u32 s27, s27, s43
  buffer_load_dwordx4 a[212:215], v5, s[8:11], s27 offen
  s_mov_b32 s27, 1966080
  s_cmp_eq_u32 s37, 1
  s_cselect_b32 s27, 4325376, s27
  s_add_u32 s27, s27, s43
  buffer_load_dwordx4 a[216:219], v5, s[8:11], s27 offen
  s_mov_b32 s27, 2031616
  s_cmp_eq_u32 s37, 1
  s_cselect_b32 s27, 4390912, s27
  s_add_u32 s27, s27, s43
  buffer_load_dwordx4 a[220:223], v5, s[8:11], s27 offen
  s_waitcnt vmcnt(52)
  ds_write_b128 v17, a[80:83] offset:0
  ds_write_b128 v17, a[84:87] offset:1024
  ds_write_b128 v17, a[88:91] offset:2048
  ds_write_b128 v17, a[92:95] offset:3072
  s_waitcnt lgkmcnt(0)
  s_barrier
  ds_read_b64_tr_b16 a[80:81], v14 offset:0
  ds_read_b64_tr_b16 a[82:83], v14 offset:256
  ds_read_b64_tr_b16 a[84:85], v14 offset:4096
  ds_read_b64_tr_b16 a[86:87], v14 offset:4352
  ds_read_b64_tr_b16 a[88:89], v14 offset:32
  ds_read_b64_tr_b16 a[90:91], v14 offset:288
  ds_read_b64_tr_b16 a[92:93], v14 offset:4128
  ds_read_b64_tr_b16 a[94:95], v14 offset:4384
  s_waitcnt lgkmcnt(0)
  s_barrier
  s_mov_b32 s27, 917504
  s_cmp_eq_u32 s37, 1
  s_cselect_b32 s27, 3276800, s27
  s_add_u32 s27, s27, s43
  buffer_load_dwordx4 a[224:227], v5, s[8:11], s27 offen
  s_mov_b32 s27, 983040
  s_cmp_eq_u32 s37, 1
  s_cselect_b32 s27, 3342336, s27
  s_add_u32 s27, s27, s43
  buffer_load_dwordx4 a[228:231], v5, s[8:11], s27 offen
  s_mov_b32 s27, 2097152
  s_cmp_eq_u32 s37, 1
  s_cselect_b32 s27, 4456448, s27
  s_add_u32 s27, s27, s43
  buffer_load_dwordx4 a[232:235], v5, s[8:11], s27 offen
  s_mov_b32 s27, 2162688
  s_cmp_eq_u32 s37, 1
  s_cselect_b32 s27, 4521984, s27
  s_add_u32 s27, s27, s43
  buffer_load_dwordx4 a[236:239], v5, s[8:11], s27 offen
  s_waitcnt vmcnt(52)
  ds_write_b128 v17, a[96:99] offset:0
  ds_write_b128 v17, a[100:103] offset:1024
  ds_write_b128 v17, a[104:107] offset:2048
  ds_write_b128 v17, a[108:111] offset:3072
  s_waitcnt lgkmcnt(0)
  s_barrier
  ds_read_b64_tr_b16 a[96:97], v14 offset:0
  ds_read_b64_tr_b16 a[98:99], v14 offset:256
  ds_read_b64_tr_b16 a[100:101], v14 offset:4096
  ds_read_b64_tr_b16 a[102:103], v14 offset:4352
  ds_read_b64_tr_b16 a[104:105], v14 offset:32
  ds_read_b64_tr_b16 a[106:107], v14 offset:288
  ds_read_b64_tr_b16 a[108:109], v14 offset:4128
  ds_read_b64_tr_b16 a[110:111], v14 offset:4384
  s_waitcnt lgkmcnt(0)
  s_barrier
  s_mov_b32 s27, 1048576
  s_cmp_eq_u32 s37, 1
  s_cselect_b32 s27, 3407872, s27
  s_add_u32 s27, s27, s43
  buffer_load_dwordx4 a[240:243], v5, s[8:11], s27 offen
  s_mov_b32 s27, 1114112
  s_cmp_eq_u32 s37, 1
  s_cselect_b32 s27, 3473408, s27
  s_add_u32 s27, s27, s43
  buffer_load_dwordx4 a[244:247], v5, s[8:11], s27 offen
  s_mov_b32 s27, 2228224
  s_cmp_eq_u32 s37, 1
  s_cselect_b32 s27, 4587520, s27
  s_add_u32 s27, s27, s43
  buffer_load_dwordx4 a[248:251], v5, s[8:11], s27 offen
  s_mov_b32 s27, 2293760
  s_cmp_eq_u32 s37, 1
  s_cselect_b32 s27, 4653056, s27
  s_add_u32 s27, s27, s43
  buffer_load_dwordx4 a[252:255], v5, s[8:11], s27 offen
  s_waitcnt vmcnt(52)
  ds_write_b128 v17, a[112:115] offset:0
  ds_write_b128 v17, a[116:119] offset:1024
  ds_write_b128 v17, a[120:123] offset:2048
  ds_write_b128 v17, a[124:127] offset:3072
  s_waitcnt lgkmcnt(0)
  s_barrier
  ds_read_b64_tr_b16 a[112:113], v14 offset:0
  ds_read_b64_tr_b16 a[114:115], v14 offset:256
  ds_read_b64_tr_b16 a[116:117], v14 offset:4096
  ds_read_b64_tr_b16 a[118:119], v14 offset:4352
  ds_read_b64_tr_b16 a[120:121], v14 offset:32
  ds_read_b64_tr_b16 a[122:123], v14 offset:288
  ds_read_b64_tr_b16 a[124:125], v14 offset:4128
  ds_read_b64_tr_b16 a[126:127], v14 offset:4384
  s_waitcnt lgkmcnt(0)
  s_barrier
  s_mov_b32 s27, 393216
  s_cmp_eq_u32 s37, 1
  s_cselect_b32 s27, 2752512, s27
  s_add_u32 s27, s27, s43
  buffer_load_dwordx4 v[80:83], v5, s[8:11], s27 offen
  s_mov_b32 s27, 458752
  s_cmp_eq_u32 s37, 1
  s_cselect_b32 s27, 2818048, s27
  s_add_u32 s27, s27, s43
  buffer_load_dwordx4 v[84:87], v5, s[8:11], s27 offen
  s_mov_b32 s27, 1572864
  s_cmp_eq_u32 s37, 1
  s_cselect_b32 s27, 3932160, s27
  s_add_u32 s27, s27, s43
  buffer_load_dwordx4 v[88:91], v5, s[8:11], s27 offen
  s_mov_b32 s27, 1638400
  s_cmp_eq_u32 s37, 1
  s_cselect_b32 s27, 3997696, s27
  s_add_u32 s27, s27, s43
  buffer_load_dwordx4 v[92:95], v5, s[8:11], s27 offen
  s_waitcnt vmcnt(52)
  ds_write_b128 v17, a[128:131] offset:0
  ds_write_b128 v17, a[132:135] offset:1024
  ds_write_b128 v17, a[136:139] offset:2048
  ds_write_b128 v17, a[140:143] offset:3072
  s_waitcnt lgkmcnt(0)
  s_barrier
  ds_read_b64_tr_b16 a[128:129], v14 offset:0
  ds_read_b64_tr_b16 a[130:131], v14 offset:256
  ds_read_b64_tr_b16 a[132:133], v14 offset:4096
  ds_read_b64_tr_b16 a[134:135], v14 offset:4352
  ds_read_b64_tr_b16 a[136:137], v14 offset:32
  ds_read_b64_tr_b16 a[138:139], v14 offset:288
  ds_read_b64_tr_b16 a[140:141], v14 offset:4128
  ds_read_b64_tr_b16 a[142:143], v14 offset:4384
  s_waitcnt lgkmcnt(0)
  s_barrier
  s_mov_b32 s27, 524288
  s_cmp_eq_u32 s37, 1
  s_cselect_b32 s27, 2883584, s27
  s_add_u32 s27, s27, s43
  buffer_load_dwordx4 v[96:99], v5, s[8:11], s27 offen
  s_mov_b32 s27, 589824
  s_cmp_eq_u32 s37, 1
  s_cselect_b32 s27, 2949120, s27
  s_add_u32 s27, s27, s43
  buffer_load_dwordx4 v[100:103], v5, s[8:11], s27 offen
  s_mov_b32 s27, 1703936
  s_cmp_eq_u32 s37, 1
  s_cselect_b32 s27, 4063232, s27
  s_add_u32 s27, s27, s43
  buffer_load_dwordx4 v[104:107], v5, s[8:11], s27 offen
  s_mov_b32 s27, 1769472
  s_cmp_eq_u32 s37, 1
  s_cselect_b32 s27, 4128768, s27
  s_add_u32 s27, s27, s43
  buffer_load_dwordx4 v[108:111], v5, s[8:11], s27 offen
  s_waitcnt vmcnt(52)
  ds_write_b128 v17, a[144:147] offset:0
  ds_write_b128 v17, a[148:151] offset:1024
  ds_write_b128 v17, a[152:155] offset:2048
  ds_write_b128 v17, a[156:159] offset:3072
  s_waitcnt lgkmcnt(0)
  s_barrier
  ds_read_b64_tr_b16 a[144:145], v14 offset:0
  ds_read_b64_tr_b16 a[146:147], v14 offset:256
  ds_read_b64_tr_b16 a[148:149], v14 offset:4096
  ds_read_b64_tr_b16 a[150:151], v14 offset:4352
  ds_read_b64_tr_b16 a[152:153], v14 offset:32
  ds_read_b64_tr_b16 a[154:155], v14 offset:288
  ds_read_b64_tr_b16 a[156:157], v14 offset:4128
  ds_read_b64_tr_b16 a[158:159], v14 offset:4384
  s_waitcnt lgkmcnt(0)
  s_barrier
  s_mov_b32 s27, 655360
  s_cmp_eq_u32 s37, 1
  s_cselect_b32 s27, 3014656, s27
  s_add_u32 s27, s27, s43
  buffer_load_dwordx4 v[112:115], v5, s[8:11], s27 offen
  s_mov_b32 s27, 720896
  s_cmp_eq_u32 s37, 1
  s_cselect_b32 s27, 3080192, s27
  s_add_u32 s27, s27, s43
  buffer_load_dwordx4 v[116:119], v5, s[8:11], s27 offen
  s_mov_b32 s27, 1835008
  s_cmp_eq_u32 s37, 1
  s_cselect_b32 s27, 4194304, s27
  s_add_u32 s27, s27, s43
  buffer_load_dwordx4 v[120:123], v5, s[8:11], s27 offen
  s_mov_b32 s27, 1900544
  s_cmp_eq_u32 s37, 1
  s_cselect_b32 s27, 4259840, s27
  s_add_u32 s27, s27, s43
  buffer_load_dwordx4 v[124:127], v5, s[8:11], s27 offen
  s_waitcnt vmcnt(52)
  ds_write_b128 v17, a[160:163] offset:0
  ds_write_b128 v17, a[164:167] offset:1024
  ds_write_b128 v17, a[168:171] offset:2048
  ds_write_b128 v17, a[172:175] offset:3072
  s_waitcnt lgkmcnt(0)
  s_barrier
  ds_read_b64_tr_b16 a[160:161], v14 offset:0
  ds_read_b64_tr_b16 a[162:163], v14 offset:256
  ds_read_b64_tr_b16 a[164:165], v14 offset:4096
  ds_read_b64_tr_b16 a[166:167], v14 offset:4352
  ds_read_b64_tr_b16 a[168:169], v14 offset:32
  ds_read_b64_tr_b16 a[170:171], v14 offset:288
  ds_read_b64_tr_b16 a[172:173], v14 offset:4128
  ds_read_b64_tr_b16 a[174:175], v14 offset:4384
  s_waitcnt lgkmcnt(0)
  s_barrier
  s_mov_b32 s27, 0
  s_cmp_eq_u32 s37, 1
  s_cselect_b32 s27, 2359296, s27
  s_add_u32 s27, s27, s43
  buffer_load_dwordx4 v[128:131], v5, s[8:11], s27 offen
  s_mov_b32 s27, 65536
  s_cmp_eq_u32 s37, 1
  s_cselect_b32 s27, 2424832, s27
  s_add_u32 s27, s27, s43
  buffer_load_dwordx4 v[132:135], v5, s[8:11], s27 offen
  s_mov_b32 s27, 1179648
  s_cmp_eq_u32 s37, 1
  s_cselect_b32 s27, 3538944, s27
  s_add_u32 s27, s27, s43
  buffer_load_dwordx4 v[136:139], v5, s[8:11], s27 offen
  s_mov_b32 s27, 1245184
  s_cmp_eq_u32 s37, 1
  s_cselect_b32 s27, 3604480, s27
  s_add_u32 s27, s27, s43
  buffer_load_dwordx4 v[140:143], v5, s[8:11], s27 offen
  s_waitcnt vmcnt(52)
  ds_write_b128 v17, a[176:179] offset:0
  ds_write_b128 v17, a[180:183] offset:1024
  ds_write_b128 v17, a[184:187] offset:2048
  ds_write_b128 v17, a[188:191] offset:3072
  s_waitcnt lgkmcnt(0)
  s_barrier
  ds_read_b64_tr_b16 a[176:177], v14 offset:0
  ds_read_b64_tr_b16 a[178:179], v14 offset:256
  ds_read_b64_tr_b16 a[180:181], v14 offset:4096
  ds_read_b64_tr_b16 a[182:183], v14 offset:4352
  ds_read_b64_tr_b16 a[184:185], v14 offset:32
  ds_read_b64_tr_b16 a[186:187], v14 offset:288
  ds_read_b64_tr_b16 a[188:189], v14 offset:4128
  ds_read_b64_tr_b16 a[190:191], v14 offset:4384
  s_waitcnt lgkmcnt(0)
  s_barrier
  s_mov_b32 s27, 131072
  s_cmp_eq_u32 s37, 1
  s_cselect_b32 s27, 2490368, s27
  s_add_u32 s27, s27, s43
  buffer_load_dwordx4 v[144:147], v5, s[8:11], s27 offen
  s_mov_b32 s27, 196608
  s_cmp_eq_u32 s37, 1
  s_cselect_b32 s27, 2555904, s27
  s_add_u32 s27, s27, s43
  buffer_load_dwordx4 v[148:151], v5, s[8:11], s27 offen
  s_mov_b32 s27, 1310720
  s_cmp_eq_u32 s37, 1
  s_cselect_b32 s27, 3670016, s27
  s_add_u32 s27, s27, s43
  buffer_load_dwordx4 v[152:155], v5, s[8:11], s27 offen
  s_mov_b32 s27, 1376256
  s_cmp_eq_u32 s37, 1
  s_cselect_b32 s27, 3735552, s27
  s_add_u32 s27, s27, s43
  buffer_load_dwordx4 v[156:159], v5, s[8:11], s27 offen
  s_waitcnt vmcnt(52)
  ds_write_b128 v17, a[192:195] offset:0
  ds_write_b128 v17, a[196:199] offset:1024
  ds_write_b128 v17, a[200:203] offset:2048
  ds_write_b128 v17, a[204:207] offset:3072
  s_waitcnt lgkmcnt(0)
  s_barrier
  ds_read_b64_tr_b16 a[192:193], v14 offset:0
  ds_read_b64_tr_b16 a[194:195], v14 offset:256
  ds_read_b64_tr_b16 a[196:197], v14 offset:4096
  ds_read_b64_tr_b16 a[198:199], v14 offset:4352
  ds_read_b64_tr_b16 a[200:201], v14 offset:32
  ds_read_b64_tr_b16 a[202:203], v14 offset:288
  ds_read_b64_tr_b16 a[204:205], v14 offset:4128
  ds_read_b64_tr_b16 a[206:207], v14 offset:4384
  s_waitcnt lgkmcnt(0)
  s_barrier
  s_mov_b32 s27, 262144
  s_cmp_eq_u32 s37, 1
  s_cselect_b32 s27, 2621440, s27
  s_add_u32 s27, s27, s43
  buffer_load_dwordx4 v[160:163], v5, s[8:11], s27 offen
  s_mov_b32 s27, 327680
  s_cmp_eq_u32 s37, 1
  s_cselect_b32 s27, 2686976, s27
  s_add_u32 s27, s27, s43
  buffer_load_dwordx4 v[164:167], v5, s[8:11], s27 offen
  s_mov_b32 s27, 1441792
  s_cmp_eq_u32 s37, 1
  s_cselect_b32 s27, 3801088, s27
  s_add_u32 s27, s27, s43
  buffer_load_dwordx4 v[168:171], v5, s[8:11], s27 offen
  s_mov_b32 s27, 1507328
  s_cmp_eq_u32 s37, 1
  s_cselect_b32 s27, 3866624, s27
  s_add_u32 s27, s27, s43
  buffer_load_dwordx4 v[172:175], v5, s[8:11], s27 offen
  s_waitcnt vmcnt(52)
  s_barrier
  ds_read_b64_tr_b16 v[20:21], v13 offset:0
  ds_read_b64_tr_b16 v[22:23], v13 offset:256
  ds_read_b64_tr_b16 v[24:25], v15 offset:0
  ds_read_b64_tr_b16 v[26:27], v15 offset:256
  ds_read_b64_tr_b16 v[28:29], v13 offset:32
  ds_read_b64_tr_b16 v[30:31], v13 offset:288
  ds_read_b64_tr_b16 v[32:33], v15 offset:32
  ds_read_b64_tr_b16 v[34:35], v15 offset:288
  s_waitcnt lgkmcnt(0)
  s_barrier
  ds_write_b128 v2, v[20:23] offset:0
  ds_write_b128 v2, v[24:27] offset:1024
  ds_write_b128 v2, v[28:31] offset:2048
  ds_write_b128 v2, v[32:35] offset:3072
  s_waitcnt vmcnt(48)
  s_barrier
  ds_read_b64_tr_b16 v[20:21], v13 offset:4096
  ds_read_b64_tr_b16 v[22:23], v13 offset:4352
  ds_read_b64_tr_b16 v[24:25], v15 offset:4096
  ds_read_b64_tr_b16 v[26:27], v15 offset:4352
  ds_read_b64_tr_b16 v[28:29], v13 offset:4128
  ds_read_b64_tr_b16 v[30:31], v13 offset:4384
  ds_read_b64_tr_b16 v[32:33], v15 offset:4128
  ds_read_b64_tr_b16 v[34:35], v15 offset:4384
  s_waitcnt lgkmcnt(0)
  s_barrier
  ds_write_b128 v2, v[20:23] offset:4096
  ds_write_b128 v2, v[24:27] offset:5120
  ds_write_b128 v2, v[28:31] offset:6144
  ds_write_b128 v2, v[32:35] offset:7168
  s_waitcnt vmcnt(44)
  s_barrier
  ds_read_b64_tr_b16 v[20:21], v13 offset:8192
  ds_read_b64_tr_b16 v[22:23], v13 offset:8448
  ds_read_b64_tr_b16 v[24:25], v15 offset:8192
  ds_read_b64_tr_b16 v[26:27], v15 offset:8448
  ds_read_b64_tr_b16 v[28:29], v13 offset:8224
  ds_read_b64_tr_b16 v[30:31], v13 offset:8480
  ds_read_b64_tr_b16 v[32:33], v15 offset:8224
  ds_read_b64_tr_b16 v[34:35], v15 offset:8480
  s_waitcnt lgkmcnt(0)
  s_barrier
  ds_write_b128 v2, v[20:23] offset:8192
  ds_write_b128 v2, v[24:27] offset:9216
  ds_write_b128 v2, v[28:31] offset:10240
  ds_write_b128 v2, v[32:35] offset:11264
  s_waitcnt vmcnt(40)
  s_barrier
  ds_read_b64_tr_b16 v[20:21], v13 offset:12288
  ds_read_b64_tr_b16 v[22:23], v13 offset:12544
  ds_read_b64_tr_b16 v[24:25], v15 offset:12288
  ds_read_b64_tr_b16 v[26:27], v15 offset:12544
  ds_read_b64_tr_b16 v[28:29], v13 offset:12320
  ds_read_b64_tr_b16 v[30:31], v13 offset:12576
  ds_read_b64_tr_b16 v[32:33], v15 offset:12320
  ds_read_b64_tr_b16 v[34:35], v15 offset:12576
  s_waitcnt lgkmcnt(0)
  s_barrier
  ds_write_b128 v2, v[20:23] offset:12288
  ds_write_b128 v2, v[24:27] offset:13312
  ds_write_b128 v2, v[28:31] offset:14336
  ds_write_b128 v2, v[32:35] offset:15360
  s_waitcnt vmcnt(36)
  s_barrier
  ds_read_b64_tr_b16 v[20:21], v13 offset:16384
  ds_read_b64_tr_b16 v[22:23], v13 offset:16640
  ds_read_b64_tr_b16 v[24:25], v15 offset:16384
  ds_read_b64_tr_b16 v[26:27], v15 offset:16640
  ds_read_b64_tr_b16 v[28:29], v13 offset:16416
  ds_read_b64_tr_b16 v[30:31], v13 offset:16672
  ds_read_b64_tr_b16 v[32:33], v15 offset:16416
  ds_read_b64_tr_b16 v[34:35], v15 offset:16672
  s_waitcnt lgkmcnt(0)
  s_barrier
  ds_write_b128 v2, v[20:23] offset:16384
  ds_write_b128 v2, v[24:27] offset:17408
  ds_write_b128 v2, v[28:31] offset:18432
  ds_write_b128 v2, v[32:35] offset:19456
  s_waitcnt vmcnt(32)
  ds_write_b128 v17, a[208:211] offset:0
  ds_write_b128 v17, a[212:215] offset:1024
  ds_write_b128 v17, a[216:219] offset:2048
  ds_write_b128 v17, a[220:223] offset:3072
  s_waitcnt lgkmcnt(0)
  s_barrier
  ds_read_b64_tr_b16 a[208:209], v14 offset:0
  ds_read_b64_tr_b16 a[210:211], v14 offset:256
  ds_read_b64_tr_b16 a[212:213], v14 offset:4096
  ds_read_b64_tr_b16 a[214:215], v14 offset:4352
  ds_read_b64_tr_b16 a[216:217], v14 offset:32
  ds_read_b64_tr_b16 a[218:219], v14 offset:288
  ds_read_b64_tr_b16 a[220:221], v14 offset:4128
  ds_read_b64_tr_b16 a[222:223], v14 offset:4384
  s_waitcnt lgkmcnt(0)
  s_barrier
  s_waitcnt vmcnt(28)
  ds_write_b128 v17, a[224:227] offset:0
  ds_write_b128 v17, a[228:231] offset:1024
  ds_write_b128 v17, a[232:235] offset:2048
  ds_write_b128 v17, a[236:239] offset:3072
  s_waitcnt lgkmcnt(0)
  s_barrier
  ds_read_b64_tr_b16 a[224:225], v14 offset:0
  ds_read_b64_tr_b16 a[226:227], v14 offset:256
  ds_read_b64_tr_b16 a[228:229], v14 offset:4096
  ds_read_b64_tr_b16 a[230:231], v14 offset:4352
  ds_read_b64_tr_b16 a[232:233], v14 offset:32
  ds_read_b64_tr_b16 a[234:235], v14 offset:288
  ds_read_b64_tr_b16 a[236:237], v14 offset:4128
  ds_read_b64_tr_b16 a[238:239], v14 offset:4384
  s_waitcnt lgkmcnt(0)
  s_barrier
  s_waitcnt vmcnt(24)
  ds_write_b128 v17, a[240:243] offset:0
  ds_write_b128 v17, a[244:247] offset:1024
  ds_write_b128 v17, a[248:251] offset:2048
  ds_write_b128 v17, a[252:255] offset:3072
  s_waitcnt lgkmcnt(0)
  s_barrier
  ds_read_b64_tr_b16 a[240:241], v14 offset:0
  ds_read_b64_tr_b16 a[242:243], v14 offset:256
  ds_read_b64_tr_b16 a[244:245], v14 offset:4096
  ds_read_b64_tr_b16 a[246:247], v14 offset:4352
  ds_read_b64_tr_b16 a[248:249], v14 offset:32
  ds_read_b64_tr_b16 a[250:251], v14 offset:288
  ds_read_b64_tr_b16 a[252:253], v14 offset:4128
  ds_read_b64_tr_b16 a[254:255], v14 offset:4384
  s_waitcnt lgkmcnt(0)
  s_barrier
  s_waitcnt vmcnt(20)
  ds_write_b128 v17, v[80:83] offset:0
  ds_write_b128 v17, v[84:87] offset:1024
  ds_write_b128 v17, v[88:91] offset:2048
  ds_write_b128 v17, v[92:95] offset:3072
  s_waitcnt lgkmcnt(0)
  s_barrier
  ds_read_b64_tr_b16 v[80:81], v14 offset:0
  ds_read_b64_tr_b16 v[82:83], v14 offset:256
  ds_read_b64_tr_b16 v[84:85], v14 offset:4096
  ds_read_b64_tr_b16 v[86:87], v14 offset:4352
  ds_read_b64_tr_b16 v[88:89], v14 offset:32
  ds_read_b64_tr_b16 v[90:91], v14 offset:288
  ds_read_b64_tr_b16 v[92:93], v14 offset:4128
  ds_read_b64_tr_b16 v[94:95], v14 offset:4384
  s_waitcnt lgkmcnt(0)
  s_barrier
  s_waitcnt vmcnt(16)
  ds_write_b128 v17, v[96:99] offset:0
  ds_write_b128 v17, v[100:103] offset:1024
  ds_write_b128 v17, v[104:107] offset:2048
  ds_write_b128 v17, v[108:111] offset:3072
  s_waitcnt lgkmcnt(0)
  s_barrier
  ds_read_b64_tr_b16 v[96:97], v14 offset:0
  ds_read_b64_tr_b16 v[98:99], v14 offset:256
  ds_read_b64_tr_b16 v[100:101], v14 offset:4096
  ds_read_b64_tr_b16 v[102:103], v14 offset:4352
  ds_read_b64_tr_b16 v[104:105], v14 offset:32
  ds_read_b64_tr_b16 v[106:107], v14 offset:288
  ds_read_b64_tr_b16 v[108:109], v14 offset:4128
  ds_read_b64_tr_b16 v[110:111], v14 offset:4384
  s_waitcnt lgkmcnt(0)
  s_barrier
  s_waitcnt vmcnt(12)
  ds_write_b128 v17, v[112:115] offset:0
  ds_write_b128 v17, v[116:119] offset:1024
  ds_write_b128 v17, v[120:123] offset:2048
  ds_write_b128 v17, v[124:127] offset:3072
  s_waitcnt lgkmcnt(0)
  s_barrier
  ds_read_b64_tr_b16 v[112:113], v14 offset:0
  ds_read_b64_tr_b16 v[114:115], v14 offset:256
  ds_read_b64_tr_b16 v[116:117], v14 offset:4096
  ds_read_b64_tr_b16 v[118:119], v14 offset:4352
  ds_read_b64_tr_b16 v[120:121], v14 offset:32
  ds_read_b64_tr_b16 v[122:123], v14 offset:288
  ds_read_b64_tr_b16 v[124:125], v14 offset:4128
  ds_read_b64_tr_b16 v[126:127], v14 offset:4384
  s_waitcnt lgkmcnt(0)
  s_barrier
  s_waitcnt vmcnt(8)
  ds_write_b128 v17, v[128:131] offset:0
  ds_write_b128 v17, v[132:135] offset:1024
  ds_write_b128 v17, v[136:139] offset:2048
  ds_write_b128 v17, v[140:143] offset:3072
  s_waitcnt lgkmcnt(0)
  s_barrier
  ds_read_b64_tr_b16 v[128:129], v14 offset:0
  ds_read_b64_tr_b16 v[130:131], v14 offset:256
  ds_read_b64_tr_b16 v[132:133], v14 offset:4096
  ds_read_b64_tr_b16 v[134:135], v14 offset:4352
  ds_read_b64_tr_b16 v[136:137], v14 offset:32
  ds_read_b64_tr_b16 v[138:139], v14 offset:288
  ds_read_b64_tr_b16 v[140:141], v14 offset:4128
  ds_read_b64_tr_b16 v[142:143], v14 offset:4384
  s_waitcnt lgkmcnt(0)
  s_barrier
  s_waitcnt vmcnt(4)
  ds_write_b128 v17, v[144:147] offset:0
  ds_write_b128 v17, v[148:151] offset:1024
  ds_write_b128 v17, v[152:155] offset:2048
  ds_write_b128 v17, v[156:159] offset:3072
  s_waitcnt lgkmcnt(0)
  s_barrier
  ds_read_b64_tr_b16 v[144:145], v14 offset:0
  ds_read_b64_tr_b16 v[146:147], v14 offset:256
  ds_read_b64_tr_b16 v[148:149], v14 offset:4096
  ds_read_b64_tr_b16 v[150:151], v14 offset:4352
  ds_read_b64_tr_b16 v[152:153], v14 offset:32
  ds_read_b64_tr_b16 v[154:155], v14 offset:288
  ds_read_b64_tr_b16 v[156:157], v14 offset:4128
  ds_read_b64_tr_b16 v[158:159], v14 offset:4384
  s_waitcnt lgkmcnt(0)
  s_barrier
  s_waitcnt vmcnt(0)
  ds_write_b128 v17, v[160:163] offset:0
  ds_write_b128 v17, v[164:167] offset:1024
  ds_write_b128 v17, v[168:171] offset:2048
  ds_write_b128 v17, v[172:175] offset:3072
  s_waitcnt lgkmcnt(0)
  s_barrier
  ds_read_b64_tr_b16 v[160:161], v14 offset:0
  ds_read_b64_tr_b16 v[162:163], v14 offset:256
  ds_read_b64_tr_b16 v[164:165], v14 offset:4096
  ds_read_b64_tr_b16 v[166:167], v14 offset:4352
  ds_read_b64_tr_b16 v[168:169], v14 offset:32
  ds_read_b64_tr_b16 v[170:171], v14 offset:288
  ds_read_b64_tr_b16 v[172:173], v14 offset:4128
  ds_read_b64_tr_b16 v[174:175], v14 offset:4384
  s_waitcnt lgkmcnt(0)
  s_barrier
  s_waitcnt lgkmcnt(0)
  s_mov_b32 s14, 0
  s_mov_b32 s15, 0
  s_mov_b32 s16, 65536
  s_mov_b32 s42, 524288
  s_mul_i32 s34, s12, 12288
  s_add_u32 s17, s16, s34
  s_mul_i32 s34, s13, 3072
  s_add_u32 s17, s17, s34
  s_mov_b32 s54, 0x3f80
  s_mov_b32 s55, 0x3f80
  s_lshl_b32 s3, s51, 7
  s_mov_b32 s48, 0x00400040
  s_mov_b32 s49, 0x00400040
  s_mov_b32 s18, 1048576
  s_mov_b32 s19, 1064960
  s_mov_b32 s20, 1081344
  s_lshl_b32 s34, s12, 13
  s_lshl_b32 s35, s13, 11
  s_add_u32 s35, s34, s35
  s_add_u32 s22, s35, 33554432
  s_and_b32 s46, s13, 1
  s_lshl_b32 s46, s46, 12
  s_mov_b32 s58, s46
  s_add_u32 s21, s34, s46
  s_add_u32 s21, s21, 17039360
  s_add_u32 s50, s34, 33816576
  s_add_u32 s35, s34, 17301504
  s_cmp_ge_u32 s13, 2
  s_cselect_b32 s50, s35, s50
  s_add_u32 s50, s50, s46
  s_lshl_b32 s46, s13, 11
  s_mul_i32 s26, s13, 1536
  s_mov_b32 s8, 0x3f803f80
  s_mov_b32 s9, 0x3f803f80
  s_lshl_b32 s44, s13, 10
  s_lshl_b32 s45, s13, 6
  s_mov_b32 s47, 0xf0
  s_lshl_b32 s34, s12, 12
  s_lshl_b32 s35, s13, 10
  s_add_u32 s34, s34, s35
  s_add_u32 s23, s34, 88080384
  s_mov_b32 s28, 0xcccccccc
  s_mov_b32 s29, 0xcccccccc
  s_mov_b32 s30, 0x003f003f
  s_mov_b32 s31, 0x003f003f
  s_mov_b32 s32, 0x3e0293ee
  s_mov_b32 s33, s32
  s_mov_b32 s25, 0
  s_lshr_b32 s34, s12, 4
  s_and_b32 s35, s12, 15
  s_cmp_eq_u32 s13, 0
  s_cselect_b32 s25, 1, 0
  s_cmp_lg_u32 s13, 1
  s_cbranch_scc1 RT_42
  s_cmp_ge_u32 s12, 16
  s_cbranch_scc1 RT_42
  s_mov_b32 s25, 1
  s_mov_b32 s34, 2
RT_42:
  s_lshr_b32 s36, s35, 2
  s_and_b32 s37, s35, 3
  s_mul_i32 s41, s36, 3072
  s_lshl_b32 s43, s34, 10
  s_add_u32 s41, s41, s43
  s_lshl_b32 s43, s37, 8
  s_add_u32 s41, s41, s43
  s_sub_u32 s34, 2, s34
  s_mul_i32 s38, s34, 3072
  s_lshl_b32 s43, s37, 8
  s_add_u32 s38, s38, s43
  s_lshl_b32 s43, s36, 6
  s_add_u32 s38, s38, s43
  s_mov_b32 s24, 0
  s_barrier
  s_cmp_lg_u32 s13, 0
  s_cbranch_scc1 SIG_43
  v_mov_b32 v4, 40
  v_mov_b32 v5, 1
  s_mov_b64 exec, 1
  global_atomic_add v4, v5, s[92:93]
  s_mov_b64 exec, -1
SIG_43:
  v_mov_b32 v44, 0
  v_mov_b32 v45, 0
  s_mov_b32 s43, 0
  v_writelane_b32 v44, s43, 0
  s_mov_b32 s43, 4294967295
  v_writelane_b32 v45, s43, 0
  s_mov_b32 s43, 44
  v_writelane_b32 v44, s43, 1
  s_mov_b32 s43, 32
  v_writelane_b32 v45, s43, 1
  s_mov_b32 s43, 96
  v_writelane_b32 v44, s43, 2
  s_mov_b32 s43, 96
  v_writelane_b32 v45, s43, 2
  s_mov_b32 s43, 100
  v_writelane_b32 v44, s43, 3
  s_mov_b32 s43, 96
  v_writelane_b32 v45, s43, 3
  s_cmp_lg_u32 s13, 0
  s_cbranch_scc1 FE0
  s_mov_b32 s27, 0
  s_mov_b64 exec, 15
FW0:
  global_load_dword v46, v44, s[92:93] sc1
  s_add_u32 s27, s27, 1
  s_cmp_gt_u32 s27, 0x20000
  s_cbranch_scc1 FD0
  s_waitcnt vmcnt(0)
  v_cmp_gt_u32 vcc, v45, v46
  s_cbranch_vccz FD0
  s_sleep 6
  s_branch FW0
FD0:
  s_waitcnt vmcnt(0)
  s_mov_b64 exec, -1
FE0:
  s_barrier
  v_mov_b32 v4, 48
  global_load_dword v5, v4, s[92:93] sc1
  s_sub_u32 s35, s21, 262144
  s_mov_b32 m0, s58
  s_nop 0
  buffer_load_dwordx4 v0, s[4:7], s35 offen offset:0 sc1 lds
  buffer_load_dwordx4 v0, s[4:7], s35 offen offset:1024 sc1 lds
  buffer_load_dwordx4 v0, s[4:7], s35 offen offset:2048 sc1 lds
  buffer_load_dwordx4 v0, s[4:7], s35 offen offset:3072 sc1 lds
  v_lshlrev_b32 v6, 3, v0
  s_mov_b32 m0, 8192
  s_sub_u32 s35, s50, 262144
  s_mov_b64 exec, 0xffffffff
  buffer_load_dword v6, s[4:7], s35 offen sc1 lds
  s_mov_b64 exec, -1
  s_mul_i32 s43, s12, 12288
  s_and_b32 s27, s13, 1
  s_lshl_b32 s27, s27, 19
  s_add_u32 s43, s43, s27
  s_lshr_b32 s27, s13, 1
  s_lshl_b32 s27, s27, 13
  s_add_u32 s43, s43, s27
  s_add_u32 s43, s43, 65536
  buffer_load_dword v6, s[4:7], s43 offen sc1 lds
  s_lshl_b32 s43, s13, 13
  s_add_u32 s43, s43, 1064960
  buffer_load_dword v6, s[4:7], s43 offen sc1 lds
  s_waitcnt vmcnt(7)
  v_readfirstlane_b32 s34, v5
  v_and_b32 v8, 0xf0, v0
  v_bfe_u32 v4, v0, 8, 2
  v_lshl_add_u32 v4, v4, 2, v8
  v_lshlrev_b32 v4, 1, v4
  v_lshrrev_b32 v8, 8, v0
  v_bfe_u32 v9, v0, 6, 2
  v_lshl_add_u32 v8, v8, 3, v9
  v_bfe_u32 v5, v0, 4, 2
  v_lshlrev_b32 v5, 3, v5
  v_lshl_add_u32 v5, v8, 5, v5
  v_bfe_u32 v8, v0, 6, 2
  v_bfe_u32 v7, v0, 4, 1
  v_lshl_add_u32 v7, v8, 1, v7
  v_lshlrev_b32 v9, 1, v7
  v_lshrrev_b32 v8, 9, v0
  v_xor_b32 v6, v8, v9
  v_lshlrev_b32 v6, 4, v6
  v_lshl_add_u32 v6, v7, 8, v6
  v_bfe_u32 v8, v0, 8, 1
  v_lshl_add_u32 v6, v8, 3, v6
  v_lshrrev_b32 v8, 8, v0
  v_bfe_u32 v10, v0, 5, 1
  v_lshl_add_u32 v8, v8, 1, v10
  v_xor_b32 v8, v8, v9
  v_lshlrev_b32 v8, 4, v8
  v_lshl_add_u32 v7, v7, 8, v8
  ds_write_b128 v0, v[4:7] offset:9216
  s_waitcnt lgkmcnt(0)
  v_mov_b32 v40, 0
  v_mov_b32 v41, 0
  v_mov_b32 v42, 0
  v_mov_b32 v43, 0
  v_mov_b32 v44, 0
  v_mov_b32 v45, 0
  v_mov_b32 v46, 0
  v_mov_b32 v47, 0
  v_mov_b32 v48, 0
  v_mov_b32 v49, 0
  v_mov_b32 v50, 0
  v_mov_b32 v51, 0
  v_mov_b32 v52, 0
  v_mov_b32 v53, 0
  v_mov_b32 v54, 0
  v_mov_b32 v55, 0
  v_mov_b32 v56, 0
  v_mov_b32 v57, 0
  v_mov_b32 v58, 0
  v_mov_b32 v59, 0
  v_mov_b32 v60, 0
  v_mov_b32 v61, 0
  v_mov_b32 v62, 0
  v_mov_b32 v63, 0
  ds_read_b128 v[64:67], v2 offset:0
  ds_read_b128 v[68:71], v2 offset:1024
  ds_read_b128 v[72:75], v2 offset:2048
  ds_read_b128 v[76:79], v2 offset:3072
  v_bfe_u32 v4, v0, 6, 2
  v_lshlrev_b32 v3, 8, v4
  v_lshrrev_b32 v4, 8, v0
  v_lshl_add_u32 v3, v4, 6, v3
  v_bfe_u32 v4, v0, 4, 1
  v_lshl_add_u32 v3, v4, 5, v3
  v_bfe_u32 v4, v0, 5, 1
  v_lshl_add_u32 v3, v4, 4, v3
  s_cmp_lg_u32 s34, 0
  s_cbranch_scc1 STEPS
STEPF:
  s_add_u32 s39, s18, 4096
  s_add_u32 s40, s18, 8192
  s_add_u32 m0, s26, 10240
  s_add_u32 s34, s18, s26
  s_add_u32 s34, s34, 3072
  s_mov_b32 s27, 0
POLLM0F:
  buffer_load_dwordx4 v[4:7], v3, s[4:7], s18 offen offset:0 sc1
  buffer_load_dwordx4 v[8:11], v3, s[4:7], s18 offen offset:1024 sc1
  buffer_load_dwordx4 v[12:15], v3, s[4:7], s18 offen offset:2048 sc1
  s_add_u32 s27, s27, 1
  s_cmp_gt_u32 s27, 0x40000
  s_cselect_b32 s15, 1, s15
  s_cmp_lg_u32 s15, 0
  s_cselect_b64 s[36:37], 0, -1
  s_waitcnt vmcnt(2)
  v_max_u32 v39, v5, v7
  s_waitcnt vmcnt(1)
  v_max3_u32 v39, v39, v9, v11
  s_waitcnt vmcnt(0)
  v_max3_u32 v39, v39, v13, v15
  v_cmp_eq_u32 vcc, -1, v39
  s_nop 0
  s_and_b64 vcc, vcc, s[36:37]
  s_cbranch_vccnz POLLM0F
  v_smfmac_f32_16x16x64_bf16 v[48:51], v[4:7], a[96:103], v1
  buffer_load_dwordx4 v0, s[4:7], s34 offen sc1 lds
  v_smfmac_f32_16x16x64_bf16 v[52:55], v[4:7], a[104:111], v1
  s_mov_b64 exec, 0xffffffff
  buffer_load_dwordx4 v0, s[4:7], s34 offen offset:1024 sc1 lds
  s_mov_b64 exec, -1
  v_smfmac_f32_16x16x64_bf16 v[56:59], v[4:7], a[208:215], v1
  buffer_load_dwordx4 v[32:35], v0, s[4:7], s22 offen offset:0 sc1
  v_smfmac_f32_16x16x64_bf16 v[60:63], v[4:7], a[216:223], v1
  buffer_load_dwordx4 v[36:39], v0, s[4:7], s22 offen offset:1024 sc1
  s_waitcnt lgkmcnt(0)
  v_smfmac_f32_16x16x64_bf16 v[40:43], v[4:7], v[64:71], v1
  ds_read_b128 v[64:67], v2 offset:4096
  v_smfmac_f32_16x16x64_bf16 v[44:47], v[4:7], v[72:79], v1
  ds_read_b128 v[68:71], v2 offset:5120
  v_smfmac_f32_16x16x64_bf16 v[40:43], v[8:11], a[0:7], v1
  ds_read_b128 v[72:75], v2 offset:6144
  v_smfmac_f32_16x16x64_bf16 v[44:47], v[8:11], a[8:15], v1
  ds_read_b128 v[76:79], v2 offset:7168
  v_smfmac_f32_16x16x64_bf16 v[48:51], v[8:11], a[112:119], v1
  v_smfmac_f32_16x16x64_bf16 v[52:55], v[8:11], a[120:127], v1
  v_smfmac_f32_16x16x64_bf16 v[56:59], v[8:11], a[224:231], v1
  v_smfmac_f32_16x16x64_bf16 v[60:63], v[8:11], a[232:239], v1
  v_smfmac_f32_16x16x64_bf16 v[40:43], v[12:15], a[16:23], v1
  s_waitcnt vmcnt(2)
  s_barrier
  v_smfmac_f32_16x16x64_bf16 v[44:47], v[12:15], a[24:31], v1
  ds_read_b128 v[16:19], v3 offset:10240
  ds_read_b128 v[20:23], v3 offset:11264
  v_smfmac_f32_16x16x64_bf16 v[56:59], v[12:15], a[240:247], v1
  ds_read_b128 v[24:27], v3 offset:12288
  ds_read_b128 v[28:31], v3 offset:13312
  v_smfmac_f32_16x16x64_bf16 v[60:63], v[12:15], a[248:255], v1
  ds_read_b128 v[4:7], v3 offset:14336
  ds_read_b128 v[8:11], v3 offset:15360
  s_waitcnt lgkmcnt(8)
  v_smfmac_f32_16x16x64_bf16 v[48:51], v[12:15], v[64:71], v1
  v_lshlrev_b32 v3, 3, v0
  s_mov_b32 m0, 8192
  s_mov_b64 exec, 0xffffffff
  buffer_load_dword v3, s[4:7], s50 offen sc1 lds
  s_mov_b64 exec, -1
  s_waitcnt lgkmcnt(6)
  v_smfmac_f32_16x16x64_bf16 v[52:55], v[12:15], v[72:79], v1
  ds_read_b128 v[64:67], v2 offset:8192
  s_waitcnt lgkmcnt(6)
  v_smfmac_f32_16x16x64_bf16 v[40:43], v[16:19], a[32:39], v1
  v_max_u32 v3, v17, v19
  ds_read_b128 v[68:71], v2 offset:9216
  v_smfmac_f32_16x16x64_bf16 v[44:47], v[16:19], a[40:47], v1
  ds_read_b128 v[72:75], v2 offset:10240
  v_smfmac_f32_16x16x64_bf16 v[48:51], v[16:19], a[128:135], v1
  ds_read_b128 v[76:79], v2 offset:11264
  v_smfmac_f32_16x16x64_bf16 v[52:55], v[16:19], a[136:143], v1
  v_smfmac_f32_16x16x64_bf16 v[56:59], v[16:19], v[80:87], v1
  v_smfmac_f32_16x16x64_bf16 v[60:63], v[16:19], v[88:95], v1
  s_waitcnt lgkmcnt(8)
  v_smfmac_f32_16x16x64_bf16 v[48:51], v[20:23], a[144:151], v1
  v_max3_u32 v3, v3, v21, v23
  v_smfmac_f32_16x16x64_bf16 v[52:55], v[20:23], a[152:159], v1
  s_waitcnt lgkmcnt(2)
  v_smfmac_f32_16x16x64_bf16 v[40:43], v[20:23], v[64:71], v1
  ds_read_b128 v[64:67], v2 offset:12288
  s_waitcnt lgkmcnt(1)
  v_smfmac_f32_16x16x64_bf16 v[44:47], v[20:23], v[72:79], v1
  ds_read_b128 v[68:71], v2 offset:13312
  v_smfmac_f32_16x16x64_bf16 v[40:43], v[24:27], a[48:55], v1
  v_max3_u32 v3, v3, v25, v27
  ds_read_b128 v[72:75], v2 offset:14336
  v_smfmac_f32_16x16x64_bf16 v[44:47], v[24:27], a[56:63], v1
  ds_read_b128 v[76:79], v2 offset:15360
  v_smfmac_f32_16x16x64_bf16 v[48:51], v[24:27], a[160:167], v1
  ds_read_b128 v[12:15], v0 offset:9216
  v_smfmac_f32_16x16x64_bf16 v[52:55], v[24:27], a[168:175], v1
  v_smfmac_f32_16x16x64_bf16 v[40:43], v[28:31], a[64:71], v1
  v_max3_u32 v3, v3, v29, v31
  v_smfmac_f32_16x16x64_bf16 v[44:47], v[28:31], a[72:79], v1
  s_waitcnt lgkmcnt(3)
  v_smfmac_f32_16x16x64_bf16 v[48:51], v[28:31], v[64:71], v1
  ds_read_b128 v[64:67], v2 offset:16384
  s_waitcnt lgkmcnt(2)
  v_smfmac_f32_16x16x64_bf16 v[52:55], v[28:31], v[72:79], v1
  ds_read_b128 v[68:71], v2 offset:17408
  v_smfmac_f32_16x16x64_bf16 v[40:43], v[4:7], a[80:87], v1
  v_max3_u32 v3, v3, v5, v7
  ds_read_b128 v[72:75], v2 offset:18432
  v_smfmac_f32_16x16x64_bf16 v[44:47], v[4:7], a[88:95], v1
  ds_read_b128 v[76:79], v2 offset:19456
  v_smfmac_f32_16x16x64_bf16 v[48:51], v[4:7], a[176:183], v1
  v_smfmac_f32_16x16x64_bf16 v[52:55], v[4:7], a[184:191], v1
  v_smfmac_f32_16x16x64_bf16 v[48:51], v[8:11], a[192:199], v1
  v_max3_u32 v3, v3, v9, v11
  v_smfmac_f32_16x16x64_bf16 v[52:55], v[8:11], a[200:207], v1
  s_waitcnt lgkmcnt(2)
  v_smfmac_f32_16x16x64_bf16 v[40:43], v[8:11], v[64:71], v1
  s_waitcnt lgkmcnt(0)
  v_smfmac_f32_16x16x64_bf16 v[44:47], v[8:11], v[72:79], v1
  v_cmp_eq_u32 vcc, -1, v3
  v_smfmac_f32_16x16x64_bf16 v[56:59], v[20:23], v[96:103], v1
  v_add_u32 v12, s44, v12
  v_pk_add_f32 v[48:49], v[48:49], v[50:51]
  v_pk_add_f32 v[52:53], v[52:53], v[54:55]
  v_cvt_pk_bf16_f32 v48, v48, v49
  v_cvt_pk_bf16_f32 v50, v52, v53
  v_pk_add_f32 v[40:41], v[40:41], v[42:43]
  v_pk_add_f32 v[44:45], v[44:45], v[46:47]
  v_pk_mul_f32 v[40:41], v[40:41], s[32:33]
  v_pk_mul_f32 v[44:45], v[44:45], s[32:33]
  v_cvt_pk_bf16_f32 v49, v40, v41
  v_cvt_pk_bf16_f32 v51, v44, v45
  ds_write2st64_b64 v12, v[48:49], v[50:51] offset0:20 offset1:21
  v_smfmac_f32_16x16x64_bf16 v[60:63], v[20:23], v[104:111], v1
  ds_read_b128 v[64:67], v0 offset:0
  ds_read_b128 v[68:71], v0 offset:4096
  s_and_b64 vcc, vcc, s[36:37]
  s_cbranch_vccnz REDOF
REDOXF:
  v_smfmac_f32_16x16x64_bf16 v[56:59], v[24:27], v[112:119], v1
  ds_read_b128 v[72:75], v0 offset:1024
  ds_read_b128 v[76:79], v0 offset:5120
  v_lshrrev_b32 v3, 1, v0
  v_mov_b32 v52, v48
  v_mov_b32 v53, v50
  v_smfmac_f32_16x16x64_bf16 v[60:63], v[24:27], v[120:127], v1
  ds_read_b128 v[20:23], v0 offset:2048
  ds_read_b128 v[24:27], v0 offset:6144
  ds_read_b128 v[16:19], v0 offset:3072
  v_smfmac_f32_16x16x64_bf16 v[56:59], v[28:31], v[128:135], v1
  v_smfmac_f32_16x16x64_bf16 v[60:63], v[28:31], v[136:143], v1
  s_waitcnt lgkmcnt(7)
  s_barrier
  ds_read_b64_tr_b16 v[40:41], v13 offset:10240
  ds_read_b64_tr_b16 v[42:43], v13 offset:10368
  ds_read_b64_tr_b16 v[44:45], v13 offset:11264
  ds_read_b64_tr_b16 v[46:47], v13 offset:11392
  ds_read_b64_tr_b16 v[48:49], v13 offset:12288
  ds_read_b64_tr_b16 v[50:51], v13 offset:12416
  buffer_store_dwordx2 v[52:53], v3, s[4:7], s23 offen sc1
  ds_read_b64_tr_b16 v[52:53], v13 offset:13312
  ds_read_b64_tr_b16 v[54:55], v13 offset:13440
  v_smfmac_f32_16x16x64_bf16 v[56:59], v[4:7], v[144:151], v1
  v_smfmac_f32_16x16x64_bf16 v[60:63], v[4:7], v[152:159], v1
  v_smfmac_f32_16x16x64_bf16 v[56:59], v[8:11], v[160:167], v1
  v_smfmac_f32_16x16x64_bf16 v[60:63], v[8:11], v[168:175], v1
  s_waitcnt lgkmcnt(6)
  v_mfma_f32_16x16x32_bf16 v[28:31], v[64:67], v[40:43], 0
  v_mfma_f32_16x16x32_bf16 v[4:7], v[68:71], v[40:43], 0
  ds_read_b128 v[64:67], v0 offset:7168
  v_mfma_f32_16x16x32_bf16 v[8:11], v[40:43], v[40:43], 0
  s_waitcnt lgkmcnt(5)
  v_mfma_f32_16x16x32_bf16 v[28:31], v[72:75], v[44:47], v[28:31]
  v_mfma_f32_16x16x32_bf16 v[4:7], v[76:79], v[44:47], v[4:7]
  v_pk_add_f32 v[56:57], v[56:57], v[58:59]
  v_pk_add_f32 v[60:61], v[60:61], v[62:63]
  v_mfma_f32_16x16x32_bf16 v[8:11], v[44:47], v[44:47], v[8:11]
  v_cvt_pk_bf16_f32 v56, v56, v57
  v_cvt_pk_bf16_f32 v57, v60, v61
  s_waitcnt lgkmcnt(3)
  v_mfma_f32_16x16x32_bf16 v[28:31], v[20:23], v[48:51], v[28:31]
  buffer_store_dwordx2 v[56:57], v3, s[4:7], s23 offen offset:512 sc1
  v_mfma_f32_16x16x32_bf16 v[4:7], v[24:27], v[48:51], v[4:7]
  v_xor_b32 v14, s45, v14
  v_xor_b32 v12, 32, v14
  v_mfma_f32_16x16x32_bf16 v[8:11], v[48:51], v[48:51], v[8:11]
  v_xor_b32 v13, 128, v15
  s_waitcnt lgkmcnt(1)
  v_mfma_f32_16x16x32_bf16 v[8:11], v[52:55], v[52:55], v[8:11]
  v_mfma_f32_16x16x32_bf16 v[28:31], v[16:19], v[52:55], v[28:31]
  s_waitcnt lgkmcnt(0)
  v_mfma_f32_16x16x32_bf16 v[4:7], v[64:67], v[52:55], v[4:7]
  ds_read_b128 v[40:43], v2 offset:24576
  ds_read_b128 v[44:47], v2 offset:25600
  ds_read_b128 v[72:75], v2 offset:22528
  ds_read_b128 v[76:79], v2 offset:23552
  s_nop 1
  v_max3_f32 v58, v8, v9, v28
  v_max3_f32 v58, v58, v29, v30
  v_mov_b32 v53, 0
  v_mov_b32 v54, 0
  v_max3_f32 v59, v4, v5, v6
  v_max3_f32 v58, v58, v31, v7
  v_max_f32 v58, v58, v59
  v_max_f32 v59, v58, v59
  v_mov_b64 v[16:17], s[8:9]
  v_mov_b64 v[18:19], s[8:9]
  v_permlane32_swap_b32 v58, v59
  v_max_f32 v58, v58, v59
  v_max_f32 v59, v58, v59
  ds_read_b128 v[64:67], v2 offset:20480
  ds_read_b128 v[68:71], v2 offset:21504
  v_permlane16_swap_b32 v58, v59
  v_max_f32 v58, v58, v59
  v_pk_add_f32 v[28:29], v[28:29], v[58:59] op_sel_hi:[1,0] neg_lo:[0,1] neg_hi:[0,1]
  v_pk_add_f32 v[30:31], v[30:31], v[58:59] op_sel_hi:[1,0] neg_lo:[0,1] neg_hi:[0,1]
  v_pk_add_f32 v[4:5], v[4:5], v[58:59] op_sel_hi:[1,0] neg_lo:[0,1] neg_hi:[0,1]
  v_pk_add_f32 v[6:7], v[6:7], v[58:59] op_sel_hi:[1,0] neg_lo:[0,1] neg_hi:[0,1]
  v_pk_add_f32 v[8:9], v[8:9], v[58:59] op_sel_hi:[1,0] neg_lo:[0,1] neg_hi:[0,1]
  v_exp_f32 v28, v28
  v_exp_f32 v29, v29
  v_exp_f32 v30, v30
  v_exp_f32 v31, v31
  v_cvt_pk_bf16_f32 v48, v28, v29
  v_exp_f32 v4, v4
  v_exp_f32 v5, v5
  v_cvt_pk_bf16_f32 v49, v30, v31
  v_exp_f32 v6, v6
  v_exp_f32 v7, v7
  v_cvt_pk_bf16_f32 v50, v4, v5
  v_exp_f32 v8, v8
  v_cvt_pk_bf16_f32 v51, v6, v7
  v_exp_f32 v9, v9
  s_waitcnt vmcnt(3)
  v_mfma_f32_16x16x32_bf16 v[60:63], v[16:19], v[48:51], 0
  v_cvt_pk_bf16_f32 v52, v8, v9
  v_cvt_pk_bf16_f32 v55, v8, v9
  v_mfma_f32_16x16x32_bf16 v[20:23], v[32:35], v[48:51], 0
  v_mfma_f32_16x16x16_bf16 v[60:63], v[16:17], v[52:53], v[60:63]
  v_mfma_f32_16x16x32_bf16 v[24:27], v[36:39], v[48:51], 0
  v_mfma_f32_16x16x16_bf16 v[20:23], v[56:57], v[52:53], v[20:23]
  v_mfma_f32_16x16x16_bf16 v[24:27], v[56:57], v[54:55], v[24:27]
  ds_read_b128 v[48:51], v2 offset:26624
  ds_read_b128 v[52:55], v2 offset:27648
  v_mov_b64 v[28:29], 0
  v_mov_b64 v[30:31], 0
  s_nop 0
  v_rcp_f32 v60, v60
  v_mov_b64 v[32:33], 0
  v_mov_b64 v[34:35], 0
  v_mov_b64 v[36:37], 0
  v_mov_b64 v[38:39], 0
  v_pk_mul_f32 v[20:21], v[20:21], v[60:61] op_sel_hi:[1,0]
  v_pk_mul_f32 v[22:23], v[22:23], v[60:61] op_sel_hi:[1,0]
  v_cvt_pk_bf16_f32 v20, v20, v21
  v_cvt_pk_bf16_f32 v21, v22, v23
  s_mov_b64 exec, s[28:29]
  ds_write_b64 v14, v[20:21] offset:14336
  v_pk_mul_f32 v[24:25], v[24:25], v[60:61] op_sel_hi:[1,0]
  v_pk_mul_f32 v[26:27], v[26:27], v[60:61] op_sel_hi:[1,0]
  v_cvt_pk_bf16_f32 v24, v24, v25
  v_cvt_pk_bf16_f32 v25, v26, v27
  ds_write_b64 v12, v[24:25] offset:14336
  s_mov_b64 exec, -1
  v_mov_b32 v12, 0
  v_mov_b32 v14, 0
  v_mov_b64 v[16:17], 0
  v_mov_b64 v[18:19], 0
  v_mov_b64 v[20:21], 0
  v_mov_b64 v[22:23], 0
  v_mov_b64 v[24:25], 0
  v_mov_b64 v[26:27], 0
  s_waitcnt lgkmcnt(0)
  s_barrier
  ds_read_b128 v[4:7], v15 offset:14336
  ds_read_b128 v[8:11], v13 offset:14336
  ds_read_b128 v[56:59], v2 offset:32768
  ds_read_b128 v[60:63], v2 offset:33792
  v_mov_b32 v13, 0
  v_mov_b32 v15, 0
  s_waitcnt lgkmcnt(3)
  s_nop 0
  v_smfmac_f32_16x16x64_bf16 v[12:15], v[4:7], v[176:183], v1
  v_smfmac_f32_16x16x64_bf16 v[16:19], v[4:7], v[184:191], v1
  v_smfmac_f32_16x16x64_bf16 v[20:23], v[4:7], v[192:199], v1
  s_waitcnt lgkmcnt(2)
  v_smfmac_f32_16x16x64_bf16 v[12:15], v[8:11], v[64:71], v1
  ds_read_b128 v[64:67], v2 offset:28672
  v_smfmac_f32_16x16x64_bf16 v[16:19], v[8:11], v[72:79], v1
  ds_read_b128 v[68:71], v2 offset:29696
  v_smfmac_f32_16x16x64_bf16 v[20:23], v[8:11], v[40:47], v1
  ds_read_b128 v[72:75], v2 offset:30720
  v_smfmac_f32_16x16x64_bf16 v[24:27], v[4:7], v[200:207], v1
  ds_read_b128 v[76:79], v2 offset:31744
  v_mov_b64 v[40:41], 0
  v_mov_b64 v[42:43], 0
  v_smfmac_f32_16x16x64_bf16 v[28:31], v[4:7], v[208:215], v1
  v_mov_b64 v[44:45], 0
  v_mov_b64 v[46:47], 0
  v_smfmac_f32_16x16x64_bf16 v[32:35], v[4:7], v[216:223], v1
  v_pk_add_f32 v[12:13], v[12:13], v[14:15]
  v_cvt_pk_bf16_f32 v12, v12, v13
  v_mov_b32 v15, s54
  v_smfmac_f32_16x16x64_bf16 v[24:27], v[8:11], v[48:55], v1
  ds_read_b128 v[48:51], v2 offset:34816
  v_pk_add_f32 v[16:17], v[16:17], v[18:19]
  v_cvt_pk_bf16_f32 v13, v16, v17
  v_pk_add_f32 v[20:21], v[20:21], v[22:23]
  s_waitcnt lgkmcnt(3)
  v_smfmac_f32_16x16x64_bf16 v[28:31], v[8:11], v[64:71], v1
  ds_read_b128 v[52:55], v2 offset:35840
  v_cvt_pk_bf16_f32 v14, v20, v21
  buffer_store_dwordx4 v[12:15], v0, s[4:7], s17 offen offset:0
  s_waitcnt lgkmcnt(2)
  v_smfmac_f32_16x16x64_bf16 v[32:35], v[8:11], v[72:79], v1
  v_smfmac_f32_16x16x64_bf16 v[36:39], v[4:7], v[224:231], v1
  v_smfmac_f32_16x16x64_bf16 v[40:43], v[4:7], v[232:239], v1
  v_smfmac_f32_16x16x64_bf16 v[44:47], v[4:7], v[240:247], v1
  v_pk_add_f32 v[24:25], v[24:25], v[26:27]
  v_cvt_pk_bf16_f32 v24, v24, v25
  v_mov_b32 v27, s54
  v_smfmac_f32_16x16x64_bf16 v[44:47], v[8:11], v[248:255], v1
  v_pk_add_f32 v[28:29], v[28:29], v[30:31]
  v_cvt_pk_bf16_f32 v25, v28, v29
  v_pk_add_f32 v[32:33], v[32:33], v[34:35]
  v_smfmac_f32_16x16x64_bf16 v[36:39], v[8:11], v[56:63], v1
  v_cvt_pk_bf16_f32 v26, v32, v33
  buffer_store_dwordx4 v[24:27], v0, s[4:7], s17 offen offset:1024
  s_waitcnt lgkmcnt(0)
  v_smfmac_f32_16x16x64_bf16 v[40:43], v[8:11], v[48:55], v1
  v_pk_add_f32 v[44:45], v[44:45], v[46:47]
  s_nop 2
  v_pk_add_f32 v[36:37], v[36:37], v[38:39]
  v_cvt_pk_bf16_f32 v38, v44, v45
  v_cvt_pk_bf16_f32 v36, v36, v37
  v_mov_b32 v39, s54
  v_pk_add_f32 v[40:41], v[40:41], v[42:43]
  v_cvt_pk_bf16_f32 v37, v40, v41
  buffer_store_dwordx4 v[36:39], v0, s[4:7], s17 offen offset:2048
  s_add_u32 s22, s22, 262144
  s_add_u32 s50, s50, 262144
  s_add_u32 s23, s23, 131072
  s_xor_b32 s17, s17, s42
  s_add_u32 s14, s14, 1
  s_and_b32 s34, s14, 3
  s_lshl_b32 s54, s34, 7
  s_add_u32 s54, s54, 0x3f80
  s_bitcmp0_b32 s25, 0
  s_cbranch_scc1 NOREDF
  v_lshrrev_b32 v78, 8, v0
  v_mul_u32_u24 v76, 12288, v78
  v_and_or_b32 v76, v0, s47, v76
  s_add_u32 s43, s16, s41
  s_mov_b32 s27, 0
  s_sleep 7
  buffer_load_dwordx4 v[4:7], v76, s[4:7], s43 offen sc1
  s_add_u32 s43, s43, 49152
  buffer_load_dwordx4 v[8:11], v76, s[4:7], s43 offen sc1
  s_add_u32 s43, s43, 49152
  buffer_load_dwordx4 v[12:15], v76, s[4:7], s43 offen sc1
  s_add_u32 s43, s43, 49152
  buffer_load_dwordx4 v[16:19], v76, s[4:7], s43 offen sc1
  s_add_u32 s43, s43, 49152
  buffer_load_dwordx4 v[20:23], v76, s[4:7], s43 offen sc1
  s_add_u32 s43, s43, 49152
  buffer_load_dwordx4 v[24:27], v76, s[4:7], s43 offen sc1
  s_add_u32 s43, s43, 49152
  buffer_load_dwordx4 v[28:31], v76, s[4:7], s43 offen sc1
  s_add_u32 s43, s43, 49152
  buffer_load_dwordx4 v[32:35], v76, s[4:7], s43 offen sc1
  s_add_u32 s43, s43, 4294623232
  v_bfe_u32 v79, v0, 4, 4
  v_and_b32 v77, 1, v79
  v_lshlrev_b32 v77, 4, v77
  v_mov_b32 v72, 0x3f80
  v_lshlrev_b32 v77, v77, v72
  v_lshrrev_b32 v72, 1, v79
  v_cmp_eq_u32 vcc, 0, v72
  v_mov_b64 v[40:41], 0
  v_mov_b64 v[42:43], 0
  v_cndmask_b32 v36, 0, v77, vcc
  v_cmp_eq_u32 vcc, 1, v72
  v_mov_b64 v[44:45], 0
  v_mov_b64 v[46:47], 0
  v_cndmask_b32 v37, 0, v77, vcc
  v_cmp_eq_u32 vcc, 2, v72
  v_mov_b64 v[48:49], 0
  v_mov_b64 v[50:51], 0
  v_cndmask_b32 v38, 0, v77, vcc
  v_cmp_eq_u32 vcc, 3, v72
  v_mov_b64 v[52:53], 0
  v_mov_b64 v[54:55], 0
  v_cndmask_b32 v39, 0, v77, vcc
  v_and_b32 v77, 1, v79
  v_lshlrev_b32 v77, 5, v77
  v_lshl_add_u32 v77, v72, 10, v77
  v_lshl_add_u32 v77, v78, 3, v77
  v_add_u32 v77, s38, v77
  v_mov_b64 v[56:57], 0
  v_mov_b64 v[58:59], 0
  v_mov_b64 v[60:61], 0
  v_mov_b64 v[62:63], 0
  v_bfe_u32 v79, v0, 6, 2
  v_lshlrev_b32 v3, 8, v79
  v_lshrrev_b32 v79, 8, v0
  v_lshl_add_u32 v3, v79, 6, v3
  v_bfe_u32 v79, v0, 4, 1
  v_lshl_add_u32 v3, v79, 5, v3
  v_bfe_u32 v79, v0, 5, 1
  v_lshl_add_u32 v3, v79, 4, v3
  ds_read_b128 v[64:67], v2 offset:0
  ds_read_b128 v[68:71], v2 offset:1024
RWAITF:
  s_waitcnt vmcnt(7)
  v_mfma_f32_16x16x32_bf16 v[72:75], v[4:7], v[36:39], 0
  v_xor_b32 v78, s55, v7
  s_waitcnt vmcnt(6)
  v_mfma_f32_16x16x32_bf16 v[72:75], v[8:11], v[36:39], v[72:75]
  v_xor_b32 v79, s55, v11
  v_or_b32 v78, v78, v79
  s_waitcnt vmcnt(5)
  v_mfma_f32_16x16x32_bf16 v[72:75], v[12:15], v[36:39], v[72:75]
  v_xor_b32 v79, s55, v15
  v_or_b32 v78, v78, v79
  s_waitcnt vmcnt(4)
  v_mfma_f32_16x16x32_bf16 v[72:75], v[16:19], v[36:39], v[72:75]
  v_xor_b32 v79, s55, v19
  v_or_b32 v78, v78, v79
  s_waitcnt vmcnt(3)
  v_mfma_f32_16x16x32_bf16 v[72:75], v[20:23], v[36:39], v[72:75]
  v_xor_b32 v79, s55, v23
  v_or_b32 v78, v78, v79
  s_waitcnt vmcnt(2)
  v_mfma_f32_16x16x32_bf16 v[72:75], v[24:27], v[36:39], v[72:75]
  v_xor_b32 v79, s55, v27
  v_or_b32 v78, v78, v79
  s_waitcnt vmcnt(1)
  v_mfma_f32_16x16x32_bf16 v[72:75], v[28:31], v[36:39], v[72:75]
  v_xor_b32 v79, s55, v31
  v_or_b32 v78, v78, v79
  s_waitcnt vmcnt(0)
  v_mfma_f32_16x16x32_bf16 v[72:75], v[32:35], v[36:39], v[72:75]
  v_xor_b32 v79, s55, v35
  v_or_b32 v78, v78, v79
  v_cmp_ne_u32 vcc, 0, v78
  s_nop 0
  s_and_b64 vcc, vcc, -1
  s_cselect_b64 s[56:57], 0, s[30:31]
  s_nop 1
  v_cvt_pk_bf16_f32 v72, v72, v73
  v_cvt_pk_bf16_f32 v73, v74, v75
  s_mov_b64 exec, s[56:57]
  buffer_store_dwordx2 v[72:73], v77, s[4:7], s19 offen
  s_cbranch_scc1 RCHKF
  s_branch RG2F
RGOF:
  buffer_store_dwordx2 v[72:73], v77, s[4:7], s19 offen
RG2F:
  v_mov_b64 v[4:5], -1
  buffer_store_dwordx2 v[4:5], v77, s[4:7], s18 offen
  s_mov_b64 exec, -1
  ds_read_b128 v[72:75], v2 offset:2048
  ds_read_b128 v[76:79], v2 offset:3072
  s_branch NEXTF
NOREDF:
  s_cmp_lt_u32 s13, 2
  s_cbranch_scc1 NODMAF
  s_mov_b32 m0, s58
  s_nop 0
  buffer_load_dwordx4 v0, s[4:7], s21 offen offset:0 sc1 lds
  buffer_load_dwordx4 v0, s[4:7], s21 offen offset:1024 sc1 lds
  buffer_load_dwordx4 v0, s[4:7], s21 offen offset:2048 sc1 lds
  buffer_load_dwordx4 v0, s[4:7], s21 offen offset:3072 sc1 lds
NODMAF:
  v_mov_b64 v[40:41], 0
  v_mov_b64 v[42:43], 0
  v_mov_b64 v[44:45], 0
  v_mov_b64 v[46:47], 0
  v_mov_b64 v[48:49], 0
  v_mov_b64 v[50:51], 0
  v_mov_b64 v[52:53], 0
  v_mov_b64 v[54:55], 0
  v_mov_b64 v[56:57], 0
  v_mov_b64 v[58:59], 0
  v_mov_b64 v[60:61], 0
  v_mov_b64 v[62:63], 0
  ds_read_b128 v[64:67], v2 offset:0
  ds_read_b128 v[68:71], v2 offset:1024
  ds_read_b128 v[72:75], v2 offset:2048
  ds_read_b128 v[76:79], v2 offset:3072
  v_bfe_u32 v4, v0, 6, 2
  v_lshlrev_b32 v3, 8, v4
  v_lshrrev_b32 v4, 8, v0
  v_lshl_add_u32 v3, v4, 6, v3
  v_bfe_u32 v4, v0, 4, 1
  v_lshl_add_u32 v3, v4, 5, v3
  v_bfe_u32 v4, v0, 5, 1
  v_lshl_add_u32 v3, v4, 4, v3
  s_sleep 15
NEXTF:
  s_xor_b32 s16, s16, s42
  s_mov_b32 s55, s54
  s_add_u32 s21, s21, 262144
  s_mov_b32 s34, s18
  s_mov_b32 s18, s19
  s_mov_b32 s19, s20
  s_mov_b32 s20, s34
  s_cmp_lg_u32 s14, 12
  s_cbranch_scc1 NKWF
  s_cmp_lg_u32 s13, 0
  s_cbranch_scc1 WFE_46
  v_mbcnt_lo_u32_b32 v4, -1, 0
  v_lshlrev_b32 v4, 2, v4
  v_add_u32 v4, 104, v4
  s_mov_b64 exec, 63
  s_mov_b32 s27, 0
WF_44:
  global_load_dword v5, v4, s[92:93] sc1
  s_add_u32 s27, s27, 1
  s_cmp_gt_u32 s27, 0x20000
  s_cbranch_scc1 WFD_45
  s_waitcnt vmcnt(0)
  v_cmp_gt_u32 vcc, 24, v5
  s_cbranch_vccz WFD_45
  s_sleep 2
  s_branch WF_44
WFD_45:
  s_waitcnt vmcnt(0)
  s_mov_b64 exec, -1
WFE_46:
  s_barrier
NKWF:
  s_cmp_lt_u32 s14, 63
  s_cbranch_scc1 STEPF
  s_add_u32 s39, s18, 4096
  s_add_u32 s40, s18, 8192
  s_mov_b32 s27, 0
FPOLLF:
  v_subrev_u32 v41, s3, v3
  buffer_load_dwordx4 v[4:7], v3, s[4:7], s18 offen offset:0 sc1
  buffer_load_dwordx4 v[8:11], v3, s[4:7], s18 offen offset:1024 sc1
  buffer_load_dwordx4 v[12:15], v3, s[4:7], s18 offen offset:2048 sc1
  buffer_load_dwordx4 v[16:19], v41, s[4:7], s18 offen offset:3072 sc1
  buffer_load_dwordx4 v[20:23], v41, s[4:7], s39 offen offset:0 sc1
  buffer_load_dwordx4 v[24:27], v41, s[4:7], s39 offen offset:1024 sc1
  buffer_load_dwordx4 v[28:31], v41, s[4:7], s39 offen offset:2048 sc1
  buffer_load_dwordx4 v[32:35], v41, s[4:7], s39 offen offset:3072 sc1
  buffer_load_dwordx4 v[36:39], v41, s[4:7], s40 offen offset:0 sc1
  s_add_u32 s27, s27, 1
  s_cmp_gt_u32 s27, 0x40000
  s_cselect_b32 s15, 1, s15
  s_waitcnt vmcnt(0)
  v_max_u32 v40, v5, v7
  v_max3_u32 v40, v40, v9, v11
  v_max3_u32 v40, v40, v13, v15
  v_max3_u32 v40, v40, v17, v19
  v_max3_u32 v40, v40, v21, v23
  v_max3_u32 v40, v40, v25, v27
  v_max3_u32 v40, v40, v29, v31
  v_max3_u32 v40, v40, v33, v35
  v_max3_u32 v40, v40, v37, v39
  v_cmp_eq_u32 vcc, -1, v40
  s_cmp_lg_u32 s15, 0
  s_cbranch_scc1 FGOF
  s_cbranch_vccnz FPOLLF
FGOF:
  ds_read_b128 v[64:67], v2 offset:4096
  ds_read_b128 v[68:71], v2 offset:5120
  ds_read_b128 v[72:75], v2 offset:6144
  ds_read_b128 v[76:79], v2 offset:7168
  ds_read_b128 v[40:43], v2 offset:12288
  ds_read_b128 v[44:47], v2 offset:13312
  v_smfmac_f32_16x16x64_bf16 v[48:51], v[4:7], a[96:103], v1
  v_smfmac_f32_16x16x64_bf16 v[52:55], v[4:7], a[104:111], v1
  v_smfmac_f32_16x16x64_bf16 v[48:51], v[8:11], a[112:119], v1
  v_smfmac_f32_16x16x64_bf16 v[52:55], v[8:11], a[120:127], v1
  v_smfmac_f32_16x16x64_bf16 v[48:51], v[16:19], a[128:135], v1
  v_smfmac_f32_16x16x64_bf16 v[52:55], v[16:19], a[136:143], v1
  v_smfmac_f32_16x16x64_bf16 v[48:51], v[20:23], a[144:151], v1
  v_smfmac_f32_16x16x64_bf16 v[52:55], v[20:23], a[152:159], v1
  v_smfmac_f32_16x16x64_bf16 v[48:51], v[24:27], a[160:167], v1
  v_smfmac_f32_16x16x64_bf16 v[52:55], v[24:27], a[168:175], v1
  v_smfmac_f32_16x16x64_bf16 v[48:51], v[32:35], a[176:183], v1
  v_smfmac_f32_16x16x64_bf16 v[52:55], v[32:35], a[184:191], v1
  v_smfmac_f32_16x16x64_bf16 v[48:51], v[36:39], a[192:199], v1
  v_smfmac_f32_16x16x64_bf16 v[52:55], v[36:39], a[200:207], v1
  s_waitcnt lgkmcnt(0)
  v_smfmac_f32_16x16x64_bf16 v[48:51], v[12:15], v[64:71], v1
  v_smfmac_f32_16x16x64_bf16 v[52:55], v[12:15], v[72:79], v1
  v_smfmac_f32_16x16x64_bf16 v[48:51], v[28:31], v[40:47], v1
  ds_read_b128 v[64:67], v2 offset:14336
  ds_read_b128 v[68:71], v2 offset:15360
  v_smfmac_f32_16x16x64_bf16 v[56:59], v[4:7], a[208:215], v1
  v_smfmac_f32_16x16x64_bf16 v[60:63], v[4:7], a[216:223], v1
  v_smfmac_f32_16x16x64_bf16 v[56:59], v[8:11], a[224:231], v1
  v_smfmac_f32_16x16x64_bf16 v[60:63], v[8:11], a[232:239], v1
  v_smfmac_f32_16x16x64_bf16 v[56:59], v[12:15], a[240:247], v1
  v_smfmac_f32_16x16x64_bf16 v[60:63], v[12:15], a[248:255], v1
  v_smfmac_f32_16x16x64_bf16 v[56:59], v[16:19], v[80:87], v1
  v_smfmac_f32_16x16x64_bf16 v[60:63], v[16:19], v[88:95], v1
  v_smfmac_f32_16x16x64_bf16 v[56:59], v[20:23], v[96:103], v1
  v_smfmac_f32_16x16x64_bf16 v[60:63], v[20:23], v[104:111], v1
  v_smfmac_f32_16x16x64_bf16 v[56:59], v[24:27], v[112:119], v1
  v_smfmac_f32_16x16x64_bf16 v[60:63], v[24:27], v[120:127], v1
  v_smfmac_f32_16x16x64_bf16 v[56:59], v[28:31], v[128:135], v1
  v_smfmac_f32_16x16x64_bf16 v[60:63], v[28:31], v[136:143], v1
  v_smfmac_f32_16x16x64_bf16 v[56:59], v[32:35], v[144:151], v1
  v_smfmac_f32_16x16x64_bf16 v[60:63], v[32:35], v[152:159], v1
  v_smfmac_f32_16x16x64_bf16 v[56:59], v[36:39], v[160:167], v1
  v_smfmac_f32_16x16x64_bf16 v[60:63], v[36:39], v[168:175], v1
  s_waitcnt lgkmcnt(0)
  v_smfmac_f32_16x16x64_bf16 v[52:55], v[28:31], v[64:71], v1
  v_lshrrev_b32 v3, 1, v0
  s_nop 3
  v_pk_add_f32 v[56:57], v[56:57], v[58:59]
  v_cvt_pk_bf16_f32 v42, v56, v57
  v_pk_add_f32 v[60:61], v[60:61], v[62:63]
  v_cvt_pk_bf16_f32 v43, v60, v61
  buffer_store_dwordx2 v[42:43], v3, s[4:7], s23 offen offset:512 sc1
  v_pk_add_f32 v[48:49], v[48:49], v[50:51]
  v_cvt_pk_bf16_f32 v40, v48, v49
  v_pk_add_f32 v[52:53], v[52:53], v[54:55]
  v_cvt_pk_bf16_f32 v41, v52, v53
  buffer_store_dwordx2 v[40:41], v3, s[4:7], s23 offen sc1
  s_branch CHAIN_DONE
REDOF:
  s_waitcnt vmcnt(0) lgkmcnt(0)
  s_nop 15
  v_mov_b64 v[40:41], 0
  v_mov_b64 v[42:43], 0
  v_mov_b64 v[44:45], 0
  v_mov_b64 v[46:47], 0
  v_mov_b64 v[48:49], 0
  v_mov_b64 v[50:51], 0
  v_mov_b64 v[52:53], 0
  v_mov_b64 v[54:55], 0
  v_mov_b64 v[56:57], 0
  v_mov_b64 v[58:59], 0
  v_mov_b64 v[60:61], 0
  v_mov_b64 v[62:63], 0
  v_bfe_u32 v64, v0, 6, 2
  v_lshlrev_b32 v3, 8, v64
  v_lshrrev_b32 v64, 8, v0
  v_lshl_add_u32 v3, v64, 6, v3
  v_bfe_u32 v64, v0, 4, 1
  v_lshl_add_u32 v3, v64, 5, v3
  v_bfe_u32 v64, v0, 5, 1
  v_lshl_add_u32 v3, v64, 4, v3
  v_subrev_u32 v65, s3, v3
RD0F:
  buffer_load_dwordx4 v[16:19], v3, s[4:7], s18 offen offset:0 sc1
  s_add_u32 s27, s27, 1
  s_cmp_gt_u32 s27, 0x40000
  s_cselect_b32 s15, 1, s15
  s_cmp_lg_u32 s15, 0
  s_cselect_b64 s[36:37], 0, -1
  s_waitcnt vmcnt(0)
  v_max_u32 v66, v17, v19
  v_cmp_eq_u32 vcc, -1, v66
  s_nop 0
  s_and_b64 vcc, vcc, s[36:37]
  s_cbranch_vccnz RD0F
  ds_read_b128 v[72:75], v2 offset:0
  ds_read_b128 v[76:79], v2 offset:1024
  s_waitcnt lgkmcnt(0)
  v_smfmac_f32_16x16x64_bf16 v[40:43], v[16:19], v[72:79], v1
  ds_read_b128 v[72:75], v2 offset:2048
  ds_read_b128 v[76:79], v2 offset:3072
  s_waitcnt lgkmcnt(0)
  v_smfmac_f32_16x16x64_bf16 v[44:47], v[16:19], v[72:79], v1
  v_smfmac_f32_16x16x64_bf16 v[48:51], v[16:19], a[96:103], v1
  v_smfmac_f32_16x16x64_bf16 v[52:55], v[16:19], a[104:111], v1
  v_smfmac_f32_16x16x64_bf16 v[56:59], v[16:19], a[208:215], v1
  v_smfmac_f32_16x16x64_bf16 v[60:63], v[16:19], a[216:223], v1
RD1F:
  buffer_load_dwordx4 v[16:19], v3, s[4:7], s18 offen offset:1024 sc1
  s_add_u32 s27, s27, 1
  s_cmp_gt_u32 s27, 0x40000
  s_cselect_b32 s15, 1, s15
  s_cmp_lg_u32 s15, 0
  s_cselect_b64 s[36:37], 0, -1
  s_waitcnt vmcnt(0)
  v_max_u32 v66, v17, v19
  v_cmp_eq_u32 vcc, -1, v66
  s_nop 0
  s_and_b64 vcc, vcc, s[36:37]
  s_cbranch_vccnz RD1F
  v_smfmac_f32_16x16x64_bf16 v[40:43], v[16:19], a[0:7], v1
  v_smfmac_f32_16x16x64_bf16 v[44:47], v[16:19], a[8:15], v1
  v_smfmac_f32_16x16x64_bf16 v[48:51], v[16:19], a[112:119], v1
  v_smfmac_f32_16x16x64_bf16 v[52:55], v[16:19], a[120:127], v1
  v_smfmac_f32_16x16x64_bf16 v[56:59], v[16:19], a[224:231], v1
  v_smfmac_f32_16x16x64_bf16 v[60:63], v[16:19], a[232:239], v1
RD2F:
  buffer_load_dwordx4 v[16:19], v3, s[4:7], s18 offen offset:2048 sc1
  s_add_u32 s27, s27, 1
  s_cmp_gt_u32 s27, 0x40000
  s_cselect_b32 s15, 1, s15
  s_cmp_lg_u32 s15, 0
  s_cselect_b64 s[36:37], 0, -1
  s_waitcnt vmcnt(0)
  v_max_u32 v66, v17, v19
  v_cmp_eq_u32 vcc, -1, v66
  s_nop 0
  s_and_b64 vcc, vcc, s[36:37]
  s_cbranch_vccnz RD2F
  v_smfmac_f32_16x16x64_bf16 v[40:43], v[16:19], a[16:23], v1
  v_smfmac_f32_16x16x64_bf16 v[44:47], v[16:19], a[24:31], v1
  ds_read_b128 v[72:75], v2 offset:4096
  ds_read_b128 v[76:79], v2 offset:5120
  s_waitcnt lgkmcnt(0)
  v_smfmac_f32_16x16x64_bf16 v[48:51], v[16:19], v[72:79], v1
  ds_read_b128 v[72:75], v2 offset:6144
  ds_read_b128 v[76:79], v2 offset:7168
  s_waitcnt lgkmcnt(0)
  v_smfmac_f32_16x16x64_bf16 v[52:55], v[16:19], v[72:79], v1
  v_smfmac_f32_16x16x64_bf16 v[56:59], v[16:19], a[240:247], v1
  v_smfmac_f32_16x16x64_bf16 v[60:63], v[16:19], a[248:255], v1
RD3F:
  buffer_load_dwordx4 v[16:19], v65, s[4:7], s18 offen offset:3072 sc1
  s_add_u32 s27, s27, 1
  s_cmp_gt_u32 s27, 0x40000
  s_cselect_b32 s15, 1, s15
  s_cmp_lg_u32 s15, 0
  s_cselect_b64 s[36:37], 0, -1
  s_waitcnt vmcnt(0)
  v_max_u32 v66, v17, v19
  v_cmp_eq_u32 vcc, -1, v66
  s_nop 0
  s_and_b64 vcc, vcc, s[36:37]
  s_cbranch_vccnz RD3F
  v_smfmac_f32_16x16x64_bf16 v[40:43], v[16:19], a[32:39], v1
  v_smfmac_f32_16x16x64_bf16 v[44:47], v[16:19], a[40:47], v1
  v_smfmac_f32_16x16x64_bf16 v[48:51], v[16:19], a[128:135], v1
  v_smfmac_f32_16x16x64_bf16 v[52:55], v[16:19], a[136:143], v1
  v_smfmac_f32_16x16x64_bf16 v[56:59], v[16:19], v[80:87], v1
  v_smfmac_f32_16x16x64_bf16 v[60:63], v[16:19], v[88:95], v1
RD4F:
  buffer_load_dwordx4 v[16:19], v65, s[4:7], s39 offen offset:0 sc1
  s_add_u32 s27, s27, 1
  s_cmp_gt_u32 s27, 0x40000
  s_cselect_b32 s15, 1, s15
  s_cmp_lg_u32 s15, 0
  s_cselect_b64 s[36:37], 0, -1
  s_waitcnt vmcnt(0)
  v_max_u32 v66, v17, v19
  v_cmp_eq_u32 vcc, -1, v66
  s_nop 0
  s_and_b64 vcc, vcc, s[36:37]
  s_cbranch_vccnz RD4F
  ds_read_b128 v[72:75], v2 offset:8192
  ds_read_b128 v[76:79], v2 offset:9216
  s_waitcnt lgkmcnt(0)
  v_smfmac_f32_16x16x64_bf16 v[40:43], v[16:19], v[72:79], v1
  ds_read_b128 v[72:75], v2 offset:10240
  ds_read_b128 v[76:79], v2 offset:11264
  s_waitcnt lgkmcnt(0)
  v_smfmac_f32_16x16x64_bf16 v[44:47], v[16:19], v[72:79], v1
  v_smfmac_f32_16x16x64_bf16 v[48:51], v[16:19], a[144:151], v1
  v_smfmac_f32_16x16x64_bf16 v[52:55], v[16:19], a[152:159], v1
  v_smfmac_f32_16x16x64_bf16 v[56:59], v[16:19], v[96:103], v1
  v_smfmac_f32_16x16x64_bf16 v[60:63], v[16:19], v[104:111], v1
RD5F:
  buffer_load_dwordx4 v[24:27], v65, s[4:7], s39 offen offset:1024 sc1
  s_add_u32 s27, s27, 1
  s_cmp_gt_u32 s27, 0x40000
  s_cselect_b32 s15, 1, s15
  s_cmp_lg_u32 s15, 0
  s_cselect_b64 s[36:37], 0, -1
  s_waitcnt vmcnt(0)
  v_max_u32 v66, v25, v27
  v_cmp_eq_u32 vcc, -1, v66
  s_nop 0
  s_and_b64 vcc, vcc, s[36:37]
  s_cbranch_vccnz RD5F
  v_smfmac_f32_16x16x64_bf16 v[40:43], v[24:27], a[48:55], v1
  v_smfmac_f32_16x16x64_bf16 v[44:47], v[24:27], a[56:63], v1
  v_smfmac_f32_16x16x64_bf16 v[48:51], v[24:27], a[160:167], v1
  v_smfmac_f32_16x16x64_bf16 v[52:55], v[24:27], a[168:175], v1
RD6F:
  buffer_load_dwordx4 v[28:31], v65, s[4:7], s39 offen offset:2048 sc1
  s_add_u32 s27, s27, 1
  s_cmp_gt_u32 s27, 0x40000
  s_cselect_b32 s15, 1, s15
  s_cmp_lg_u32 s15, 0
  s_cselect_b64 s[36:37], 0, -1
  s_waitcnt vmcnt(0)
  v_max_u32 v66, v29, v31
  v_cmp_eq_u32 vcc, -1, v66
  s_nop 0
  s_and_b64 vcc, vcc, s[36:37]
  s_cbranch_vccnz RD6F
  v_smfmac_f32_16x16x64_bf16 v[40:43], v[28:31], a[64:71], v1
  v_smfmac_f32_16x16x64_bf16 v[44:47], v[28:31], a[72:79], v1
  ds_read_b128 v[72:75], v2 offset:12288
  ds_read_b128 v[76:79], v2 offset:13312
  s_waitcnt lgkmcnt(0)
  v_smfmac_f32_16x16x64_bf16 v[48:51], v[28:31], v[72:79], v1
  ds_read_b128 v[72:75], v2 offset:14336
  ds_read_b128 v[76:79], v2 offset:15360
  s_waitcnt lgkmcnt(0)
  v_smfmac_f32_16x16x64_bf16 v[52:55], v[28:31], v[72:79], v1
RD7F:
  buffer_load_dwordx4 v[4:7], v65, s[4:7], s39 offen offset:3072 sc1
  s_add_u32 s27, s27, 1
  s_cmp_gt_u32 s27, 0x40000
  s_cselect_b32 s15, 1, s15
  s_cmp_lg_u32 s15, 0
  s_cselect_b64 s[36:37], 0, -1
  s_waitcnt vmcnt(0)
  v_max_u32 v66, v5, v7
  v_cmp_eq_u32 vcc, -1, v66
  s_nop 0
  s_and_b64 vcc, vcc, s[36:37]
  s_cbranch_vccnz RD7F
  v_smfmac_f32_16x16x64_bf16 v[40:43], v[4:7], a[80:87], v1
  v_smfmac_f32_16x16x64_bf16 v[44:47], v[4:7], a[88:95], v1
  v_smfmac_f32_16x16x64_bf16 v[48:51], v[4:7], a[176:183], v1
  v_smfmac_f32_16x16x64_bf16 v[52:55], v[4:7], a[184:191], v1
RD8F:
  buffer_load_dwordx4 v[8:11], v65, s[4:7], s40 offen offset:0 sc1
  s_add_u32 s27, s27, 1
  s_cmp_gt_u32 s27, 0x40000
  s_cselect_b32 s15, 1, s15
  s_cmp_lg_u32 s15, 0
  s_cselect_b64 s[36:37], 0, -1
  s_waitcnt vmcnt(0)
  v_max_u32 v66, v9, v11
  v_cmp_eq_u32 vcc, -1, v66
  s_nop 0
  s_and_b64 vcc, vcc, s[36:37]
  s_cbranch_vccnz RD8F
  ds_read_b128 v[72:75], v2 offset:16384
  ds_read_b128 v[76:79], v2 offset:17408
  s_waitcnt lgkmcnt(0)
  v_smfmac_f32_16x16x64_bf16 v[40:43], v[8:11], v[72:79], v1
  ds_read_b128 v[72:75], v2 offset:18432
  ds_read_b128 v[76:79], v2 offset:19456
  s_waitcnt lgkmcnt(0)
  v_smfmac_f32_16x16x64_bf16 v[44:47], v[8:11], v[72:79], v1
  v_smfmac_f32_16x16x64_bf16 v[48:51], v[8:11], a[192:199], v1
  v_smfmac_f32_16x16x64_bf16 v[52:55], v[8:11], a[200:207], v1
  s_nop 15
  ds_read_b128 v[64:67], v0 offset:0
  ds_read_b128 v[68:71], v0 offset:4096
  ds_read_b128 v[72:75], v0 offset:1024
  ds_read_b128 v[76:79], v0 offset:5120
  v_pk_add_f32 v[48:49], v[48:49], v[50:51]
  v_pk_add_f32 v[52:53], v[52:53], v[54:55]
  v_cvt_pk_bf16_f32 v48, v48, v49
  v_cvt_pk_bf16_f32 v50, v52, v53
  v_pk_add_f32 v[40:41], v[40:41], v[42:43]
  v_pk_add_f32 v[44:45], v[44:45], v[46:47]
  v_pk_mul_f32 v[40:41], v[40:41], s[32:33]
  v_pk_mul_f32 v[44:45], v[44:45], s[32:33]
  v_cvt_pk_bf16_f32 v49, v40, v41
  v_cvt_pk_bf16_f32 v51, v44, v45
  ds_write2st64_b64 v12, v[48:49], v[50:51] offset0:20 offset1:21
  s_waitcnt lgkmcnt(0)
  s_branch REDOXF
RCHKF:
  s_mov_b64 exec, -1
RCH2F:
  buffer_load_dwordx4 v[4:7], v76, s[4:7], s43 offen sc1
  s_add_u32 s43, s43, 49152
  buffer_load_dwordx4 v[8:11], v76, s[4:7], s43 offen sc1
  s_add_u32 s43, s43, 49152
  buffer_load_dwordx4 v[12:15], v76, s[4:7], s43 offen sc1
  s_add_u32 s43, s43, 49152
  buffer_load_dwordx4 v[16:19], v76, s[4:7], s43 offen sc1
  s_add_u32 s43, s43, 49152
  buffer_load_dwordx4 v[20:23], v76, s[4:7], s43 offen sc1
  s_add_u32 s43, s43, 49152
  buffer_load_dwordx4 v[24:27], v76, s[4:7], s43 offen sc1
  s_add_u32 s43, s43, 49152
  buffer_load_dwordx4 v[28:31], v76, s[4:7], s43 offen sc1
  s_add_u32 s43, s43, 49152
  buffer_load_dwordx4 v[32:35], v76, s[4:7], s43 offen sc1
  s_add_u32 s43, s43, 4294623232
  s_add_u32 s27, s27, 1
  s_cmp_gt_u32 s27, 0x40000
  s_cselect_b32 s15, 1, s15
  s_cmp_eq_u32 s15, 0
  s_cbranch_scc1 RWAITF
  s_waitcnt vmcnt(0)
  s_mov_b64 exec, s[30:31]
  s_branch RGOF
STEPS:
  s_add_u32 s39, s18, 4096
  s_add_u32 s40, s18, 8192
  s_add_u32 m0, s26, 10240
  s_add_u32 s34, s18, s26
  s_add_u32 s34, s34, 3072
  s_mov_b32 s27, 0
POLLM0S:
  buffer_load_dwordx4 v[4:7], v3, s[4:7], s18 offen offset:0 sc1
  buffer_load_dwordx4 v[8:11], v3, s[4:7], s18 offen offset:1024 sc1
  buffer_load_dwordx4 v[12:15], v3, s[4:7], s18 offen offset:2048 sc1
  s_add_u32 s27, s27, 1
  s_cmp_gt_u32 s27, 0x40000
  s_cselect_b32 s15, 1, s15
  s_cmp_lg_u32 s15, 0
  s_cselect_b64 s[36:37], 0, -1
  s_waitcnt vmcnt(2)
  v_max_u32 v39, v5, v7
  s_waitcnt vmcnt(1)
  v_max3_u32 v39, v39, v9, v11
  s_waitcnt vmcnt(0)
  v_max3_u32 v39, v39, v13, v15
  v_cmp_eq_u32 vcc, -1, v39
  s_nop 0
  s_and_b64 vcc, vcc, s[36:37]
  s_cbranch_vccnz POLLM0S
  v_smfmac_f32_16x16x64_bf16 v[48:51], v[4:7], a[96:103], v1
  buffer_load_dwordx4 v0, s[4:7], s34 offen sc1 lds
  v_smfmac_f32_16x16x64_bf16 v[52:55], v[4:7], a[104:111], v1
  s_mov_b64 exec, 0xffffffff
  buffer_load_dwordx4 v0, s[4:7], s34 offen offset:1024 sc1 lds
  s_mov_b64 exec, -1
  v_smfmac_f32_16x16x64_bf16 v[56:59], v[4:7], a[208:215], v1
  buffer_load_dwordx4 v[32:35], v0, s[4:7], s22 offen offset:0 sc1
  v_smfmac_f32_16x16x64_bf16 v[60:63], v[4:7], a[216:223], v1
  buffer_load_dwordx4 v[36:39], v0, s[4:7], s22 offen offset:1024 sc1
  s_waitcnt lgkmcnt(0)
  v_smfmac_f32_16x16x64_bf16 v[40:43], v[4:7], v[64:71], v1
  ds_read_b128 v[64:67], v2 offset:4096
  v_smfmac_f32_16x16x64_bf16 v[44:47], v[4:7], v[72:79], v1
  ds_read_b128 v[68:71], v2 offset:5120
  v_smfmac_f32_16x16x64_bf16 v[40:43], v[8:11], a[0:7], v1
  ds_read_b128 v[72:75], v2 offset:6144
  v_smfmac_f32_16x16x64_bf16 v[44:47], v[8:11], a[8:15], v1
  ds_read_b128 v[76:79], v2 offset:7168
  v_smfmac_f32_16x16x64_bf16 v[48:51], v[8:11], a[112:119], v1
  v_smfmac_f32_16x16x64_bf16 v[52:55], v[8:11], a[120:127], v1
  v_smfmac_f32_16x16x64_bf16 v[56:59], v[8:11], a[224:231], v1
  v_smfmac_f32_16x16x64_bf16 v[60:63], v[8:11], a[232:239], v1
  v_smfmac_f32_16x16x64_bf16 v[40:43], v[12:15], a[16:23], v1
  s_waitcnt vmcnt(2)
  s_barrier
  v_smfmac_f32_16x16x64_bf16 v[44:47], v[12:15], a[24:31], v1
  ds_read_b128 v[16:19], v3 offset:10240
  ds_read_b128 v[20:23], v3 offset:11264
  v_smfmac_f32_16x16x64_bf16 v[56:59], v[12:15], a[240:247], v1
  ds_read_b128 v[24:27], v3 offset:12288
  ds_read_b128 v[28:31], v3 offset:13312
  v_smfmac_f32_16x16x64_bf16 v[60:63], v[12:15], a[248:255], v1
  ds_read_b128 v[4:7], v3 offset:14336
  ds_read_b128 v[8:11], v3 offset:15360
  s_waitcnt lgkmcnt(8)
  v_smfmac_f32_16x16x64_bf16 v[48:51], v[12:15], v[64:71], v1
  v_lshlrev_b32 v3, 3, v0
  s_mov_b32 m0, 8192
  s_mov_b64 exec, 0xffffffff
  buffer_load_dword v3, s[4:7], s50 offen sc1 lds
  s_mov_b64 exec, -1
  s_waitcnt lgkmcnt(6)
  v_smfmac_f32_16x16x64_bf16 v[52:55], v[12:15], v[72:79], v1
  ds_read_b128 v[64:67], v2 offset:8192
  s_waitcnt lgkmcnt(6)
  v_smfmac_f32_16x16x64_bf16 v[40:43], v[16:19], a[32:39], v1
  v_max_u32 v3, v17, v19
  ds_read_b128 v[68:71], v2 offset:9216
  v_smfmac_f32_16x16x64_bf16 v[44:47], v[16:19], a[40:47], v1
  ds_read_b128 v[72:75], v2 offset:10240
  v_smfmac_f32_16x16x64_bf16 v[48:51], v[16:19], a[128:135], v1
  ds_read_b128 v[76:79], v2 offset:11264
  v_smfmac_f32_16x16x64_bf16 v[52:55], v[16:19], a[136:143], v1
  v_smfmac_f32_16x16x64_bf16 v[56:59], v[16:19], v[80:87], v1
  v_smfmac_f32_16x16x64_bf16 v[60:63], v[16:19], v[88:95], v1
  s_waitcnt lgkmcnt(8)
  v_smfmac_f32_16x16x64_bf16 v[48:51], v[20:23], a[144:151], v1
  v_max3_u32 v3, v3, v21, v23
  v_smfmac_f32_16x16x64_bf16 v[52:55], v[20:23], a[152:159], v1
  s_waitcnt lgkmcnt(2)
  v_smfmac_f32_16x16x64_bf16 v[40:43], v[20:23], v[64:71], v1
  ds_read_b128 v[64:67], v2 offset:12288
  s_waitcnt lgkmcnt(1)
  v_smfmac_f32_16x16x64_bf16 v[44:47], v[20:23], v[72:79], v1
  ds_read_b128 v[68:71], v2 offset:13312
  v_smfmac_f32_16x16x64_bf16 v[40:43], v[24:27], a[48:55], v1
  v_max3_u32 v3, v3, v25, v27
  ds_read_b128 v[72:75], v2 offset:14336
  v_smfmac_f32_16x16x64_bf16 v[44:47], v[24:27], a[56:63], v1
  ds_read_b128 v[76:79], v2 offset:15360
  v_smfmac_f32_16x16x64_bf16 v[48:51], v[24:27], a[160:167], v1
  ds_read_b128 v[12:15], v0 offset:9216
  v_smfmac_f32_16x16x64_bf16 v[52:55], v[24:27], a[168:175], v1
  v_smfmac_f32_16x16x64_bf16 v[40:43], v[28:31], a[64:71], v1
  v_max3_u32 v3, v3, v29, v31
  v_smfmac_f32_16x16x64_bf16 v[44:47], v[28:31], a[72:79], v1
  s_waitcnt lgkmcnt(3)
  v_smfmac_f32_16x16x64_bf16 v[48:51], v[28:31], v[64:71], v1
  ds_read_b128 v[64:67], v2 offset:16384
  s_waitcnt lgkmcnt(2)
  v_smfmac_f32_16x16x64_bf16 v[52:55], v[28:31], v[72:79], v1
  ds_read_b128 v[68:71], v2 offset:17408
  v_smfmac_f32_16x16x64_bf16 v[40:43], v[4:7], a[80:87], v1
  v_max3_u32 v3, v3, v5, v7
  ds_read_b128 v[72:75], v2 offset:18432
  v_smfmac_f32_16x16x64_bf16 v[44:47], v[4:7], a[88:95], v1
  ds_read_b128 v[76:79], v2 offset:19456
  v_smfmac_f32_16x16x64_bf16 v[48:51], v[4:7], a[176:183], v1
  v_smfmac_f32_16x16x64_bf16 v[52:55], v[4:7], a[184:191], v1
  v_smfmac_f32_16x16x64_bf16 v[48:51], v[8:11], a[192:199], v1
  v_max3_u32 v3, v3, v9, v11
  v_smfmac_f32_16x16x64_bf16 v[52:55], v[8:11], a[200:207], v1
  s_waitcnt lgkmcnt(2)
  v_smfmac_f32_16x16x64_bf16 v[40:43], v[8:11], v[64:71], v1
  s_waitcnt lgkmcnt(0)
  v_smfmac_f32_16x16x64_bf16 v[44:47], v[8:11], v[72:79], v1
  v_cmp_eq_u32 vcc, -1, v3
  v_smfmac_f32_16x16x64_bf16 v[56:59], v[20:23], v[96:103], v1
  v_add_u32 v12, s44, v12
  v_pk_add_f32 v[48:49], v[48:49], v[50:51]
  v_pk_add_f32 v[52:53], v[52:53], v[54:55]
  v_cvt_pk_bf16_f32 v48, v48, v49
  v_cvt_pk_bf16_f32 v50, v52, v53
  v_pk_add_f32 v[40:41], v[40:41], v[42:43]
  v_pk_add_f32 v[44:45], v[44:45], v[46:47]
  v_pk_mul_f32 v[40:41], v[40:41], s[32:33]
  v_pk_mul_f32 v[44:45], v[44:45], s[32:33]
  v_cvt_pk_bf16_f32 v49, v40, v41
  v_cvt_pk_bf16_f32 v51, v44, v45
  ds_write2st64_b64 v12, v[48:49], v[50:51] offset0:20 offset1:21
  v_smfmac_f32_16x16x64_bf16 v[60:63], v[20:23], v[104:111], v1
  ds_read_b128 v[64:67], v0 offset:0
  ds_read_b128 v[68:71], v0 offset:4096
  s_and_b64 vcc, vcc, s[36:37]
  s_cbranch_vccnz REDOS
REDOXS:
  v_smfmac_f32_16x16x64_bf16 v[56:59], v[24:27], v[112:119], v1
  ds_read_b128 v[72:75], v0 offset:1024
  ds_read_b128 v[76:79], v0 offset:5120
  v_lshrrev_b32 v3, 1, v0
  v_mov_b32 v52, v48
  v_mov_b32 v53, v50
  v_smfmac_f32_16x16x64_bf16 v[60:63], v[24:27], v[120:127], v1
  ds_read_b128 v[20:23], v0 offset:2048
  ds_read_b128 v[24:27], v0 offset:6144
  ds_read_b128 v[16:19], v0 offset:3072
  v_smfmac_f32_16x16x64_bf16 v[56:59], v[28:31], v[128:135], v1
  v_smfmac_f32_16x16x64_bf16 v[60:63], v[28:31], v[136:143], v1
  s_waitcnt lgkmcnt(7)
  s_barrier
  ds_read_b64_tr_b16 v[40:41], v13 offset:10240
  ds_read_b64_tr_b16 v[42:43], v13 offset:10368
  ds_read_b64_tr_b16 v[44:45], v13 offset:11264
  ds_read_b64_tr_b16 v[46:47], v13 offset:11392
  ds_read_b64_tr_b16 v[48:49], v13 offset:12288
  ds_read_b64_tr_b16 v[50:51], v13 offset:12416
  buffer_store_dwordx2 v[52:53], v3, s[4:7], s23 offen sc1
  ds_read_b64_tr_b16 v[52:53], v13 offset:13312
  ds_read_b64_tr_b16 v[54:55], v13 offset:13440
  v_smfmac_f32_16x16x64_bf16 v[56:59], v[4:7], v[144:151], v1
  v_smfmac_f32_16x16x64_bf16 v[60:63], v[4:7], v[152:159], v1
  v_smfmac_f32_16x16x64_bf16 v[56:59], v[8:11], v[160:167], v1
  v_smfmac_f32_16x16x64_bf16 v[60:63], v[8:11], v[168:175], v1
  s_waitcnt lgkmcnt(6)
  v_mfma_f32_16x16x32_bf16 v[28:31], v[64:67], v[40:43], 0
  v_mfma_f32_16x16x32_bf16 v[4:7], v[68:71], v[40:43], 0
  ds_read_b128 v[64:67], v0 offset:7168
  v_mfma_f32_16x16x32_bf16 v[8:11], v[40:43], v[40:43], 0
  s_waitcnt lgkmcnt(5)
  v_mfma_f32_16x16x32_bf16 v[28:31], v[72:75], v[44:47], v[28:31]
  v_mfma_f32_16x16x32_bf16 v[4:7], v[76:79], v[44:47], v[4:7]
  v_pk_add_f32 v[56:57], v[56:57], v[58:59]
  v_pk_add_f32 v[60:61], v[60:61], v[62:63]
  v_mfma_f32_16x16x32_bf16 v[8:11], v[44:47], v[44:47], v[8:11]
  v_cvt_pk_bf16_f32 v56, v56, v57
  v_cvt_pk_bf16_f32 v57, v60, v61
  s_waitcnt lgkmcnt(3)
  v_mfma_f32_16x16x32_bf16 v[28:31], v[20:23], v[48:51], v[28:31]
  buffer_store_dwordx2 v[56:57], v3, s[4:7], s23 offen offset:512 sc1
  v_mfma_f32_16x16x32_bf16 v[4:7], v[24:27], v[48:51], v[4:7]
  v_xor_b32 v14, s45, v14
  v_xor_b32 v12, 32, v14
  v_mfma_f32_16x16x32_bf16 v[8:11], v[48:51], v[48:51], v[8:11]
  v_xor_b32 v13, 128, v15
  s_waitcnt lgkmcnt(1)
  v_mfma_f32_16x16x32_bf16 v[8:11], v[52:55], v[52:55], v[8:11]
  v_mfma_f32_16x16x32_bf16 v[28:31], v[16:19], v[52:55], v[28:31]
  s_waitcnt lgkmcnt(0)
  v_mfma_f32_16x16x32_bf16 v[4:7], v[64:67], v[52:55], v[4:7]
  ds_read_b128 v[40:43], v2 offset:24576
  ds_read_b128 v[44:47], v2 offset:25600
  ds_read_b128 v[72:75], v2 offset:22528
  ds_read_b128 v[76:79], v2 offset:23552
  s_nop 1
  v_max3_f32 v58, v8, v9, v28
  v_max3_f32 v58, v58, v29, v30
  v_mov_b32 v53, 0
  v_mov_b32 v54, 0
  v_max3_f32 v59, v4, v5, v6
  v_max3_f32 v58, v58, v31, v7
  v_max_f32 v58, v58, v59
  v_max_f32 v59, v58, v59
  v_mov_b64 v[16:17], s[8:9]
  v_mov_b64 v[18:19], s[8:9]
  v_permlane32_swap_b32 v58, v59
  v_max_f32 v58, v58, v59
  v_max_f32 v59, v58, v59
  ds_read_b128 v[64:67], v2 offset:20480
  ds_read_b128 v[68:71], v2 offset:21504
  v_permlane16_swap_b32 v58, v59
  v_max_f32 v58, v58, v59
  v_pk_add_f32 v[28:29], v[28:29], v[58:59] op_sel_hi:[1,0] neg_lo:[0,1] neg_hi:[0,1]
  v_pk_add_f32 v[30:31], v[30:31], v[58:59] op_sel_hi:[1,0] neg_lo:[0,1] neg_hi:[0,1]
  v_pk_add_f32 v[4:5], v[4:5], v[58:59] op_sel_hi:[1,0] neg_lo:[0,1] neg_hi:[0,1]
  v_pk_add_f32 v[6:7], v[6:7], v[58:59] op_sel_hi:[1,0] neg_lo:[0,1] neg_hi:[0,1]
  v_pk_add_f32 v[8:9], v[8:9], v[58:59] op_sel_hi:[1,0] neg_lo:[0,1] neg_hi:[0,1]
  v_exp_f32 v28, v28
  v_exp_f32 v29, v29
  v_exp_f32 v30, v30
  v_exp_f32 v31, v31
  v_cvt_pk_bf16_f32 v48, v28, v29
  v_exp_f32 v4, v4
  v_exp_f32 v5, v5
  v_cvt_pk_bf16_f32 v49, v30, v31
  v_exp_f32 v6, v6
  v_exp_f32 v7, v7
  v_cvt_pk_bf16_f32 v50, v4, v5
  v_exp_f32 v8, v8
  v_cvt_pk_bf16_f32 v51, v6, v7
  v_exp_f32 v9, v9
  s_waitcnt vmcnt(3)
  v_mfma_f32_16x16x32_bf16 v[60:63], v[16:19], v[48:51], 0
  v_cvt_pk_bf16_f32 v52, v8, v9
  v_cvt_pk_bf16_f32 v55, v8, v9
  v_mfma_f32_16x16x32_bf16 v[20:23], v[32:35], v[48:51], 0
  v_mfma_f32_16x16x16_bf16 v[60:63], v[16:17], v[52:53], v[60:63]
  v_mfma_f32_16x16x32_bf16 v[24:27], v[36:39], v[48:51], 0
  v_mfma_f32_16x16x16_bf16 v[20:23], v[56:57], v[52:53], v[20:23]
  v_mfma_f32_16x16x16_bf16 v[24:27], v[56:57], v[54:55], v[24:27]
  ds_read_b128 v[48:51], v2 offset:26624
  ds_read_b128 v[52:55], v2 offset:27648
  v_mov_b64 v[28:29], 0
  v_mov_b64 v[30:31], 0
  s_nop 0
  v_rcp_f32 v60, v60
  v_mov_b64 v[32:33], 0
  v_mov_b64 v[34:35], 0
  v_mov_b64 v[36:37], 0
  v_mov_b64 v[38:39], 0
  v_pk_mul_f32 v[20:21], v[20:21], v[60:61] op_sel_hi:[1,0]
  v_pk_mul_f32 v[22:23], v[22:23], v[60:61] op_sel_hi:[1,0]
  v_cvt_pk_bf16_f32 v20, v20, v21
  v_cvt_pk_bf16_f32 v21, v22, v23
  s_mov_b64 exec, s[28:29]
  ds_write_b64 v14, v[20:21] offset:14336
  v_pk_mul_f32 v[24:25], v[24:25], v[60:61] op_sel_hi:[1,0]
  v_pk_mul_f32 v[26:27], v[26:27], v[60:61] op_sel_hi:[1,0]
  v_cvt_pk_bf16_f32 v24, v24, v25
  v_cvt_pk_bf16_f32 v25, v26, v27
  ds_write_b64 v12, v[24:25] offset:14336
  s_mov_b64 exec, -1
  v_mov_b32 v12, 0
  v_mov_b32 v14, 0
  v_mov_b64 v[16:17], 0
  v_mov_b64 v[18:19], 0
  v_mov_b64 v[20:21], 0
  v_mov_b64 v[22:23], 0
  v_mov_b64 v[24:25], 0
  v_mov_b64 v[26:27], 0
  s_waitcnt lgkmcnt(0)
  s_barrier
  ds_read_b128 v[4:7], v15 offset:14336
  ds_read_b128 v[8:11], v13 offset:14336
  ds_read_b128 v[56:59], v2 offset:32768
  ds_read_b128 v[60:63], v2 offset:33792
  v_mov_b32 v13, 0
  v_mov_b32 v15, 0
  s_waitcnt lgkmcnt(3)
  s_nop 0
  v_smfmac_f32_16x16x64_bf16 v[12:15], v[4:7], v[176:183], v1
  v_smfmac_f32_16x16x64_bf16 v[16:19], v[4:7], v[184:191], v1
  v_smfmac_f32_16x16x64_bf16 v[20:23], v[4:7], v[192:199], v1
  s_waitcnt lgkmcnt(2)
  v_smfmac_f32_16x16x64_bf16 v[12:15], v[8:11], v[64:71], v1
  ds_read_b128 v[64:67], v2 offset:28672
  v_smfmac_f32_16x16x64_bf16 v[16:19], v[8:11], v[72:79], v1
  ds_read_b128 v[68:71], v2 offset:29696
  v_smfmac_f32_16x16x64_bf16 v[20:23], v[8:11], v[40:47], v1
  ds_read_b128 v[72:75], v2 offset:30720
  v_smfmac_f32_16x16x64_bf16 v[24:27], v[4:7], v[200:207], v1
  ds_read_b128 v[76:79], v2 offset:31744
  v_mov_b64 v[40:41], 0
  v_mov_b64 v[42:43], 0
  v_smfmac_f32_16x16x64_bf16 v[28:31], v[4:7], v[208:215], v1
  v_mov_b64 v[44:45], 0
  v_mov_b64 v[46:47], 0
  v_smfmac_f32_16x16x64_bf16 v[32:35], v[4:7], v[216:223], v1
  v_pk_add_f32 v[12:13], v[12:13], v[14:15]
  v_cvt_pk_bf16_f32 v12, v12, v13
  v_mov_b32 v15, s54
  v_smfmac_f32_16x16x64_bf16 v[24:27], v[8:11], v[48:55], v1
  ds_read_b128 v[48:51], v2 offset:34816
  v_pk_add_f32 v[16:17], v[16:17], v[18:19]
  v_cvt_pk_bf16_f32 v13, v16, v17
  v_pk_add_f32 v[20:21], v[20:21], v[22:23]
  s_waitcnt lgkmcnt(3)
  v_smfmac_f32_16x16x64_bf16 v[28:31], v[8:11], v[64:71], v1
  ds_read_b128 v[52:55], v2 offset:35840
  v_cvt_pk_bf16_f32 v14, v20, v21
  buffer_store_dwordx4 v[12:15], v0, s[4:7], s17 offen offset:0 sc1
  s_waitcnt lgkmcnt(2)
  v_smfmac_f32_16x16x64_bf16 v[32:35], v[8:11], v[72:79], v1
  v_smfmac_f32_16x16x64_bf16 v[36:39], v[4:7], v[224:231], v1
  v_smfmac_f32_16x16x64_bf16 v[40:43], v[4:7], v[232:239], v1
  v_smfmac_f32_16x16x64_bf16 v[44:47], v[4:7], v[240:247], v1
  v_pk_add_f32 v[24:25], v[24:25], v[26:27]
  v_cvt_pk_bf16_f32 v24, v24, v25
  v_mov_b32 v27, s54
  v_smfmac_f32_16x16x64_bf16 v[44:47], v[8:11], v[248:255], v1
  v_pk_add_f32 v[28:29], v[28:29], v[30:31]
  v_cvt_pk_bf16_f32 v25, v28, v29
  v_pk_add_f32 v[32:33], v[32:33], v[34:35]
  v_smfmac_f32_16x16x64_bf16 v[36:39], v[8:11], v[56:63], v1
  v_cvt_pk_bf16_f32 v26, v32, v33
  buffer_store_dwordx4 v[24:27], v0, s[4:7], s17 offen offset:1024 sc1
  s_waitcnt lgkmcnt(0)
  v_smfmac_f32_16x16x64_bf16 v[40:43], v[8:11], v[48:55], v1
  v_pk_add_f32 v[44:45], v[44:45], v[46:47]
  s_nop 2
  v_pk_add_f32 v[36:37], v[36:37], v[38:39]
  v_cvt_pk_bf16_f32 v38, v44, v45
  v_cvt_pk_bf16_f32 v36, v36, v37
  v_mov_b32 v39, s54
  v_pk_add_f32 v[40:41], v[40:41], v[42:43]
  v_cvt_pk_bf16_f32 v37, v40, v41
  buffer_store_dwordx4 v[36:39], v0, s[4:7], s17 offen offset:2048 sc1
  s_add_u32 s22, s22, 262144
  s_add_u32 s50, s50, 262144
  s_add_u32 s23, s23, 131072
  s_xor_b32 s17, s17, s42
  s_add_u32 s14, s14, 1
  s_and_b32 s34, s14, 3
  s_lshl_b32 s54, s34, 7
  s_add_u32 s54, s54, 0x3f80
  s_bitcmp0_b32 s25, 0
  s_cbranch_scc1 NOREDS
  v_lshrrev_b32 v78, 8, v0
  v_mul_u32_u24 v76, 12288, v78
  v_and_or_b32 v76, v0, s47, v76
  s_add_u32 s43, s16, s41
  s_mov_b32 s27, 0
  s_sleep 7
  buffer_load_dwordx4 v[4:7], v76, s[4:7], s43 offen sc1
  s_add_u32 s43, s43, 49152
  buffer_load_dwordx4 v[8:11], v76, s[4:7], s43 offen sc1
  s_add_u32 s43, s43, 49152
  buffer_load_dwordx4 v[12:15], v76, s[4:7], s43 offen sc1
  s_add_u32 s43, s43, 49152
  buffer_load_dwordx4 v[16:19], v76, s[4:7], s43 offen sc1
  s_add_u32 s43, s43, 49152
  buffer_load_dwordx4 v[20:23], v76, s[4:7], s43 offen sc1
  s_add_u32 s43, s43, 49152
  buffer_load_dwordx4 v[24:27], v76, s[4:7], s43 offen sc1
  s_add_u32 s43, s43, 49152
  buffer_load_dwordx4 v[28:31], v76, s[4:7], s43 offen sc1
  s_add_u32 s43, s43, 49152
  buffer_load_dwordx4 v[32:35], v76, s[4:7], s43 offen sc1
  s_add_u32 s43, s43, 4294623232
  v_bfe_u32 v79, v0, 4, 4
  v_and_b32 v77, 1, v79
  v_lshlrev_b32 v77, 4, v77
  v_mov_b32 v72, 0x3f80
  v_lshlrev_b32 v77, v77, v72
  v_lshrrev_b32 v72, 1, v79
  v_cmp_eq_u32 vcc, 0, v72
  v_mov_b64 v[40:41], 0
  v_mov_b64 v[42:43], 0
  v_cndmask_b32 v36, 0, v77, vcc
  v_cmp_eq_u32 vcc, 1, v72
  v_mov_b64 v[44:45], 0
  v_mov_b64 v[46:47], 0
  v_cndmask_b32 v37, 0, v77, vcc
  v_cmp_eq_u32 vcc, 2, v72
  v_mov_b64 v[48:49], 0
  v_mov_b64 v[50:51], 0
  v_cndmask_b32 v38, 0, v77, vcc
  v_cmp_eq_u32 vcc, 3, v72
  v_mov_b64 v[52:53], 0
  v_mov_b64 v[54:55], 0
  v_cndmask_b32 v39, 0, v77, vcc
  v_and_b32 v77, 1, v79
  v_lshlrev_b32 v77, 5, v77
  v_lshl_add_u32 v77, v72, 10, v77
  v_lshl_add_u32 v77, v78, 3, v77
  v_add_u32 v77, s38, v77
  v_mov_b64 v[56:57], 0
  v_mov_b64 v[58:59], 0
  v_mov_b64 v[60:61], 0
  v_mov_b64 v[62:63], 0
  v_bfe_u32 v79, v0, 6, 2
  v_lshlrev_b32 v3, 8, v79
  v_lshrrev_b32 v79, 8, v0
  v_lshl_add_u32 v3, v79, 6, v3
  v_bfe_u32 v79, v0, 4, 1
  v_lshl_add_u32 v3, v79, 5, v3
  v_bfe_u32 v79, v0, 5, 1
  v_lshl_add_u32 v3, v79, 4, v3
  ds_read_b128 v[64:67], v2 offset:0
  ds_read_b128 v[68:71], v2 offset:1024
RWAITS:
  s_waitcnt vmcnt(7)
  v_mfma_f32_16x16x32_bf16 v[72:75], v[4:7], v[36:39], 0
  v_xor_b32 v78, s55, v7
  s_waitcnt vmcnt(6)
  v_mfma_f32_16x16x32_bf16 v[72:75], v[8:11], v[36:39], v[72:75]
  v_xor_b32 v79, s55, v11
  v_or_b32 v78, v78, v79
  s_waitcnt vmcnt(5)
  v_mfma_f32_16x16x32_bf16 v[72:75], v[12:15], v[36:39], v[72:75]
  v_xor_b32 v79, s55, v15
  v_or_b32 v78, v78, v79
  s_waitcnt vmcnt(4)
  v_mfma_f32_16x16x32_bf16 v[72:75], v[16:19], v[36:39], v[72:75]
  v_xor_b32 v79, s55, v19
  v_or_b32 v78, v78, v79
  s_waitcnt vmcnt(3)
  v_mfma_f32_16x16x32_bf16 v[72:75], v[20:23], v[36:39], v[72:75]
  v_xor_b32 v79, s55, v23
  v_or_b32 v78, v78, v79
  s_waitcnt vmcnt(2)
  v_mfma_f32_16x16x32_bf16 v[72:75], v[24:27], v[36:39], v[72:75]
  v_xor_b32 v79, s55, v27
  v_or_b32 v78, v78, v79
  s_waitcnt vmcnt(1)
  v_mfma_f32_16x16x32_bf16 v[72:75], v[28:31], v[36:39], v[72:75]
  v_xor_b32 v79, s55, v31
  v_or_b32 v78, v78, v79
  s_waitcnt vmcnt(0)
  v_mfma_f32_16x16x32_bf16 v[72:75], v[32:35], v[36:39], v[72:75]
  v_xor_b32 v79, s55, v35
  v_or_b32 v78, v78, v79
  v_cmp_ne_u32 vcc, 0, v78
  s_nop 0
  s_and_b64 vcc, vcc, -1
  s_cselect_b64 s[56:57], 0, s[30:31]
  s_nop 1
  v_cvt_pk_bf16_f32 v72, v72, v73
  v_cvt_pk_bf16_f32 v73, v74, v75
  s_mov_b64 exec, s[56:57]
  buffer_store_dwordx2 v[72:73], v77, s[4:7], s19 offen sc1
  s_cbranch_scc1 RCHKS
  s_branch RG2S
RGOS:
  buffer_store_dwordx2 v[72:73], v77, s[4:7], s19 offen sc1
RG2S:
  v_mov_b64 v[4:5], -1
  buffer_store_dwordx2 v[4:5], v77, s[4:7], s18 offen sc1
  s_mov_b64 exec, -1
  ds_read_b128 v[72:75], v2 offset:2048
  ds_read_b128 v[76:79], v2 offset:3072
  s_branch NEXTS
NOREDS:
  s_cmp_lt_u32 s13, 2
  s_cbranch_scc1 NODMAS
  s_mov_b32 m0, s58
  s_nop 0
  buffer_load_dwordx4 v0, s[4:7], s21 offen offset:0 sc1 lds
  buffer_load_dwordx4 v0, s[4:7], s21 offen offset:1024 sc1 lds
  buffer_load_dwordx4 v0, s[4:7], s21 offen offset:2048 sc1 lds
  buffer_load_dwordx4 v0, s[4:7], s21 offen offset:3072 sc1 lds
NODMAS:
  v_mov_b64 v[40:41], 0
  v_mov_b64 v[42:43], 0
  v_mov_b64 v[44:45], 0
  v_mov_b64 v[46:47], 0
  v_mov_b64 v[48:49], 0
  v_mov_b64 v[50:51], 0
  v_mov_b64 v[52:53], 0
  v_mov_b64 v[54:55], 0
  v_mov_b64 v[56:57], 0
  v_mov_b64 v[58:59], 0
  v_mov_b64 v[60:61], 0
  v_mov_b64 v[62:63], 0
  ds_read_b128 v[64:67], v2 offset:0
  ds_read_b128 v[68:71], v2 offset:1024
  ds_read_b128 v[72:75], v2 offset:2048
  ds_read_b128 v[76:79], v2 offset:3072
  v_bfe_u32 v4, v0, 6, 2
  v_lshlrev_b32 v3, 8, v4
  v_lshrrev_b32 v4, 8, v0
  v_lshl_add_u32 v3, v4, 6, v3
  v_bfe_u32 v4, v0, 4, 1
  v_lshl_add_u32 v3, v4, 5, v3
  v_bfe_u32 v4, v0, 5, 1
  v_lshl_add_u32 v3, v4, 4, v3
  s_sleep 15
NEXTS:
  s_xor_b32 s16, s16, s42
  s_mov_b32 s55, s54
  s_add_u32 s21, s21, 262144
  s_mov_b32 s34, s18
  s_mov_b32 s18, s19
  s_mov_b32 s19, s20
  s_mov_b32 s20, s34
  s_cmp_lg_u32 s14, 12
  s_cbranch_scc1 NKWS
  s_cmp_lg_u32 s13, 0
  s_cbranch_scc1 WFE_49
  v_mbcnt_lo_u32_b32 v4, -1, 0
  v_lshlrev_b32 v4, 2, v4
  v_add_u32 v4, 104, v4
  s_mov_b64 exec, 63
  s_mov_b32 s27, 0
WF_47:
  global_load_dword v5, v4, s[92:93] sc1
  s_add_u32 s27, s27, 1
  s_cmp_gt_u32 s27, 0x20000
  s_cbranch_scc1 WFD_48
  s_waitcnt vmcnt(0)
  v_cmp_gt_u32 vcc, 24, v5
  s_cbranch_vccz WFD_48
  s_sleep 2
  s_branch WF_47
WFD_48:
  s_waitcnt vmcnt(0)
  s_mov_b64 exec, -1
WFE_49:
  s_barrier
NKWS:
  s_cmp_lt_u32 s14, 63
  s_cbranch_scc1 STEPS
  s_add_u32 s39, s18, 4096
  s_add_u32 s40, s18, 8192
  s_mov_b32 s27, 0
FPOLLS:
  v_subrev_u32 v41, s3, v3
  buffer_load_dwordx4 v[4:7], v3, s[4:7], s18 offen offset:0 sc1
  buffer_load_dwordx4 v[8:11], v3, s[4:7], s18 offen offset:1024 sc1
  buffer_load_dwordx4 v[12:15], v3, s[4:7], s18 offen offset:2048 sc1
  buffer_load_dwordx4 v[16:19], v41, s[4:7], s18 offen offset:3072 sc1
  buffer_load_dwordx4 v[20:23], v41, s[4:7], s39 offen offset:0 sc1
  buffer_load_dwordx4 v[24:27], v41, s[4:7], s39 offen offset:1024 sc1
  buffer_load_dwordx4 v[28:31], v41, s[4:7], s39 offen offset:2048 sc1
  buffer_load_dwordx4 v[32:35], v41, s[4:7], s39 offen offset:3072 sc1
  buffer_load_dwordx4 v[36:39], v41, s[4:7], s40 offen offset:0 sc1
  s_add_u32 s27, s27, 1
  s_cmp_gt_u32 s27, 0x40000
  s_cselect_b32 s15, 1, s15
  s_waitcnt vmcnt(0)
  v_max_u32 v40, v5, v7
  v_max3_u32 v40, v40, v9, v11
  v_max3_u32 v40, v40, v13, v15
  v_max3_u32 v40, v40, v17, v19
  v_max3_u32 v40, v40, v21, v23
  v_max3_u32 v40, v40, v25, v27
  v_max3_u32 v40, v40, v29, v31
  v_max3_u32 v40, v40, v33, v35
  v_max3_u32 v40, v40, v37, v39
  v_cmp_eq_u32 vcc, -1, v40
  s_cmp_lg_u32 s15, 0
  s_cbranch_scc1 FGOS
  s_cbranch_vccnz FPOLLS
FGOS:
  ds_read_b128 v[64:67], v2 offset:4096
  ds_read_b128 v[68:71], v2 offset:5120
  ds_read_b128 v[72:75], v2 offset:6144
  ds_read_b128 v[76:79], v2 offset:7168
  ds_read_b128 v[40:43], v2 offset:12288
  ds_read_b128 v[44:47], v2 offset:13312
  v_smfmac_f32_16x16x64_bf16 v[48:51], v[4:7], a[96:103], v1
  v_smfmac_f32_16x16x64_bf16 v[52:55], v[4:7], a[104:111], v1
  v_smfmac_f32_16x16x64_bf16 v[48:51], v[8:11], a[112:119], v1
  v_smfmac_f32_16x16x64_bf16 v[52:55], v[8:11], a[120:127], v1
  v_smfmac_f32_16x16x64_bf16 v[48:51], v[16:19], a[128:135], v1
  v_smfmac_f32_16x16x64_bf16 v[52:55], v[16:19], a[136:143], v1
  v_smfmac_f32_16x16x64_bf16 v[48:51], v[20:23], a[144:151], v1
  v_smfmac_f32_16x16x64_bf16 v[52:55], v[20:23], a[152:159], v1
  v_smfmac_f32_16x16x64_bf16 v[48:51], v[24:27], a[160:167], v1
  v_smfmac_f32_16x16x64_bf16 v[52:55], v[24:27], a[168:175], v1
  v_smfmac_f32_16x16x64_bf16 v[48:51], v[32:35], a[176:183], v1
  v_smfmac_f32_16x16x64_bf16 v[52:55], v[32:35], a[184:191], v1
  v_smfmac_f32_16x16x64_bf16 v[48:51], v[36:39], a[192:199], v1
  v_smfmac_f32_16x16x64_bf16 v[52:55], v[36:39], a[200:207], v1
  s_waitcnt lgkmcnt(0)
  v_smfmac_f32_16x16x64_bf16 v[48:51], v[12:15], v[64:71], v1
  v_smfmac_f32_16x16x64_bf16 v[52:55], v[12:15], v[72:79], v1
  v_smfmac_f32_16x16x64_bf16 v[48:51], v[28:31], v[40:47], v1
  ds_read_b128 v[64:67], v2 offset:14336
  ds_read_b128 v[68:71], v2 offset:15360
  v_smfmac_f32_16x16x64_bf16 v[56:59], v[4:7], a[208:215], v1
  v_smfmac_f32_16x16x64_bf16 v[60:63], v[4:7], a[216:223], v1
  v_smfmac_f32_16x16x64_bf16 v[56:59], v[8:11], a[224:231], v1
  v_smfmac_f32_16x16x64_bf16 v[60:63], v[8:11], a[232:239], v1
  v_smfmac_f32_16x16x64_bf16 v[56:59], v[12:15], a[240:247], v1
  v_smfmac_f32_16x16x64_bf16 v[60:63], v[12:15], a[248:255], v1
  v_smfmac_f32_16x16x64_bf16 v[56:59], v[16:19], v[80:87], v1
  v_smfmac_f32_16x16x64_bf16 v[60:63], v[16:19], v[88:95], v1
  v_smfmac_f32_16x16x64_bf16 v[56:59], v[20:23], v[96:103], v1
  v_smfmac_f32_16x16x64_bf16 v[60:63], v[20:23], v[104:111], v1
  v_smfmac_f32_16x16x64_bf16 v[56:59], v[24:27], v[112:119], v1
  v_smfmac_f32_16x16x64_bf16 v[60:63], v[24:27], v[120:127], v1
  v_smfmac_f32_16x16x64_bf16 v[56:59], v[28:31], v[128:135], v1
  v_smfmac_f32_16x16x64_bf16 v[60:63], v[28:31], v[136:143], v1
  v_smfmac_f32_16x16x64_bf16 v[56:59], v[32:35], v[144:151], v1
  v_smfmac_f32_16x16x64_bf16 v[60:63], v[32:35], v[152:159], v1
  v_smfmac_f32_16x16x64_bf16 v[56:59], v[36:39], v[160:167], v1
  v_smfmac_f32_16x16x64_bf16 v[60:63], v[36:39], v[168:175], v1
  s_waitcnt lgkmcnt(0)
  v_smfmac_f32_16x16x64_bf16 v[52:55], v[28:31], v[64:71], v1
  v_lshrrev_b32 v3, 1, v0
  s_nop 3
  v_pk_add_f32 v[56:57], v[56:57], v[58:59]
  v_cvt_pk_bf16_f32 v42, v56, v57
  v_pk_add_f32 v[60:61], v[60:61], v[62:63]
  v_cvt_pk_bf16_f32 v43, v60, v61
  buffer_store_dwordx2 v[42:43], v3, s[4:7], s23 offen offset:512 sc1
  v_pk_add_f32 v[48:49], v[48:49], v[50:51]
  v_cvt_pk_bf16_f32 v40, v48, v49
  v_pk_add_f32 v[52:53], v[52:53], v[54:55]
  v_cvt_pk_bf16_f32 v41, v52, v53
  buffer_store_dwordx2 v[40:41], v3, s[4:7], s23 offen sc1
  s_branch CHAIN_DONE
REDOS:
  s_waitcnt vmcnt(0) lgkmcnt(0)
  s_nop 15
  v_mov_b64 v[40:41], 0
  v_mov_b64 v[42:43], 0
  v_mov_b64 v[44:45], 0
  v_mov_b64 v[46:47], 0
  v_mov_b64 v[48:49], 0
  v_mov_b64 v[50:51], 0
  v_mov_b64 v[52:53], 0
  v_mov_b64 v[54:55], 0
  v_mov_b64 v[56:57], 0
  v_mov_b64 v[58:59], 0
  v_mov_b64 v[60:61], 0
  v_mov_b64 v[62:63], 0
  v_bfe_u32 v64, v0, 6, 2
  v_lshlrev_b32 v3, 8, v64
  v_lshrrev_b32 v64, 8, v0
  v_lshl_add_u32 v3, v64, 6, v3
  v_bfe_u32 v64, v0, 4, 1
  v_lshl_add_u32 v3, v64, 5, v3
  v_bfe_u32 v64, v0, 5, 1
  v_lshl_add_u32 v3, v64, 4, v3
  v_subrev_u32 v65, s3, v3
RD0S:
  buffer_load_dwordx4 v[16:19], v3, s[4:7], s18 offen offset:0 sc1
  s_add_u32 s27, s27, 1
  s_cmp_gt_u32 s27, 0x40000
  s_cselect_b32 s15, 1, s15
  s_cmp_lg_u32 s15, 0
  s_cselect_b64 s[36:37], 0, -1
  s_waitcnt vmcnt(0)
  v_max_u32 v66, v17, v19
  v_cmp_eq_u32 vcc, -1, v66
  s_nop 0
  s_and_b64 vcc, vcc, s[36:37]
  s_cbranch_vccnz RD0S
  ds_read_b128 v[72:75], v2 offset:0
  ds_read_b128 v[76:79], v2 offset:1024
  s_waitcnt lgkmcnt(0)
  v_smfmac_f32_16x16x64_bf16 v[40:43], v[16:19], v[72:79], v1
  ds_read_b128 v[72:75], v2 offset:2048
  ds_read_b128 v[76:79], v2 offset:3072
  s_waitcnt lgkmcnt(0)
  v_smfmac_f32_16x16x64_bf16 v[44:47], v[16:19], v[72:79], v1
  v_smfmac_f32_16x16x64_bf16 v[48:51], v[16:19], a[96:103], v1
  v_smfmac_f32_16x16x64_bf16 v[52:55], v[16:19], a[104:111], v1
  v_smfmac_f32_16x16x64_bf16 v[56:59], v[16:19], a[208:215], v1
  v_smfmac_f32_16x16x64_bf16 v[60:63], v[16:19], a[216:223], v1
RD1S:
  buffer_load_dwordx4 v[16:19], v3, s[4:7], s18 offen offset:1024 sc1
  s_add_u32 s27, s27, 1
  s_cmp_gt_u32 s27, 0x40000
  s_cselect_b32 s15, 1, s15
  s_cmp_lg_u32 s15, 0
  s_cselect_b64 s[36:37], 0, -1
  s_waitcnt vmcnt(0)
  v_max_u32 v66, v17, v19
  v_cmp_eq_u32 vcc, -1, v66
  s_nop 0
  s_and_b64 vcc, vcc, s[36:37]
  s_cbranch_vccnz RD1S
  v_smfmac_f32_16x16x64_bf16 v[40:43], v[16:19], a[0:7], v1
  v_smfmac_f32_16x16x64_bf16 v[44:47], v[16:19], a[8:15], v1
  v_smfmac_f32_16x16x64_bf16 v[48:51], v[16:19], a[112:119], v1
  v_smfmac_f32_16x16x64_bf16 v[52:55], v[16:19], a[120:127], v1
  v_smfmac_f32_16x16x64_bf16 v[56:59], v[16:19], a[224:231], v1
  v_smfmac_f32_16x16x64_bf16 v[60:63], v[16:19], a[232:239], v1
RD2S:
  buffer_load_dwordx4 v[16:19], v3, s[4:7], s18 offen offset:2048 sc1
  s_add_u32 s27, s27, 1
  s_cmp_gt_u32 s27, 0x40000
  s_cselect_b32 s15, 1, s15
  s_cmp_lg_u32 s15, 0
  s_cselect_b64 s[36:37], 0, -1
  s_waitcnt vmcnt(0)
  v_max_u32 v66, v17, v19
  v_cmp_eq_u32 vcc, -1, v66
  s_nop 0
  s_and_b64 vcc, vcc, s[36:37]
  s_cbranch_vccnz RD2S
  v_smfmac_f32_16x16x64_bf16 v[40:43], v[16:19], a[16:23], v1
  v_smfmac_f32_16x16x64_bf16 v[44:47], v[16:19], a[24:31], v1
  ds_read_b128 v[72:75], v2 offset:4096
  ds_read_b128 v[76:79], v2 offset:5120
  s_waitcnt lgkmcnt(0)
  v_smfmac_f32_16x16x64_bf16 v[48:51], v[16:19], v[72:79], v1
  ds_read_b128 v[72:75], v2 offset:6144
  ds_read_b128 v[76:79], v2 offset:7168
  s_waitcnt lgkmcnt(0)
  v_smfmac_f32_16x16x64_bf16 v[52:55], v[16:19], v[72:79], v1
  v_smfmac_f32_16x16x64_bf16 v[56:59], v[16:19], a[240:247], v1
  v_smfmac_f32_16x16x64_bf16 v[60:63], v[16:19], a[248:255], v1
RD3S:
  buffer_load_dwordx4 v[16:19], v65, s[4:7], s18 offen offset:3072 sc1
  s_add_u32 s27, s27, 1
  s_cmp_gt_u32 s27, 0x40000
  s_cselect_b32 s15, 1, s15
  s_cmp_lg_u32 s15, 0
  s_cselect_b64 s[36:37], 0, -1
  s_waitcnt vmcnt(0)
  v_max_u32 v66, v17, v19
  v_cmp_eq_u32 vcc, -1, v66
  s_nop 0
  s_and_b64 vcc, vcc, s[36:37]
  s_cbranch_vccnz RD3S
  v_smfmac_f32_16x16x64_bf16 v[40:43], v[16:19], a[32:39], v1
  v_smfmac_f32_16x16x64_bf16 v[44:47], v[16:19], a[40:47], v1
  v_smfmac_f32_16x16x64_bf16 v[48:51], v[16:19], a[128:135], v1
  v_smfmac_f32_16x16x64_bf16 v[52:55], v[16:19], a[136:143], v1
  v_smfmac_f32_16x16x64_bf16 v[56:59], v[16:19], v[80:87], v1
  v_smfmac_f32_16x16x64_bf16 v[60:63], v[16:19], v[88:95], v1
RD4S:
  buffer_load_dwordx4 v[16:19], v65, s[4:7], s39 offen offset:0 sc1
  s_add_u32 s27, s27, 1
  s_cmp_gt_u32 s27, 0x40000
  s_cselect_b32 s15, 1, s15
  s_cmp_lg_u32 s15, 0
  s_cselect_b64 s[36:37], 0, -1
  s_waitcnt vmcnt(0)
  v_max_u32 v66, v17, v19
  v_cmp_eq_u32 vcc, -1, v66
  s_nop 0
  s_and_b64 vcc, vcc, s[36:37]
  s_cbranch_vccnz RD4S
  ds_read_b128 v[72:75], v2 offset:8192
  ds_read_b128 v[76:79], v2 offset:9216
  s_waitcnt lgkmcnt(0)
  v_smfmac_f32_16x16x64_bf16 v[40:43], v[16:19], v[72:79], v1
  ds_read_b128 v[72:75], v2 offset:10240
  ds_read_b128 v[76:79], v2 offset:11264
  s_waitcnt lgkmcnt(0)
  v_smfmac_f32_16x16x64_bf16 v[44:47], v[16:19], v[72:79], v1
  v_smfmac_f32_16x16x64_bf16 v[48:51], v[16:19], a[144:151], v1
  v_smfmac_f32_16x16x64_bf16 v[52:55], v[16:19], a[152:159], v1
  v_smfmac_f32_16x16x64_bf16 v[56:59], v[16:19], v[96:103], v1
  v_smfmac_f32_16x16x64_bf16 v[60:63], v[16:19], v[104:111], v1
RD5S:
  buffer_load_dwordx4 v[24:27], v65, s[4:7], s39 offen offset:1024 sc1
  s_add_u32 s27, s27, 1
  s_cmp_gt_u32 s27, 0x40000
  s_cselect_b32 s15, 1, s15
  s_cmp_lg_u32 s15, 0
  s_cselect_b64 s[36:37], 0, -1
  s_waitcnt vmcnt(0)
  v_max_u32 v66, v25, v27
  v_cmp_eq_u32 vcc, -1, v66
  s_nop 0
  s_and_b64 vcc, vcc, s[36:37]
  s_cbranch_vccnz RD5S
  v_smfmac_f32_16x16x64_bf16 v[40:43], v[24:27], a[48:55], v1
  v_smfmac_f32_16x16x64_bf16 v[44:47], v[24:27], a[56:63], v1
  v_smfmac_f32_16x16x64_bf16 v[48:51], v[24:27], a[160:167], v1
  v_smfmac_f32_16x16x64_bf16 v[52:55], v[24:27], a[168:175], v1
RD6S:
  buffer_load_dwordx4 v[28:31], v65, s[4:7], s39 offen offset:2048 sc1
  s_add_u32 s27, s27, 1
  s_cmp_gt_u32 s27, 0x40000
  s_cselect_b32 s15, 1, s15
  s_cmp_lg_u32 s15, 0
  s_cselect_b64 s[36:37], 0, -1
  s_waitcnt vmcnt(0)
  v_max_u32 v66, v29, v31
  v_cmp_eq_u32 vcc, -1, v66
  s_nop 0
  s_and_b64 vcc, vcc, s[36:37]
  s_cbranch_vccnz RD6S
  v_smfmac_f32_16x16x64_bf16 v[40:43], v[28:31], a[64:71], v1
  v_smfmac_f32_16x16x64_bf16 v[44:47], v[28:31], a[72:79], v1
  ds_read_b128 v[72:75], v2 offset:12288
  ds_read_b128 v[76:79], v2 offset:13312
  s_waitcnt lgkmcnt(0)
  v_smfmac_f32_16x16x64_bf16 v[48:51], v[28:31], v[72:79], v1
  ds_read_b128 v[72:75], v2 offset:14336
  ds_read_b128 v[76:79], v2 offset:15360
  s_waitcnt lgkmcnt(0)
  v_smfmac_f32_16x16x64_bf16 v[52:55], v[28:31], v[72:79], v1
RD7S:
  buffer_load_dwordx4 v[4:7], v65, s[4:7], s39 offen offset:3072 sc1
  s_add_u32 s27, s27, 1
  s_cmp_gt_u32 s27, 0x40000
  s_cselect_b32 s15, 1, s15
  s_cmp_lg_u32 s15, 0
  s_cselect_b64 s[36:37], 0, -1
  s_waitcnt vmcnt(0)
  v_max_u32 v66, v5, v7
  v_cmp_eq_u32 vcc, -1, v66
  s_nop 0
  s_and_b64 vcc, vcc, s[36:37]
  s_cbranch_vccnz RD7S
  v_smfmac_f32_16x16x64_bf16 v[40:43], v[4:7], a[80:87], v1
  v_smfmac_f32_16x16x64_bf16 v[44:47], v[4:7], a[88:95], v1
  v_smfmac_f32_16x16x64_bf16 v[48:51], v[4:7], a[176:183], v1
  v_smfmac_f32_16x16x64_bf16 v[52:55], v[4:7], a[184:191], v1
RD8S:
  buffer_load_dwordx4 v[8:11], v65, s[4:7], s40 offen offset:0 sc1
  s_add_u32 s27, s27, 1
  s_cmp_gt_u32 s27, 0x40000
  s_cselect_b32 s15, 1, s15
  s_cmp_lg_u32 s15, 0
  s_cselect_b64 s[36:37], 0, -1
  s_waitcnt vmcnt(0)
  v_max_u32 v66, v9, v11
  v_cmp_eq_u32 vcc, -1, v66
  s_nop 0
  s_and_b64 vcc, vcc, s[36:37]
  s_cbranch_vccnz RD8S
  ds_read_b128 v[72:75], v2 offset:16384
  ds_read_b128 v[76:79], v2 offset:17408
  s_waitcnt lgkmcnt(0)
  v_smfmac_f32_16x16x64_bf16 v[40:43], v[8:11], v[72:79], v1
  ds_read_b128 v[72:75], v2 offset:18432
  ds_read_b128 v[76:79], v2 offset:19456
  s_waitcnt lgkmcnt(0)
  v_smfmac_f32_16x16x64_bf16 v[44:47], v[8:11], v[72:79], v1
  v_smfmac_f32_16x16x64_bf16 v[48:51], v[8:11], a[192:199], v1
  v_smfmac_f32_16x16x64_bf16 v[52:55], v[8:11], a[200:207], v1
  s_nop 15
  ds_read_b128 v[64:67], v0 offset:0
  ds_read_b128 v[68:71], v0 offset:4096
  ds_read_b128 v[72:75], v0 offset:1024
  ds_read_b128 v[76:79], v0 offset:5120
  v_pk_add_f32 v[48:49], v[48:49], v[50:51]
  v_pk_add_f32 v[52:53], v[52:53], v[54:55]
  v_cvt_pk_bf16_f32 v48, v48, v49
  v_cvt_pk_bf16_f32 v50, v52, v53
  v_pk_add_f32 v[40:41], v[40:41], v[42:43]
  v_pk_add_f32 v[44:45], v[44:45], v[46:47]
  v_pk_mul_f32 v[40:41], v[40:41], s[32:33]
  v_pk_mul_f32 v[44:45], v[44:45], s[32:33]
  v_cvt_pk_bf16_f32 v49, v40, v41
  v_cvt_pk_bf16_f32 v51, v44, v45
  ds_write2st64_b64 v12, v[48:49], v[50:51] offset0:20 offset1:21
  s_waitcnt lgkmcnt(0)
  s_branch REDOXS
RCHKS:
  s_mov_b64 exec, -1
RCH2S:
  buffer_load_dwordx4 v[4:7], v76, s[4:7], s43 offen sc1
  s_add_u32 s43, s43, 49152
  buffer_load_dwordx4 v[8:11], v76, s[4:7], s43 offen sc1
  s_add_u32 s43, s43, 49152
  buffer_load_dwordx4 v[12:15], v76, s[4:7], s43 offen sc1
  s_add_u32 s43, s43, 49152
  buffer_load_dwordx4 v[16:19], v76, s[4:7], s43 offen sc1
  s_add_u32 s43, s43, 49152
  buffer_load_dwordx4 v[20:23], v76, s[4:7], s43 offen sc1
  s_add_u32 s43, s43, 49152
  buffer_load_dwordx4 v[24:27], v76, s[4:7], s43 offen sc1
  s_add_u32 s43, s43, 49152
  buffer_load_dwordx4 v[28:31], v76, s[4:7], s43 offen sc1
  s_add_u32 s43, s43, 49152
  buffer_load_dwordx4 v[32:35], v76, s[4:7], s43 offen sc1
  s_add_u32 s43, s43, 4294623232
  s_add_u32 s27, s27, 1
  s_cmp_gt_u32 s27, 0x40000
  s_cselect_b32 s15, 1, s15
  s_cmp_eq_u32 s15, 0
  s_cbranch_scc1 RWAITS
  s_waitcnt vmcnt(0)
  s_mov_b64 exec, s[30:31]
  s_branch RGOS
CHAIN_DONE:
K_DONE:
  s_waitcnt vmcnt(0) lgkmcnt(0)
K_END:
  s_endpgm
.section .rodata,"a"
.p2align 6
.amdhsa_kernel parallel_sum__memory_aug_recurrent_mem_tr__geglu_ffn__prompt_kernel
  .amdhsa_next_free_vgpr 512
  .amdhsa_next_free_sgpr 102
  .amdhsa_accum_offset 256
  .amdhsa_group_segment_fixed_size 0
  .amdhsa_kernarg_size 112
  .amdhsa_user_sgpr_count 2
  .amdhsa_user_sgpr_kernarg_segment_ptr 1
  .amdhsa_system_sgpr_workgroup_id_x 1
.end_amdhsa_kernel
```
